```python
import torch

def _softmax(x, axis=-1):
    return torch.softmax(x, dim=axis)
def _gelu(x):
    return torch.nn.functional.gelu(x, approximate="tanh")
def _silu(x):
    return torch.nn.functional.silu(x)
def _sigmoid(x):
    return torch.sigmoid(x)
def _layernorm(x, axis=-1, eps=1e-5):
    m = x.mean(dim=axis, keepdim=True)
    v = x.var(dim=axis, keepdim=True, unbiased=False)
    return (x - m) / torch.sqrt(v + eps)
def _scatter_add(tgt, idx, src, axis=0):
    return tgt.clone().index_add_(axis, idx, src)
def _segment_sum(src, seg, n):
    out = torch.zeros((n,) + src.shape[1:], dtype=src.dtype)
    return out.index_add_(0, seg, src)
def _pad(x, pw):
    flat = tuple(v for pair in reversed(pw) for v in pair)
    return torch.nn.functional.pad(x, flat)

kernel_name = 'concat_heads__mha_block_cached__gqa_block_cached__near_ridge'

def setup_inputs():

    _w = (lambda a: (lambda t: t.to(torch.bfloat16) if t.is_floating_point() else t)(torch.as_tensor(a)))
    def _A_setup():
        B, Sq, D = 8, 208, 512
        H, Sk, Dh = 32, 512, 128
        return {
            "x": _w((lambda *s: torch.randn(*s, dtype=torch.bfloat16) * 0.8)(B, Sq, D)),
            "k_cache": _w((lambda *s: torch.randn(*s, dtype=torch.bfloat16) * 0.8)(B, H, Sk, Dh)),
            "v_cache": _w((lambda *s: torch.randn(*s, dtype=torch.bfloat16) * 0.05)(B, H, Sk, Dh)),
            "wq": _w((lambda *s: torch.randn(*s, dtype=torch.bfloat16) * 0.8)(D, H * Dh) * (D ** -0.5)),
            "wo": _w((lambda *s: torch.randn(*s, dtype=torch.bfloat16) * 0.05)(H * Dh, D) * ((H * Dh) ** -0.5)),
        }
    _A_in = _A_setup()

    def _B_setup():
        B, Sq, D = 8, 208, 512
        Hq, Hkv, Sk, Dh = 32, 32, 512, 128
        assert Hq % Hkv == 0, (Hq, Hkv)
        return {
            "x": _w((lambda *s: torch.randn(*s, dtype=torch.bfloat16) * 0.8)(B, Sq, D)),
            "k_cache": _w((lambda *s: torch.randn(*s, dtype=torch.bfloat16) * 0.8)(B, Hkv, Sk, Dh)),
            "v_cache": _w((lambda *s: torch.randn(*s, dtype=torch.bfloat16) * 0.05)(B, Hkv, Sk, Dh)),
            "wq": _w((lambda *s: torch.randn(*s, dtype=torch.bfloat16) * 0.8)(D, Hq * Dh) * (D ** -0.5)),
            "wo": _w((lambda *s: torch.randn(*s, dtype=torch.bfloat16) * 0.05)(Hq * Dh, D) * ((Hq * Dh) ** -0.5)),
        }
    _B_in = _B_setup()

    return {
        "A_x": _A_in["x"],
        "A_k_cache": _A_in["k_cache"],
        "A_v_cache": _A_in["v_cache"],
        "A_wq": _A_in["wq"],
        "A_wo": _A_in["wo"],
        "B_x": _B_in["x"],
        "B_k_cache": _B_in["k_cache"],
        "B_v_cache": _B_in["v_cache"],
        "B_wq": _B_in["wq"],
        "B_wo": _B_in["wo"],
    }

def reference(A_x, A_k_cache, A_v_cache, A_wq, A_wo, B_x, B_k_cache, B_v_cache, B_wq, B_wo):
    def _A_ref(x, k_cache, v_cache, wq, wo):
        B, Sq, D = x.shape
        H, Dh = 32, 128
        q = (lambda x, *d: x.permute(*d))((x @ wq).reshape(B, Sq, H, Dh), 0, 2, 1, 3)
        scores = torch.einsum("bhqd,bhkd->bhqk", q, k_cache) * (Dh ** -0.5)
        p = _softmax(scores, axis=-1)
        o = torch.einsum("bhqk,bhkd->bhqd", p, v_cache)
        return (lambda x, *d: x.permute(*d))(o, 0, 2, 1, 3).reshape(B, Sq, H * Dh) @ wo

    def _B_ref(x, k_cache, v_cache, wq, wo):
        B, Sq, D = x.shape
        Hq, Dh = 32, 128
        Hkv = k_cache.shape[1]
        rep = Hq // Hkv
        q = (lambda x, *d: x.permute(*d))((x @ wq).reshape(B, Sq, Hq, Dh), 0, 2, 1, 3)
        k = (lambda x, n, axis: torch.repeat_interleave(x, n, dim=axis))(k_cache, rep, axis=1)
        v = (lambda x, n, axis: torch.repeat_interleave(x, n, dim=axis))(v_cache, rep, axis=1)
        scores = torch.einsum("bhqd,bhkd->bhqk", q, k) * (Dh ** -0.5)
        p = _softmax(scores, axis=-1)
        o = torch.einsum("bhqk,bhkd->bhqd", p, v)
        return (lambda x, *d: x.permute(*d))(o, 0, 2, 1, 3).reshape(B, Sq, Hq * Dh) @ wo

    a = _A_ref(A_x, A_k_cache, A_v_cache, A_wq, A_wo)
    b = _B_ref(B_x, B_k_cache, B_v_cache, B_wq, B_wo)
    return torch.concatenate([a, b], axis=-1)
```

```asm
; @launch grid=(256,1,1) block=(512,1,1) lds=163840
.amdgcn_target "amdgcn-amd-amdhsa--gfx950"
.text
.globl concat_heads__mha_block_cached__gqa_block_cached__near_ridge_kernel
.p2align 8
.type concat_heads__mha_block_cached__gqa_block_cached__near_ridge_kernel,@function
concat_heads__mha_block_cached__gqa_block_cached__near_ridge_kernel:
    s_cmp_ge_u32 s2, 256
    s_cbranch_scc1 L_concat_heads__mha_block_cached__gqa_block_cached__near_ridge_kernel_end
    s_load_dwordx8 s[8:15], s[0:1], 0
    s_load_dwordx8 s[16:23], s[0:1], 40
    s_load_dwordx4 s[96:99], s[0:1], 88
    v_lshrrev_b32 v9, 6, v0
    v_and_b32 v11, 63, v0
    v_readfirstlane_b32 s57, v9
    v_and_b32 v10, 3, v9
    v_lshlrev_b32 v184, 4, v11
    v_and_b32 v15, 15, v11
    v_lshrrev_b32 v16, 4, v11
    v_bfe_u32 v17, v11, 2, 2
    v_and_b32 v18, 3, v11
    s_and_b32 s7, s2, 7
    s_lshr_b32 s4, s7, 2
    s_and_b32 s26, s7, 3
    s_lshr_b32 s54, s2, 3
    s_and_b32 s62, s54, 3
    s_lshr_b32 s5, s54, 2
    s_and_b32 s3, s57, 3
    s_lshr_b32 s56, s57, 2
    s_lshl_b32 s6, s26, 2
    s_add_u32 s6, s6, s62
    s_lshl_b32 s6, s6, 1
    s_add_u32 s6, s6, s56
    s_lshl_b32 s27, s4, 3
    s_add_u32 s27, s27, s5
    v_lshrrev_b32 v12, 3, v11
    v_and_b32 v13, 7, v11
    v_and_b32 v14, 1, v9
    v_lshl_add_u32 v14, v14, 2, v16
    v_xor_b32 v14, v14, v13
    v_lshlrev_b32 v14, 4, v14
    v_lshl_add_u32 v180, v12, 10, v14
    v_lshl_add_u32 v180, v9, 13, v180
    v_lshl_add_u32 v12, v10, 3, v12
    v_lshl_add_u32 v174, v12, 8, v14
    v_and_b32 v14, 1, v16
    v_and_b32 v181, 1, v10
    v_lshl_or_b32 v14, v181, 1, v14
    v_lshlrev_b32 v14, 1, v14
    v_xor_b32 v14, v14, v13
    v_lshlrev_b32 v14, 4, v14
    v_lshl_add_u32 v181, v12, 13, v14
    v_lshlrev_b32 v14, 1, v16
    v_xor_b32 v14, v14, v13
    v_lshlrev_b32 v14, 4, v14
    v_lshl_add_u32 v175, v12, 8, v14
    s_lshl_b32 s7, s3, 11
    s_mul_i32 s101, s56, 81920
    s_add_u32 s52, s101, s7
    s_mov_b32 s53, s52
    s_lshl_b32 s51, s57, 10
    s_add_u32 s100, s101, 65536
    s_mul_i32 s28, s5, 212992
    s_lshl_b32 s32, s6, 8
    s_lshl_b32 s36, s5, 5
    s_add_u32 s36, s36, s6
    s_lshl_b32 s36, s36, 17
    s_mov_b32 s30, 212992
    s_mov_b32 s31, 0x20000
    s_sub_u32 s34, 0x400000, s32
    s_mov_b32 s35, 0x20000
    s_mov_b32 s38, 0x20000
    s_mov_b32 s39, 0x20000
    s_mov_b32 s42, 0x20000
    s_mov_b32 s43, 0x20000
    s_cmp_eq_u32 s4, 0
    s_waitcnt lgkmcnt(0)
    s_cselect_b64 s[8:9], s[8:9], s[16:17]
    s_cselect_b64 s[10:11], s[10:11], s[18:19]
    s_cselect_b64 s[12:13], s[12:13], s[20:21]
    s_cselect_b64 s[14:15], s[14:15], s[22:23]
    s_mov_b64 s[24:25], s[98:99]
    s_mov_b32 s16, 0
    s_mov_b32 s20, s96
    s_mov_b32 s21, s97
    s_mov_b32 s22, 256
    s_mov_b32 s23, 0x20000
    s_add_u32 s28, s8, s28
    s_addc_u32 s29, s9, 0
    s_add_u32 s32, s14, s32
    s_addc_u32 s33, s15, 0
    s_add_u32 s40, s12, s36
    s_addc_u32 s41, s13, 0
    s_add_u32 s36, s10, s36
    s_addc_u32 s37, s11, 0
    s_add_u32 s7, s100, 16380
    v_mov_b32 v186, s7
    v_mov_b32 v187, 0
    ds_write_b32 v186, v187
    s_add_u32 m0, s51, 40960
    s_mov_b32 s63, 0
    buffer_load_dwordx4 v180, s[28:31], s63 offen lds
    s_add_u32 m0, s51, 49152
    s_mov_b32 s63, 65536
    buffer_load_dwordx4 v180, s[28:31], s63 offen lds
    s_add_u32 m0, s51, 57344
    s_mov_b32 s63, 131072
    buffer_load_dwordx4 v180, s[28:31], s63 offen lds
    s_add_u32 m0, s51, 65536
    s_mov_b32 s63, 196608
    buffer_load_dwordx4 v180, s[28:31], s63 offen lds
    s_add_u32 m0, s52, 8192
    s_mov_b32 s48, 0
    buffer_load_dwordx4 v181, s[32:35], s48 offen lds
    s_add_u32 m0, s52, 9088
    s_nop 0
    buffer_load_dwordx4 v181, s[32:35], s48 offen offset:128 lds
    s_add_u32 m0, s52, 16384
    s_mov_b32 s48, 262144
    buffer_load_dwordx4 v181, s[32:35], s48 offen lds
    s_add_u32 m0, s52, 17280
    s_nop 0
    buffer_load_dwordx4 v181, s[32:35], s48 offen offset:128 lds
    s_add_u32 m0, s51, 122880
    s_mov_b32 s63, 128
    buffer_load_dwordx4 v180, s[28:31], s63 offen lds
    s_add_u32 m0, s51, 131072
    s_mov_b32 s63, 65664
    buffer_load_dwordx4 v180, s[28:31], s63 offen lds
    s_add_u32 m0, s51, 139264
    s_mov_b32 s63, 131200
    buffer_load_dwordx4 v180, s[28:31], s63 offen lds
    s_add_u32 m0, s51, 147456
    s_mov_b32 s63, 196736
    buffer_load_dwordx4 v180, s[28:31], s63 offen lds
    s_add_u32 s84, s24, 100663296
    s_addc_u32 s85, s25, 0
    s_mov_b32 s86, 65536
    s_mov_b32 s87, 0x20000
    s_lshl_b32 s7, s2, 8
    v_mov_b32 v12, 0
    v_lshlrev_b32 v13, 2, v11
    buffer_store_dword v12, v13, s[84:87], s7 offen sc1
    s_mul_i32 s7, s27, 1703936
    s_lshl_b32 s54, s6, 12
    s_add_u32 s7, s7, s54
    s_add_u32 s44, s24, s7
    s_addc_u32 s45, s25, 0
    s_sub_u32 s46, 1703936, s54
    s_mov_b32 s47, 0x20000
    s_mov_b32 s58, 0x3e0293ee
    s_mov_b32 s59, 0x2b800000
    s_mov_b32 s60, 0x53800000
    s_mul_i32 s61, s3, 393216
    v_add_u32 v185, s100, v184
    v_lshrrev_b32 v12, 3, v15
    v_lshlrev_b32 v12, 10, v12
    v_and_b32 v13, 7, v15
    v_lshl_add_u32 v12, v13, 7, v12
    v_add_u32 v12, 122880, v12
    v_lshrrev_b32 v13, 1, v15
    v_xor_b32 v13, v13, v16
    v_lshl_add_u32 v178, v13, 4, v12
    v_xor_b32 v13, 4, v13
    v_lshl_add_u32 v179, v13, 4, v12
    v_mul_u32_u24 v14, 6144, v10
    v_add_u32 v176, v178, v14
    v_add_u32 v177, v179, v14
    v_lshlrev_b32 v12, 11, v16
    v_lshl_add_u32 v12, v17, 7, v12
    v_lshl_add_u32 v12, v18, 3, v12
    s_add_u32 s7, s101, 8192
    v_add_u32 v12, s7, v12
    v_lshrrev_b32 v13, 1, v17
    v_and_b32 v14, 1, v16
    v_lshl_or_b32 v13, v14, 1, v13
    v_xor_b32 v14, 0, v13
    v_lshl_add_u32 v168, v14, 5, v12
    v_xor_b32 v14, 1, v13
    v_lshl_add_u32 v169, v14, 5, v12
    v_xor_b32 v14, 2, v13
    v_lshl_add_u32 v170, v14, 5, v12
    v_xor_b32 v14, 3, v13
    v_lshl_add_u32 v171, v14, 5, v12
    v_lshrrev_b32 v14, 1, v10
    v_lshl_add_u32 v12, v14, 10, v12
    v_and_b32 v14, 1, v10
    v_lshlrev_b32 v14, 1, v14
    v_xor_b32 v13, v13, v14
    v_lshl_add_u32 v172, v13, 5, v12
    v_xor_b32 v13, 1, v13
    v_lshl_add_u32 v173, v13, 5, v12
    v_subrev_u32 v104, 81920, v176
    v_subrev_u32 v105, 81920, v177
    v_subrev_u32 v106, 81920, v178
    v_subrev_u32 v107, 81920, v179
    s_load_dwordx2 s[8:9], s[0:1], 32
    s_load_dwordx2 s[10:11], s[0:1], 72
    v_lshrrev_b32 v108, 1, v11
    v_lshlrev_b32 v108, 10, v108
    v_and_b32 v109, 1, v11
    v_lshl_add_u32 v108, v109, 7, v108
    s_lshl_b32 s7, s26, 20
    s_lshl_b32 s54, s62, 8
    s_add_u32 s7, s7, s54
    s_and_b32 s54, s5, 3
    s_lshl_b32 s54, s54, 3
    s_add_u32 s54, s54, s57
    s_lshl_b32 s54, s54, 15
    s_add_u32 s7, s7, s54
    s_cmp_eq_u32 s4, 0
    s_waitcnt lgkmcnt(0)
    s_cselect_b64 s[8:9], s[8:9], s[10:11]
    s_add_u32 s92, s8, s7
    s_addc_u32 s93, s9, 0
    s_mov_b32 s94, 32768
    s_mov_b32 s95, 0x20000
    s_waitcnt vmcnt(7)
    s_barrier
    ds_read_b128 a[0:3], v104 offset:0
    ds_read_b64_tr_b16 a[4:5], v168 offset:0
    ds_read_b64_tr_b16 a[6:7], v168 offset:512
    s_waitcnt lgkmcnt(0)
    v_mfma_f32_16x16x32_bf16 v[0:3], a[4:7], a[0:3], 0
    ds_read_b128 a[8:11], v104 offset:2048
    ds_read_b128 a[12:15], v104 offset:4096
    ds_read_b64_tr_b16 a[16:17], v169 offset:0
    ds_read_b64_tr_b16 a[18:19], v169 offset:512
    s_waitcnt lgkmcnt(1)
    v_mfma_f32_16x16x32_bf16 v[32:35], a[4:7], a[8:11], 0
    ds_read_b64_tr_b16 a[20:21], v170 offset:0
    ds_read_b64_tr_b16 a[22:23], v170 offset:512
    ds_read_b64_tr_b16 a[24:25], v171 offset:0
    v_mfma_f32_16x16x32_bf16 v[64:67], a[4:7], a[12:15], 0
    ds_read_b64_tr_b16 a[26:27], v171 offset:512
    ds_read_b64_tr_b16 a[28:29], v168 offset:1024
    ds_read_b64_tr_b16 a[30:31], v168 offset:1536
    s_waitcnt lgkmcnt(4)
    v_mfma_f32_16x16x32_bf16 v[4:7], a[16:19], a[0:3], 0
    ds_read_b64_tr_b16 a[32:33], v169 offset:1024
    ds_read_b64_tr_b16 a[34:35], v169 offset:1536
    ds_read_b64_tr_b16 a[36:37], v170 offset:1024
    v_mfma_f32_16x16x32_bf16 v[36:39], a[16:19], a[8:11], 0
    ds_read_b64_tr_b16 a[38:39], v170 offset:1536
    ds_read_b64_tr_b16 a[40:41], v171 offset:1024
    ds_read_b64_tr_b16 a[42:43], v171 offset:1536
    ds_read_b128 a[44:47], v106 offset:24576
    v_mfma_f32_16x16x32_bf16 v[68:71], a[16:19], a[12:15], 0
    ds_read_b64_tr_b16 a[48:49], v172 offset:0
    ds_read_b64_tr_b16 a[50:51], v172 offset:512
    ds_read_b64_tr_b16 a[52:53], v173 offset:0
    ds_read_b64_tr_b16 a[54:55], v173 offset:512
    v_mfma_f32_16x16x32_bf16 v[8:11], a[20:23], a[0:3], 0
    ds_read_b128 a[56:59], v105 offset:0
    s_add_u32 m0, s52, 24576
    s_mov_b32 s48, 524288
    buffer_load_dwordx4 v181, s[32:35], s48 offen lds
    v_mfma_f32_16x16x32_bf16 v[40:43], a[20:23], a[8:11], 0
    s_add_u32 m0, s52, 25472
    s_nop 0
    buffer_load_dwordx4 v181, s[32:35], s48 offen offset:128 lds
    v_mfma_f32_16x16x32_bf16 v[72:75], a[20:23], a[12:15], 0
    s_waitcnt lgkmcnt(12)
    v_mfma_f32_16x16x32_bf16 v[12:15], a[24:27], a[0:3], 0
    v_mfma_f32_16x16x32_bf16 v[44:47], a[24:27], a[8:11], 0
    v_mfma_f32_16x16x32_bf16 v[76:79], a[24:27], a[12:15], 0
    v_mfma_f32_16x16x32_bf16 v[16:19], a[28:31], a[0:3], 0
    v_mfma_f32_16x16x32_bf16 v[48:51], a[28:31], a[8:11], 0
    v_mfma_f32_16x16x32_bf16 v[80:83], a[28:31], a[12:15], 0
    s_waitcnt lgkmcnt(8)
    v_mfma_f32_16x16x32_bf16 v[20:23], a[32:35], a[0:3], 0
    v_mfma_f32_16x16x32_bf16 v[52:55], a[32:35], a[8:11], 0
    v_mfma_f32_16x16x32_bf16 v[84:87], a[32:35], a[12:15], 0
    s_waitcnt vmcnt(7)
    s_waitcnt lgkmcnt(0)
    s_barrier
    v_mfma_f32_16x16x32_bf16 v[24:27], a[36:39], a[0:3], 0
    ds_read_b64_tr_b16 a[60:61], v168 offset:8192
    ds_read_b64_tr_b16 a[62:63], v168 offset:8704
    ds_read_b128 a[64:67], v105 offset:2048
    ds_read_b128 a[4:7], v105 offset:4096
    v_mfma_f32_16x16x32_bf16 v[56:59], a[36:39], a[8:11], 0
    ds_read_b64_tr_b16 a[16:17], v169 offset:8192
    ds_read_b64_tr_b16 a[18:19], v169 offset:8704
    ds_read_b64_tr_b16 a[20:21], v170 offset:8192
    v_mfma_f32_16x16x32_bf16 v[88:91], a[36:39], a[12:15], 0
    ds_read_b64_tr_b16 a[22:23], v170 offset:8704
    ds_read_b64_tr_b16 a[24:25], v171 offset:8192
    ds_read_b64_tr_b16 a[26:27], v171 offset:8704
    v_mfma_f32_16x16x32_bf16 v[28:31], a[40:43], a[0:3], 0
    ds_read_b64_tr_b16 a[28:29], v168 offset:9216
    ds_read_b64_tr_b16 a[30:31], v168 offset:9728
    ds_read_b64_tr_b16 a[32:33], v169 offset:9216
    v_mfma_f32_16x16x32_bf16 v[60:63], a[40:43], a[8:11], 0
    ds_read_b64_tr_b16 a[34:35], v169 offset:9728
    ds_read_b64_tr_b16 a[36:37], v170 offset:9216
    ds_read_b64_tr_b16 a[38:39], v170 offset:9728
    s_add_u32 m0, s52, 8192
    v_mfma_f32_16x16x32_bf16 v[92:95], a[40:43], a[12:15], 0
    ds_read_b64_tr_b16 a[0:1], v171 offset:9216
    ds_read_b64_tr_b16 a[2:3], v171 offset:9728
    ds_read_b128 a[8:11], v107 offset:24576
    s_mov_b32 s48, 786432
    v_mfma_f32_16x16x32_bf16 v[96:99], a[48:51], a[44:47], 0
    ds_read_b64_tr_b16 a[12:13], v172 offset:8192
    ds_read_b64_tr_b16 a[14:15], v172 offset:8704
    ds_read_b64_tr_b16 a[40:41], v173 offset:8192
    buffer_load_dwordx4 v181, s[32:35], s48 offen lds
    v_mfma_f32_16x16x32_bf16 v[100:103], a[52:55], a[44:47], 0
    ds_read_b64_tr_b16 a[42:43], v173 offset:8704
    s_add_u32 m0, s52, 9088
    s_nop 0
    buffer_load_dwordx4 v181, s[32:35], s48 offen offset:128 lds
    s_waitcnt lgkmcnt(15)
    v_mfma_f32_16x16x32_bf16 v[0:3], a[60:63], a[56:59], v[0:3]
    v_mfma_f32_16x16x32_bf16 v[32:35], a[60:63], a[64:67], v[32:35]
    v_mfma_f32_16x16x32_bf16 v[64:67], a[60:63], a[4:7], v[64:67]
    v_mfma_f32_16x16x32_bf16 v[4:7], a[16:19], a[56:59], v[4:7]
    v_mfma_f32_16x16x32_bf16 v[36:39], a[16:19], a[64:67], v[36:39]
    v_mfma_f32_16x16x32_bf16 v[68:71], a[16:19], a[4:7], v[68:71]
    v_mfma_f32_16x16x32_bf16 v[8:11], a[20:23], a[56:59], v[8:11]
    v_mfma_f32_16x16x32_bf16 v[40:43], a[20:23], a[64:67], v[40:43]
    v_mfma_f32_16x16x32_bf16 v[72:75], a[20:23], a[4:7], v[72:75]
    s_waitcnt lgkmcnt(11)
    v_mfma_f32_16x16x32_bf16 v[12:15], a[24:27], a[56:59], v[12:15]
    v_mfma_f32_16x16x32_bf16 v[44:47], a[24:27], a[64:67], v[44:47]
    v_mfma_f32_16x16x32_bf16 v[76:79], a[24:27], a[4:7], v[76:79]
    v_mfma_f32_16x16x32_bf16 v[16:19], a[28:31], a[56:59], v[16:19]
    v_mfma_f32_16x16x32_bf16 v[48:51], a[28:31], a[64:67], v[48:51]
    v_mfma_f32_16x16x32_bf16 v[80:83], a[28:31], a[4:7], v[80:83]
    s_waitcnt lgkmcnt(7)
    v_mfma_f32_16x16x32_bf16 v[20:23], a[32:35], a[56:59], v[20:23]
    v_mfma_f32_16x16x32_bf16 v[52:55], a[32:35], a[64:67], v[52:55]
    v_mfma_f32_16x16x32_bf16 v[84:87], a[32:35], a[4:7], v[84:87]
    s_waitcnt vmcnt(2)
    s_waitcnt lgkmcnt(0)
    s_barrier
    v_mfma_f32_16x16x32_bf16 v[24:27], a[36:39], a[56:59], v[24:27]
    ds_read_b128 a[48:51], v176 offset:0
    ds_read_b64_tr_b16 a[44:45], v168 offset:16384
    ds_read_b64_tr_b16 a[46:47], v168 offset:16896
    v_mfma_f32_16x16x32_bf16 v[56:59], a[36:39], a[64:67], v[56:59]
    ds_read_b128 a[52:55], v176 offset:2048
    ds_read_b128 a[60:63], v176 offset:4096
    ds_read_b64_tr_b16 a[16:17], v169 offset:16384
    v_mfma_f32_16x16x32_bf16 v[88:91], a[36:39], a[4:7], v[88:91]
    ds_read_b64_tr_b16 a[18:19], v169 offset:16896
    ds_read_b64_tr_b16 a[20:21], v170 offset:16384
    ds_read_b64_tr_b16 a[22:23], v170 offset:16896
    v_mfma_f32_16x16x32_bf16 v[28:31], a[0:3], a[56:59], v[28:31]
    ds_read_b64_tr_b16 a[24:25], v171 offset:16384
    ds_read_b64_tr_b16 a[26:27], v171 offset:16896
    ds_read_b64_tr_b16 a[28:29], v168 offset:17408
    v_mfma_f32_16x16x32_bf16 v[60:63], a[0:3], a[64:67], v[60:63]
    ds_read_b64_tr_b16 a[30:31], v168 offset:17920
    ds_read_b64_tr_b16 a[32:33], v169 offset:17408
    ds_read_b64_tr_b16 a[34:35], v169 offset:17920
    s_add_u32 m0, s52, 16384
    v_mfma_f32_16x16x32_bf16 v[92:95], a[0:3], a[4:7], v[92:95]
    ds_read_b64_tr_b16 a[36:37], v170 offset:17408
    ds_read_b64_tr_b16 a[38:39], v170 offset:17920
    ds_read_b64_tr_b16 a[56:57], v171 offset:17408
    s_mov_b32 s48, 1048576
    v_mfma_f32_16x16x32_bf16 v[96:99], a[12:15], a[8:11], v[96:99]
    ds_read_b64_tr_b16 a[58:59], v171 offset:17920
    ds_read_b128 a[64:67], v178 offset:24576
    ds_read_b64_tr_b16 a[0:1], v172 offset:16384
    buffer_load_dwordx4 v181, s[32:35], s48 offen lds
    v_mfma_f32_16x16x32_bf16 v[100:103], a[40:43], a[8:11], v[100:103]
    ds_read_b64_tr_b16 a[2:3], v172 offset:16896
    ds_read_b64_tr_b16 a[4:5], v173 offset:16384
    ds_read_b64_tr_b16 a[6:7], v173 offset:16896
    s_add_u32 m0, s52, 17280
    s_waitcnt lgkmcnt(15)
    v_mfma_f32_16x16x32_bf16 v[0:3], a[44:47], a[48:51], v[0:3]
    ds_read_b128 a[12:15], v177 offset:0
    buffer_load_dwordx4 v181, s[32:35], s48 offen offset:128 lds
    s_add_u32 m0, s51, 40960
    s_mov_b32 s63, 256
    v_mfma_f32_16x16x32_bf16 v[32:35], a[44:47], a[52:55], v[32:35]
    buffer_load_dwordx4 v180, s[28:31], s63 offen lds
    s_add_u32 m0, s51, 49152
    s_mov_b32 s63, 65792
    buffer_load_dwordx4 v180, s[28:31], s63 offen lds
    v_mfma_f32_16x16x32_bf16 v[64:67], a[44:47], a[60:63], v[64:67]
    s_add_u32 m0, s51, 57344
    s_mov_b32 s63, 131328
    buffer_load_dwordx4 v180, s[28:31], s63 offen lds
    s_add_u32 m0, s51, 65536
    v_mfma_f32_16x16x32_bf16 v[4:7], a[16:19], a[48:51], v[4:7]
    s_mov_b32 s63, 196864
    buffer_load_dwordx4 v180, s[28:31], s63 offen lds
    v_mfma_f32_16x16x32_bf16 v[36:39], a[16:19], a[52:55], v[36:39]
    v_mfma_f32_16x16x32_bf16 v[68:71], a[16:19], a[60:63], v[68:71]
    v_mfma_f32_16x16x32_bf16 v[8:11], a[20:23], a[48:51], v[8:11]
    v_mfma_f32_16x16x32_bf16 v[40:43], a[20:23], a[52:55], v[40:43]
    v_mfma_f32_16x16x32_bf16 v[72:75], a[20:23], a[60:63], v[72:75]
    s_waitcnt lgkmcnt(12)
    v_mfma_f32_16x16x32_bf16 v[12:15], a[24:27], a[48:51], v[12:15]
    v_mfma_f32_16x16x32_bf16 v[44:47], a[24:27], a[52:55], v[44:47]
    v_mfma_f32_16x16x32_bf16 v[76:79], a[24:27], a[60:63], v[76:79]
    v_mfma_f32_16x16x32_bf16 v[16:19], a[28:31], a[48:51], v[16:19]
    v_mfma_f32_16x16x32_bf16 v[48:51], a[28:31], a[52:55], v[48:51]
    v_mfma_f32_16x16x32_bf16 v[80:83], a[28:31], a[60:63], v[80:83]
    s_waitcnt lgkmcnt(8)
    v_mfma_f32_16x16x32_bf16 v[20:23], a[32:35], a[48:51], v[20:23]
    v_mfma_f32_16x16x32_bf16 v[52:55], a[32:35], a[52:55], v[52:55]
    s_mov_b32 s49, 0
    s_add_u32 m0, s53, 32768
    s_nop 0
    buffer_load_dwordx4 v174, s[36:39], s49 offen nt lds
    v_mfma_f32_16x16x32_bf16 v[84:87], a[32:35], a[60:63], v[84:87]
    s_add_u32 m0, s53, 33664
    s_nop 0
    buffer_load_dwordx4 v174, s[36:39], s49 offen offset:128 nt lds
    s_waitcnt vmcnt(8)
    s_waitcnt lgkmcnt(0)
    s_barrier
    v_mfma_f32_16x16x32_bf16 v[24:27], a[36:39], a[48:51], v[24:27]
    ds_read_b64_tr_b16 a[8:9], v168 offset:0
    ds_read_b64_tr_b16 a[10:11], v168 offset:512
    ds_read_b128 a[40:43], v177 offset:2048
    ds_read_b128 a[44:47], v177 offset:4096
    v_mfma_f32_16x16x32_bf16 v[56:59], a[36:39], a[52:55], v[56:59]
    ds_read_b64_tr_b16 a[16:17], v169 offset:0
    ds_read_b64_tr_b16 a[18:19], v169 offset:512
    ds_read_b64_tr_b16 a[20:21], v170 offset:0
    v_mfma_f32_16x16x32_bf16 v[88:91], a[36:39], a[60:63], v[88:91]
    ds_read_b64_tr_b16 a[22:23], v170 offset:512
    ds_read_b64_tr_b16 a[24:25], v171 offset:0
    ds_read_b64_tr_b16 a[26:27], v171 offset:512
    v_mfma_f32_16x16x32_bf16 v[28:31], a[56:59], a[48:51], v[28:31]
    ds_read_b64_tr_b16 a[28:29], v168 offset:1024
    ds_read_b64_tr_b16 a[30:31], v168 offset:1536
    ds_read_b64_tr_b16 a[32:33], v169 offset:1024
    v_mfma_f32_16x16x32_bf16 v[60:63], a[56:59], a[52:55], v[60:63]
    ds_read_b64_tr_b16 a[34:35], v169 offset:1536
    ds_read_b64_tr_b16 a[36:37], v170 offset:1024
    ds_read_b64_tr_b16 a[38:39], v170 offset:1536
    s_add_u32 m0, s52, 24576
    v_mfma_f32_16x16x32_bf16 v[92:95], a[56:59], a[60:63], v[92:95]
    ds_read_b64_tr_b16 a[48:49], v171 offset:1024
    ds_read_b64_tr_b16 a[50:51], v171 offset:1536
    ds_read_b128 a[52:55], v179 offset:24576
    s_mov_b32 s48, 1310720
    v_mfma_f32_16x16x32_bf16 v[96:99], a[0:3], a[64:67], v[96:99]
    ds_read_b64_tr_b16 a[56:57], v172 offset:0
    ds_read_b64_tr_b16 a[58:59], v172 offset:512
    ds_read_b64_tr_b16 a[60:61], v173 offset:0
    buffer_load_dwordx4 v181, s[32:35], s48 offen lds
    v_mfma_f32_16x16x32_bf16 v[100:103], a[4:7], a[64:67], v[100:103]
    ds_read_b64_tr_b16 a[62:63], v173 offset:512
    s_add_u32 m0, s52, 25472
    s_nop 0
    buffer_load_dwordx4 v181, s[32:35], s48 offen offset:128 lds
    s_waitcnt lgkmcnt(15)
    v_mfma_f32_16x16x32_bf16 v[0:3], a[8:11], a[12:15], v[0:3]
    v_mfma_f32_16x16x32_bf16 v[32:35], a[8:11], a[40:43], v[32:35]
    v_mfma_f32_16x16x32_bf16 v[64:67], a[8:11], a[44:47], v[64:67]
    v_mfma_f32_16x16x32_bf16 v[4:7], a[16:19], a[12:15], v[4:7]
    v_mfma_f32_16x16x32_bf16 v[36:39], a[16:19], a[40:43], v[36:39]
    v_mfma_f32_16x16x32_bf16 v[68:71], a[16:19], a[44:47], v[68:71]
    v_mfma_f32_16x16x32_bf16 v[8:11], a[20:23], a[12:15], v[8:11]
    v_mfma_f32_16x16x32_bf16 v[40:43], a[20:23], a[40:43], v[40:43]
    v_mfma_f32_16x16x32_bf16 v[72:75], a[20:23], a[44:47], v[72:75]
    s_waitcnt lgkmcnt(11)
    v_mfma_f32_16x16x32_bf16 v[12:15], a[24:27], a[12:15], v[12:15]
    v_mfma_f32_16x16x32_bf16 v[44:47], a[24:27], a[40:43], v[44:47]
    v_mfma_f32_16x16x32_bf16 v[76:79], a[24:27], a[44:47], v[76:79]
    v_mfma_f32_16x16x32_bf16 v[16:19], a[28:31], a[12:15], v[16:19]
    v_mfma_f32_16x16x32_bf16 v[48:51], a[28:31], a[40:43], v[48:51]
    v_mfma_f32_16x16x32_bf16 v[80:83], a[28:31], a[44:47], v[80:83]
    s_waitcnt lgkmcnt(7)
    v_mfma_f32_16x16x32_bf16 v[20:23], a[32:35], a[12:15], v[20:23]
    v_mfma_f32_16x16x32_bf16 v[52:55], a[32:35], a[40:43], v[52:55]
    v_mfma_f32_16x16x32_bf16 v[84:87], a[32:35], a[44:47], v[84:87]
    s_waitcnt vmcnt(4)
    s_waitcnt lgkmcnt(0)
    s_barrier
    v_mfma_f32_16x16x32_bf16 v[24:27], a[36:39], a[12:15], v[24:27]
    ds_read_b128 a[0:3], v104 offset:0
    ds_read_b64_tr_b16 a[4:5], v168 offset:8192
    ds_read_b64_tr_b16 a[6:7], v168 offset:8704
    v_mfma_f32_16x16x32_bf16 v[56:59], a[36:39], a[40:43], v[56:59]
    ds_read_b128 a[64:67], v104 offset:2048
    ds_read_b128 a[8:11], v104 offset:4096
    ds_read_b64_tr_b16 a[16:17], v169 offset:8192
    v_mfma_f32_16x16x32_bf16 v[88:91], a[36:39], a[44:47], v[88:91]
    ds_read_b64_tr_b16 a[18:19], v169 offset:8704
    ds_read_b64_tr_b16 a[20:21], v170 offset:8192
    ds_read_b64_tr_b16 a[22:23], v170 offset:8704
    v_mfma_f32_16x16x32_bf16 v[28:31], a[48:51], a[12:15], v[28:31]
    ds_read_b64_tr_b16 a[24:25], v171 offset:8192
    ds_read_b64_tr_b16 a[26:27], v171 offset:8704
    ds_read_b64_tr_b16 a[28:29], v168 offset:9216
    v_mfma_f32_16x16x32_bf16 v[60:63], a[48:51], a[40:43], v[60:63]
    ds_read_b64_tr_b16 a[30:31], v168 offset:9728
    ds_read_b64_tr_b16 a[32:33], v169 offset:9216
    ds_read_b64_tr_b16 a[34:35], v169 offset:9728
    s_add_u32 m0, s52, 8192
    v_mfma_f32_16x16x32_bf16 v[92:95], a[48:51], a[44:47], v[92:95]
    ds_read_b64_tr_b16 a[36:37], v170 offset:9216
    ds_read_b64_tr_b16 a[38:39], v170 offset:9728
    ds_read_b64_tr_b16 a[12:13], v171 offset:9216
    s_mov_b32 s48, 1572864
    v_mfma_f32_16x16x32_bf16 v[96:99], a[56:59], a[52:55], v[96:99]
    ds_read_b64_tr_b16 a[14:15], v171 offset:9728
    ds_read_b128 a[40:43], v106 offset:24576
    ds_read_b64_tr_b16 a[44:45], v172 offset:8192
    buffer_load_dwordx4 v181, s[32:35], s48 offen lds
    v_mfma_f32_16x16x32_bf16 v[100:103], a[60:63], a[52:55], v[100:103]
    ds_read_b64_tr_b16 a[46:47], v172 offset:8704
    ds_read_b64_tr_b16 a[48:49], v173 offset:8192
    ds_read_b64_tr_b16 a[50:51], v173 offset:8704
    s_add_u32 m0, s52, 9088
    s_waitcnt lgkmcnt(15)
    v_mfma_f32_16x16x32_bf16 v[0:3], a[4:7], a[0:3], v[0:3]
    ds_read_b128 a[56:59], v105 offset:0
    buffer_load_dwordx4 v181, s[32:35], s48 offen offset:128 lds
    s_add_u32 m0, s51, 122880
    s_mov_b32 s63, 384
    v_mfma_f32_16x16x32_bf16 v[32:35], a[4:7], a[64:67], v[32:35]
    buffer_load_dwordx4 v180, s[28:31], s63 offen lds
    s_add_u32 m0, s51, 131072
    s_mov_b32 s63, 65920
    buffer_load_dwordx4 v180, s[28:31], s63 offen lds
    v_mfma_f32_16x16x32_bf16 v[64:67], a[4:7], a[8:11], v[64:67]
    s_add_u32 m0, s51, 139264
    s_mov_b32 s63, 131456
    buffer_load_dwordx4 v180, s[28:31], s63 offen lds
    s_add_u32 m0, s51, 147456
    v_mfma_f32_16x16x32_bf16 v[4:7], a[16:19], a[0:3], v[4:7]
    s_mov_b32 s63, 196992
    buffer_load_dwordx4 v180, s[28:31], s63 offen lds
    v_mfma_f32_16x16x32_bf16 v[36:39], a[16:19], a[64:67], v[36:39]
    v_mfma_f32_16x16x32_bf16 v[68:71], a[16:19], a[8:11], v[68:71]
    v_mfma_f32_16x16x32_bf16 v[8:11], a[20:23], a[0:3], v[8:11]
    v_mfma_f32_16x16x32_bf16 v[40:43], a[20:23], a[64:67], v[40:43]
    v_mfma_f32_16x16x32_bf16 v[72:75], a[20:23], a[8:11], v[72:75]
    s_waitcnt lgkmcnt(12)
    v_mfma_f32_16x16x32_bf16 v[12:15], a[24:27], a[0:3], v[12:15]
    v_mfma_f32_16x16x32_bf16 v[44:47], a[24:27], a[64:67], v[44:47]
    v_mfma_f32_16x16x32_bf16 v[76:79], a[24:27], a[8:11], v[76:79]
    v_mfma_f32_16x16x32_bf16 v[16:19], a[28:31], a[0:3], v[16:19]
    v_mfma_f32_16x16x32_bf16 v[48:51], a[28:31], a[64:67], v[48:51]
    v_mfma_f32_16x16x32_bf16 v[80:83], a[28:31], a[8:11], v[80:83]
    s_waitcnt lgkmcnt(8)
    v_mfma_f32_16x16x32_bf16 v[20:23], a[32:35], a[0:3], v[20:23]
    v_mfma_f32_16x16x32_bf16 v[52:55], a[32:35], a[64:67], v[52:55]
    s_mov_b32 s49, 0
    s_add_u32 m0, s52, 0
    s_nop 0
    buffer_load_dwordx4 v175, s[40:43], s49 offen nt lds
    v_mfma_f32_16x16x32_bf16 v[84:87], a[32:35], a[8:11], v[84:87]
    s_add_u32 m0, s52, 896
    s_nop 0
    buffer_load_dwordx4 v175, s[40:43], s49 offen offset:128 nt lds
    s_waitcnt vmcnt(8)
    s_waitcnt lgkmcnt(0)
    s_barrier
    v_mfma_f32_16x16x32_bf16 v[24:27], a[36:39], a[0:3], v[24:27]
    ds_read_b64_tr_b16 a[52:53], v168 offset:16384
    ds_read_b64_tr_b16 a[54:55], v168 offset:16896
    ds_read_b128 a[60:63], v105 offset:2048
    ds_read_b128 a[4:7], v105 offset:4096
    v_mfma_f32_16x16x32_bf16 v[56:59], a[36:39], a[64:67], v[56:59]
    ds_read_b64_tr_b16 a[16:17], v169 offset:16384
    ds_read_b64_tr_b16 a[18:19], v169 offset:16896
    ds_read_b64_tr_b16 a[20:21], v170 offset:16384
    v_mfma_f32_16x16x32_bf16 v[88:91], a[36:39], a[8:11], v[88:91]
    ds_read_b64_tr_b16 a[22:23], v170 offset:16896
    ds_read_b64_tr_b16 a[24:25], v171 offset:16384
    ds_read_b64_tr_b16 a[26:27], v171 offset:16896
    v_mfma_f32_16x16x32_bf16 v[28:31], a[12:15], a[0:3], v[28:31]
    ds_read_b64_tr_b16 a[28:29], v168 offset:17408
    ds_read_b64_tr_b16 a[30:31], v168 offset:17920
    ds_read_b64_tr_b16 a[32:33], v169 offset:17408
    v_mfma_f32_16x16x32_bf16 v[60:63], a[12:15], a[64:67], v[60:63]
    ds_read_b64_tr_b16 a[34:35], v169 offset:17920
    ds_read_b64_tr_b16 a[36:37], v170 offset:17408
    ds_read_b64_tr_b16 a[38:39], v170 offset:17920
    s_add_u32 m0, s52, 16384
    v_mfma_f32_16x16x32_bf16 v[92:95], a[12:15], a[8:11], v[92:95]
    ds_read_b64_tr_b16 a[0:1], v171 offset:17408
    ds_read_b64_tr_b16 a[2:3], v171 offset:17920
    ds_read_b128 a[64:67], v107 offset:24576
    s_mov_b32 s48, 1835008
    v_mfma_f32_16x16x32_bf16 v[96:99], a[44:47], a[40:43], v[96:99]
    ds_read_b64_tr_b16 a[8:9], v172 offset:16384
    ds_read_b64_tr_b16 a[10:11], v172 offset:16896
    ds_read_b64_tr_b16 a[12:13], v173 offset:16384
    buffer_load_dwordx4 v181, s[32:35], s48 offen lds
    v_mfma_f32_16x16x32_bf16 v[100:103], a[48:51], a[40:43], v[100:103]
    ds_read_b64_tr_b16 a[14:15], v173 offset:16896
    s_add_u32 m0, s52, 17280
    s_nop 0
    buffer_load_dwordx4 v181, s[32:35], s48 offen offset:128 lds
    s_waitcnt lgkmcnt(15)
    v_mfma_f32_16x16x32_bf16 v[0:3], a[52:55], a[56:59], v[0:3]
    v_mfma_f32_16x16x32_bf16 v[32:35], a[52:55], a[60:63], v[32:35]
    v_mfma_f32_16x16x32_bf16 v[64:67], a[52:55], a[4:7], v[64:67]
    v_mfma_f32_16x16x32_bf16 v[4:7], a[16:19], a[56:59], v[4:7]
    v_mfma_f32_16x16x32_bf16 v[36:39], a[16:19], a[60:63], v[36:39]
    v_mfma_f32_16x16x32_bf16 v[68:71], a[16:19], a[4:7], v[68:71]
    v_mfma_f32_16x16x32_bf16 v[8:11], a[20:23], a[56:59], v[8:11]
    v_mfma_f32_16x16x32_bf16 v[40:43], a[20:23], a[60:63], v[40:43]
    v_mfma_f32_16x16x32_bf16 v[72:75], a[20:23], a[4:7], v[72:75]
    s_waitcnt lgkmcnt(11)
    v_mfma_f32_16x16x32_bf16 v[12:15], a[24:27], a[56:59], v[12:15]
    v_mfma_f32_16x16x32_bf16 v[44:47], a[24:27], a[60:63], v[44:47]
    v_mfma_f32_16x16x32_bf16 v[76:79], a[24:27], a[4:7], v[76:79]
    v_mfma_f32_16x16x32_bf16 v[16:19], a[28:31], a[56:59], v[16:19]
    v_mfma_f32_16x16x32_bf16 v[48:51], a[28:31], a[60:63], v[48:51]
    v_mfma_f32_16x16x32_bf16 v[80:83], a[28:31], a[4:7], v[80:83]
    s_waitcnt lgkmcnt(7)
    v_mfma_f32_16x16x32_bf16 v[20:23], a[32:35], a[56:59], v[20:23]
    v_mfma_f32_16x16x32_bf16 v[52:55], a[32:35], a[60:63], v[52:55]
    v_mfma_f32_16x16x32_bf16 v[84:87], a[32:35], a[4:7], v[84:87]
    s_waitcnt vmcnt(4)
    s_waitcnt lgkmcnt(0)
    s_barrier
    v_mfma_f32_16x16x32_bf16 v[24:27], a[36:39], a[56:59], v[24:27]
    ds_read_b128 a[44:47], v176 offset:0
    ds_read_b64_tr_b16 a[40:41], v168 offset:0
    ds_read_b64_tr_b16 a[42:43], v168 offset:512
    v_mfma_f32_16x16x32_bf16 v[56:59], a[36:39], a[60:63], v[56:59]
    ds_read_b128 a[48:51], v176 offset:2048
    ds_read_b128 a[52:55], v176 offset:4096
    ds_read_b64_tr_b16 a[16:17], v169 offset:0
    v_mfma_f32_16x16x32_bf16 v[88:91], a[36:39], a[4:7], v[88:91]
    ds_read_b64_tr_b16 a[18:19], v169 offset:512
    ds_read_b64_tr_b16 a[20:21], v170 offset:0
    ds_read_b64_tr_b16 a[22:23], v170 offset:512
    v_mfma_f32_16x16x32_bf16 v[28:31], a[0:3], a[56:59], v[28:31]
    ds_read_b64_tr_b16 a[24:25], v171 offset:0
    ds_read_b64_tr_b16 a[26:27], v171 offset:512
    ds_read_b64_tr_b16 a[28:29], v168 offset:1024
    v_mfma_f32_16x16x32_bf16 v[60:63], a[0:3], a[60:63], v[60:63]
    ds_read_b64_tr_b16 a[30:31], v168 offset:1536
    ds_read_b64_tr_b16 a[32:33], v169 offset:1024
    ds_read_b64_tr_b16 a[34:35], v169 offset:1536
    s_add_u32 m0, s52, 24576
    v_mfma_f32_16x16x32_bf16 v[92:95], a[0:3], a[4:7], v[92:95]
    ds_read_b64_tr_b16 a[36:37], v170 offset:1024
    ds_read_b64_tr_b16 a[38:39], v170 offset:1536
    ds_read_b64_tr_b16 a[56:57], v171 offset:1024
    s_mov_b32 s48, 2097152
    v_mfma_f32_16x16x32_bf16 v[96:99], a[8:11], a[64:67], v[96:99]
    ds_read_b64_tr_b16 a[58:59], v171 offset:1536
    ds_read_b128 a[60:63], v178 offset:24576
    ds_read_b64_tr_b16 a[0:1], v172 offset:0
    buffer_load_dwordx4 v181, s[32:35], s48 offen lds
    v_mfma_f32_16x16x32_bf16 v[100:103], a[12:15], a[64:67], v[100:103]
    ds_read_b64_tr_b16 a[2:3], v172 offset:512
    ds_read_b64_tr_b16 a[4:5], v173 offset:0
    ds_read_b64_tr_b16 a[6:7], v173 offset:512
    s_add_u32 m0, s52, 25472
    s_waitcnt lgkmcnt(15)
    v_mfma_f32_16x16x32_bf16 v[0:3], a[40:43], a[44:47], v[0:3]
    ds_read_b128 a[8:11], v177 offset:0
    buffer_load_dwordx4 v181, s[32:35], s48 offen offset:128 lds
    s_add_u32 m0, s51, 40960
    s_mov_b32 s63, 512
    v_mfma_f32_16x16x32_bf16 v[32:35], a[40:43], a[48:51], v[32:35]
    buffer_load_dwordx4 v180, s[28:31], s63 offen lds
    s_add_u32 m0, s51, 49152
    s_mov_b32 s63, 66048
    buffer_load_dwordx4 v180, s[28:31], s63 offen lds
    v_mfma_f32_16x16x32_bf16 v[64:67], a[40:43], a[52:55], v[64:67]
    s_add_u32 m0, s51, 57344
    s_mov_b32 s63, 131584
    buffer_load_dwordx4 v180, s[28:31], s63 offen lds
    s_add_u32 m0, s51, 65536
    v_mfma_f32_16x16x32_bf16 v[4:7], a[16:19], a[44:47], v[4:7]
    s_mov_b32 s63, 197120
    buffer_load_dwordx4 v180, s[28:31], s63 offen lds
    v_mfma_f32_16x16x32_bf16 v[36:39], a[16:19], a[48:51], v[36:39]
    v_mfma_f32_16x16x32_bf16 v[68:71], a[16:19], a[52:55], v[68:71]
    v_mfma_f32_16x16x32_bf16 v[8:11], a[20:23], a[44:47], v[8:11]
    v_mfma_f32_16x16x32_bf16 v[40:43], a[20:23], a[48:51], v[40:43]
    v_mfma_f32_16x16x32_bf16 v[72:75], a[20:23], a[52:55], v[72:75]
    s_waitcnt lgkmcnt(12)
    v_mfma_f32_16x16x32_bf16 v[12:15], a[24:27], a[44:47], v[12:15]
    v_mfma_f32_16x16x32_bf16 v[44:47], a[24:27], a[48:51], v[44:47]
    v_mfma_f32_16x16x32_bf16 v[76:79], a[24:27], a[52:55], v[76:79]
    v_mfma_f32_16x16x32_bf16 v[16:19], a[28:31], a[44:47], v[16:19]
    v_mfma_f32_16x16x32_bf16 v[48:51], a[28:31], a[48:51], v[48:51]
    v_mfma_f32_16x16x32_bf16 v[80:83], a[28:31], a[52:55], v[80:83]
    s_waitcnt lgkmcnt(8)
    v_mfma_f32_16x16x32_bf16 v[20:23], a[32:35], a[44:47], v[20:23]
    v_mfma_f32_16x16x32_bf16 v[52:55], a[32:35], a[48:51], v[52:55]
    v_mfma_f32_16x16x32_bf16 v[84:87], a[32:35], a[52:55], v[84:87]
    s_waitcnt vmcnt(6)
    s_waitcnt lgkmcnt(0)
    s_barrier
    v_mfma_f32_16x16x32_bf16 v[24:27], a[36:39], a[44:47], v[24:27]
    ds_read_b64_tr_b16 a[12:13], v168 offset:8192
    ds_read_b64_tr_b16 a[14:15], v168 offset:8704
    ds_read_b128 a[64:67], v177 offset:2048
    ds_read_b128 a[40:43], v177 offset:4096
    v_mfma_f32_16x16x32_bf16 v[56:59], a[36:39], a[48:51], v[56:59]
    ds_read_b64_tr_b16 a[16:17], v169 offset:8192
    ds_read_b64_tr_b16 a[18:19], v169 offset:8704
    ds_read_b64_tr_b16 a[20:21], v170 offset:8192
    v_mfma_f32_16x16x32_bf16 v[88:91], a[36:39], a[52:55], v[88:91]
    ds_read_b64_tr_b16 a[22:23], v170 offset:8704
    ds_read_b64_tr_b16 a[24:25], v171 offset:8192
    ds_read_b64_tr_b16 a[26:27], v171 offset:8704
    v_mfma_f32_16x16x32_bf16 v[28:31], a[56:59], a[44:47], v[28:31]
    ds_read_b64_tr_b16 a[28:29], v168 offset:9216
    ds_read_b64_tr_b16 a[30:31], v168 offset:9728
    ds_read_b64_tr_b16 a[32:33], v169 offset:9216
    v_mfma_f32_16x16x32_bf16 v[60:63], a[56:59], a[48:51], v[60:63]
    ds_read_b64_tr_b16 a[34:35], v169 offset:9728
    ds_read_b64_tr_b16 a[36:37], v170 offset:9216
    ds_read_b64_tr_b16 a[38:39], v170 offset:9728
    s_add_u32 m0, s52, 8192
    v_mfma_f32_16x16x32_bf16 v[92:95], a[56:59], a[52:55], v[92:95]
    ds_read_b64_tr_b16 a[44:45], v171 offset:9216
    ds_read_b64_tr_b16 a[46:47], v171 offset:9728
    ds_read_b128 a[48:51], v179 offset:24576
    s_mov_b32 s48, 2359296
    v_mfma_f32_16x16x32_bf16 v[96:99], a[0:3], a[60:63], v[96:99]
    ds_read_b64_tr_b16 a[52:53], v172 offset:8192
    ds_read_b64_tr_b16 a[54:55], v172 offset:8704
    ds_read_b64_tr_b16 a[56:57], v173 offset:8192
    buffer_load_dwordx4 v181, s[32:35], s48 offen lds
    v_mfma_f32_16x16x32_bf16 v[100:103], a[4:7], a[60:63], v[100:103]
    ds_read_b64_tr_b16 a[58:59], v173 offset:8704
    s_add_u32 m0, s52, 9088
    s_nop 0
    buffer_load_dwordx4 v181, s[32:35], s48 offen offset:128 lds
    s_waitcnt lgkmcnt(15)
    v_mfma_f32_16x16x32_bf16 v[0:3], a[12:15], a[8:11], v[0:3]
    v_mfma_f32_16x16x32_bf16 v[32:35], a[12:15], a[64:67], v[32:35]
    v_mfma_f32_16x16x32_bf16 v[64:67], a[12:15], a[40:43], v[64:67]
    v_mfma_f32_16x16x32_bf16 v[4:7], a[16:19], a[8:11], v[4:7]
    v_mfma_f32_16x16x32_bf16 v[36:39], a[16:19], a[64:67], v[36:39]
    v_mfma_f32_16x16x32_bf16 v[68:71], a[16:19], a[40:43], v[68:71]
    v_mfma_f32_16x16x32_bf16 v[8:11], a[20:23], a[8:11], v[8:11]
    v_mfma_f32_16x16x32_bf16 v[40:43], a[20:23], a[64:67], v[40:43]
    v_mfma_f32_16x16x32_bf16 v[72:75], a[20:23], a[40:43], v[72:75]
    s_waitcnt lgkmcnt(11)
    v_mfma_f32_16x16x32_bf16 v[12:15], a[24:27], a[8:11], v[12:15]
    v_mfma_f32_16x16x32_bf16 v[44:47], a[24:27], a[64:67], v[44:47]
    v_mfma_f32_16x16x32_bf16 v[76:79], a[24:27], a[40:43], v[76:79]
    v_mfma_f32_16x16x32_bf16 v[16:19], a[28:31], a[8:11], v[16:19]
    v_mfma_f32_16x16x32_bf16 v[48:51], a[28:31], a[64:67], v[48:51]
    v_mfma_f32_16x16x32_bf16 v[80:83], a[28:31], a[40:43], v[80:83]
    s_waitcnt lgkmcnt(7)
    v_mfma_f32_16x16x32_bf16 v[20:23], a[32:35], a[8:11], v[20:23]
    v_mfma_f32_16x16x32_bf16 v[52:55], a[32:35], a[64:67], v[52:55]
    v_mfma_f32_16x16x32_bf16 v[84:87], a[32:35], a[40:43], v[84:87]
    s_waitcnt vmcnt(2)
    s_waitcnt lgkmcnt(0)
    s_barrier
    v_mfma_f32_16x16x32_bf16 v[24:27], a[36:39], a[8:11], v[24:27]
    ds_read_b128 a[0:3], v104 offset:0
    ds_read_b64_tr_b16 a[4:5], v168 offset:16384
    ds_read_b64_tr_b16 a[6:7], v168 offset:16896
    v_mfma_f32_16x16x32_bf16 v[56:59], a[36:39], a[64:67], v[56:59]
    ds_read_b128 a[60:63], v104 offset:2048
    ds_read_b128 a[12:15], v104 offset:4096
    ds_read_b64_tr_b16 a[16:17], v169 offset:16384
    v_mfma_f32_16x16x32_bf16 v[88:91], a[36:39], a[40:43], v[88:91]
    ds_read_b64_tr_b16 a[18:19], v169 offset:16896
    ds_read_b64_tr_b16 a[20:21], v170 offset:16384
    ds_read_b64_tr_b16 a[22:23], v170 offset:16896
    v_mfma_f32_16x16x32_bf16 v[28:31], a[44:47], a[8:11], v[28:31]
    ds_read_b64_tr_b16 a[24:25], v171 offset:16384
    ds_read_b64_tr_b16 a[26:27], v171 offset:16896
    ds_read_b64_tr_b16 a[28:29], v168 offset:17408
    v_mfma_f32_16x16x32_bf16 v[60:63], a[44:47], a[64:67], v[60:63]
    ds_read_b64_tr_b16 a[30:31], v168 offset:17920
    ds_read_b64_tr_b16 a[32:33], v169 offset:17408
    ds_read_b64_tr_b16 a[34:35], v169 offset:17920
    s_add_u32 m0, s52, 16384
    v_mfma_f32_16x16x32_bf16 v[92:95], a[44:47], a[40:43], v[92:95]
    ds_read_b64_tr_b16 a[36:37], v170 offset:17408
    ds_read_b64_tr_b16 a[38:39], v170 offset:17920
    ds_read_b64_tr_b16 a[8:9], v171 offset:17408
    s_mov_b32 s48, 2621440
    v_mfma_f32_16x16x32_bf16 v[96:99], a[52:55], a[48:51], v[96:99]
    ds_read_b64_tr_b16 a[10:11], v171 offset:17920
    ds_read_b128 a[64:67], v106 offset:24576
    ds_read_b64_tr_b16 a[40:41], v172 offset:16384
    buffer_load_dwordx4 v181, s[32:35], s48 offen lds
    v_mfma_f32_16x16x32_bf16 v[100:103], a[56:59], a[48:51], v[100:103]
    ds_read_b64_tr_b16 a[42:43], v172 offset:16896
    ds_read_b64_tr_b16 a[44:45], v173 offset:16384
    ds_read_b64_tr_b16 a[46:47], v173 offset:16896
    s_add_u32 m0, s52, 17280
    s_waitcnt lgkmcnt(15)
    v_mfma_f32_16x16x32_bf16 v[0:3], a[4:7], a[0:3], v[0:3]
    ds_read_b128 a[52:55], v105 offset:0
    buffer_load_dwordx4 v181, s[32:35], s48 offen offset:128 lds
    s_add_u32 m0, s51, 122880
    s_mov_b32 s63, 640
    v_mfma_f32_16x16x32_bf16 v[32:35], a[4:7], a[60:63], v[32:35]
    buffer_load_dwordx4 v180, s[28:31], s63 offen lds
    s_add_u32 m0, s51, 131072
    s_mov_b32 s63, 66176
    buffer_load_dwordx4 v180, s[28:31], s63 offen lds
    v_mfma_f32_16x16x32_bf16 v[64:67], a[4:7], a[12:15], v[64:67]
    s_add_u32 m0, s51, 139264
    s_mov_b32 s63, 131712
    buffer_load_dwordx4 v180, s[28:31], s63 offen lds
    s_add_u32 m0, s51, 147456
    v_mfma_f32_16x16x32_bf16 v[4:7], a[16:19], a[0:3], v[4:7]
    s_mov_b32 s63, 197248
    buffer_load_dwordx4 v180, s[28:31], s63 offen lds
    v_mfma_f32_16x16x32_bf16 v[36:39], a[16:19], a[60:63], v[36:39]
    v_mfma_f32_16x16x32_bf16 v[68:71], a[16:19], a[12:15], v[68:71]
    v_mfma_f32_16x16x32_bf16 v[8:11], a[20:23], a[0:3], v[8:11]
    v_mfma_f32_16x16x32_bf16 v[40:43], a[20:23], a[60:63], v[40:43]
    v_mfma_f32_16x16x32_bf16 v[72:75], a[20:23], a[12:15], v[72:75]
    s_waitcnt lgkmcnt(12)
    v_mfma_f32_16x16x32_bf16 v[12:15], a[24:27], a[0:3], v[12:15]
    v_mfma_f32_16x16x32_bf16 v[44:47], a[24:27], a[60:63], v[44:47]
    v_mfma_f32_16x16x32_bf16 v[76:79], a[24:27], a[12:15], v[76:79]
    v_mfma_f32_16x16x32_bf16 v[16:19], a[28:31], a[0:3], v[16:19]
    v_mfma_f32_16x16x32_bf16 v[48:51], a[28:31], a[60:63], v[48:51]
    v_mfma_f32_16x16x32_bf16 v[80:83], a[28:31], a[12:15], v[80:83]
    s_waitcnt lgkmcnt(8)
    v_mfma_f32_16x16x32_bf16 v[20:23], a[32:35], a[0:3], v[20:23]
    v_mfma_f32_16x16x32_bf16 v[52:55], a[32:35], a[60:63], v[52:55]
    v_mfma_f32_16x16x32_bf16 v[84:87], a[32:35], a[12:15], v[84:87]
    s_waitcnt vmcnt(6)
    s_waitcnt lgkmcnt(0)
    s_barrier
    v_mfma_f32_16x16x32_bf16 v[24:27], a[36:39], a[0:3], v[24:27]
    ds_read_b64_tr_b16 a[48:49], v168 offset:0
    ds_read_b64_tr_b16 a[50:51], v168 offset:512
    ds_read_b128 a[56:59], v105 offset:2048
    ds_read_b128 a[4:7], v105 offset:4096
    v_mfma_f32_16x16x32_bf16 v[56:59], a[36:39], a[60:63], v[56:59]
    ds_read_b64_tr_b16 a[16:17], v169 offset:0
    ds_read_b64_tr_b16 a[18:19], v169 offset:512
    ds_read_b64_tr_b16 a[20:21], v170 offset:0
    v_mfma_f32_16x16x32_bf16 v[88:91], a[36:39], a[12:15], v[88:91]
    ds_read_b64_tr_b16 a[22:23], v170 offset:512
    ds_read_b64_tr_b16 a[24:25], v171 offset:0
    ds_read_b64_tr_b16 a[26:27], v171 offset:512
    v_mfma_f32_16x16x32_bf16 v[28:31], a[8:11], a[0:3], v[28:31]
    ds_read_b64_tr_b16 a[28:29], v168 offset:1024
    ds_read_b64_tr_b16 a[30:31], v168 offset:1536
    ds_read_b64_tr_b16 a[32:33], v169 offset:1024
    v_mfma_f32_16x16x32_bf16 v[60:63], a[8:11], a[60:63], v[60:63]
    ds_read_b64_tr_b16 a[34:35], v169 offset:1536
    ds_read_b64_tr_b16 a[36:37], v170 offset:1024
    ds_read_b64_tr_b16 a[38:39], v170 offset:1536
    s_add_u32 m0, s52, 24576
    v_mfma_f32_16x16x32_bf16 v[92:95], a[8:11], a[12:15], v[92:95]
    ds_read_b64_tr_b16 a[0:1], v171 offset:1024
    ds_read_b64_tr_b16 a[2:3], v171 offset:1536
    ds_read_b128 a[60:63], v107 offset:24576
    s_mov_b32 s48, 2883584
    v_mfma_f32_16x16x32_bf16 v[96:99], a[40:43], a[64:67], v[96:99]
    ds_read_b64_tr_b16 a[8:9], v172 offset:0
    ds_read_b64_tr_b16 a[10:11], v172 offset:512
    ds_read_b64_tr_b16 a[12:13], v173 offset:0
    buffer_load_dwordx4 v181, s[32:35], s48 offen lds
    v_mfma_f32_16x16x32_bf16 v[100:103], a[44:47], a[64:67], v[100:103]
    ds_read_b64_tr_b16 a[14:15], v173 offset:512
    s_add_u32 m0, s52, 25472
    s_nop 0
    buffer_load_dwordx4 v181, s[32:35], s48 offen offset:128 lds
    s_waitcnt lgkmcnt(15)
    v_mfma_f32_16x16x32_bf16 v[0:3], a[48:51], a[52:55], v[0:3]
    v_mfma_f32_16x16x32_bf16 v[32:35], a[48:51], a[56:59], v[32:35]
    v_mfma_f32_16x16x32_bf16 v[64:67], a[48:51], a[4:7], v[64:67]
    v_mfma_f32_16x16x32_bf16 v[4:7], a[16:19], a[52:55], v[4:7]
    v_mfma_f32_16x16x32_bf16 v[36:39], a[16:19], a[56:59], v[36:39]
    v_mfma_f32_16x16x32_bf16 v[68:71], a[16:19], a[4:7], v[68:71]
    v_mfma_f32_16x16x32_bf16 v[8:11], a[20:23], a[52:55], v[8:11]
    v_mfma_f32_16x16x32_bf16 v[40:43], a[20:23], a[56:59], v[40:43]
    v_mfma_f32_16x16x32_bf16 v[72:75], a[20:23], a[4:7], v[72:75]
    s_waitcnt lgkmcnt(11)
    v_mfma_f32_16x16x32_bf16 v[12:15], a[24:27], a[52:55], v[12:15]
    v_mfma_f32_16x16x32_bf16 v[44:47], a[24:27], a[56:59], v[44:47]
    v_mfma_f32_16x16x32_bf16 v[76:79], a[24:27], a[4:7], v[76:79]
    v_mfma_f32_16x16x32_bf16 v[16:19], a[28:31], a[52:55], v[16:19]
    v_mfma_f32_16x16x32_bf16 v[48:51], a[28:31], a[56:59], v[48:51]
    v_mfma_f32_16x16x32_bf16 v[80:83], a[28:31], a[4:7], v[80:83]
    s_waitcnt lgkmcnt(7)
    v_mfma_f32_16x16x32_bf16 v[20:23], a[32:35], a[52:55], v[20:23]
    v_mfma_f32_16x16x32_bf16 v[52:55], a[32:35], a[56:59], v[52:55]
    v_mfma_f32_16x16x32_bf16 v[84:87], a[32:35], a[4:7], v[84:87]
    s_waitcnt vmcnt(2)
    s_waitcnt lgkmcnt(0)
    s_barrier
    v_mfma_f32_16x16x32_bf16 v[24:27], a[36:39], a[52:55], v[24:27]
    ds_read_b128 a[40:43], v176 offset:0
    ds_read_b64_tr_b16 a[44:45], v168 offset:8192
    ds_read_b64_tr_b16 a[46:47], v168 offset:8704
    v_mfma_f32_16x16x32_bf16 v[56:59], a[36:39], a[56:59], v[56:59]
    ds_read_b128 a[64:67], v176 offset:2048
    ds_read_b128 a[48:51], v176 offset:4096
    ds_read_b64_tr_b16 a[16:17], v169 offset:8192
    v_mfma_f32_16x16x32_bf16 v[88:91], a[36:39], a[4:7], v[88:91]
    ds_read_b64_tr_b16 a[18:19], v169 offset:8704
    ds_read_b64_tr_b16 a[20:21], v170 offset:8192
    ds_read_b64_tr_b16 a[22:23], v170 offset:8704
    v_mfma_f32_16x16x32_bf16 v[28:31], a[0:3], a[52:55], v[28:31]
    ds_read_b64_tr_b16 a[24:25], v171 offset:8192
    ds_read_b64_tr_b16 a[26:27], v171 offset:8704
    ds_read_b64_tr_b16 a[28:29], v168 offset:9216
    v_mfma_f32_16x16x32_bf16 v[60:63], a[0:3], a[56:59], v[60:63]
    ds_read_b64_tr_b16 a[30:31], v168 offset:9728
    ds_read_b64_tr_b16 a[32:33], v169 offset:9216
    ds_read_b64_tr_b16 a[34:35], v169 offset:9728
    s_add_u32 m0, s52, 8192
    v_mfma_f32_16x16x32_bf16 v[92:95], a[0:3], a[4:7], v[92:95]
    ds_read_b64_tr_b16 a[36:37], v170 offset:9216
    ds_read_b64_tr_b16 a[38:39], v170 offset:9728
    ds_read_b64_tr_b16 a[52:53], v171 offset:9216
    s_mov_b32 s48, 3145728
    v_mfma_f32_16x16x32_bf16 v[96:99], a[8:11], a[60:63], v[96:99]
    ds_read_b64_tr_b16 a[54:55], v171 offset:9728
    ds_read_b128 a[56:59], v178 offset:24576
    ds_read_b64_tr_b16 a[0:1], v172 offset:8192
    buffer_load_dwordx4 v181, s[32:35], s48 offen lds
    v_mfma_f32_16x16x32_bf16 v[100:103], a[12:15], a[60:63], v[100:103]
    ds_read_b64_tr_b16 a[2:3], v172 offset:8704
    ds_read_b64_tr_b16 a[4:5], v173 offset:8192
    ds_read_b64_tr_b16 a[6:7], v173 offset:8704
    s_add_u32 m0, s52, 9088
    s_waitcnt lgkmcnt(15)
    v_mfma_f32_16x16x32_bf16 v[0:3], a[44:47], a[40:43], v[0:3]
    ds_read_b128 a[8:11], v177 offset:0
    buffer_load_dwordx4 v181, s[32:35], s48 offen offset:128 lds
    s_add_u32 m0, s51, 40960
    s_mov_b32 s63, 768
    v_mfma_f32_16x16x32_bf16 v[32:35], a[44:47], a[64:67], v[32:35]
    buffer_load_dwordx4 v180, s[28:31], s63 offen lds
    s_add_u32 m0, s51, 49152
    s_mov_b32 s63, 66304
    buffer_load_dwordx4 v180, s[28:31], s63 offen lds
    v_mfma_f32_16x16x32_bf16 v[64:67], a[44:47], a[48:51], v[64:67]
    s_add_u32 m0, s51, 57344
    s_mov_b32 s63, 131840
    buffer_load_dwordx4 v180, s[28:31], s63 offen lds
    s_add_u32 m0, s51, 65536
    v_mfma_f32_16x16x32_bf16 v[4:7], a[16:19], a[40:43], v[4:7]
    s_mov_b32 s63, 197376
    buffer_load_dwordx4 v180, s[28:31], s63 offen lds
    v_mfma_f32_16x16x32_bf16 v[36:39], a[16:19], a[64:67], v[36:39]
    v_mfma_f32_16x16x32_bf16 v[68:71], a[16:19], a[48:51], v[68:71]
    v_mfma_f32_16x16x32_bf16 v[8:11], a[20:23], a[40:43], v[8:11]
    v_mfma_f32_16x16x32_bf16 v[40:43], a[20:23], a[64:67], v[40:43]
    v_mfma_f32_16x16x32_bf16 v[72:75], a[20:23], a[48:51], v[72:75]
    s_waitcnt lgkmcnt(12)
    v_mfma_f32_16x16x32_bf16 v[12:15], a[24:27], a[40:43], v[12:15]
    v_mfma_f32_16x16x32_bf16 v[44:47], a[24:27], a[64:67], v[44:47]
    v_mfma_f32_16x16x32_bf16 v[76:79], a[24:27], a[48:51], v[76:79]
    v_mfma_f32_16x16x32_bf16 v[16:19], a[28:31], a[40:43], v[16:19]
    v_mfma_f32_16x16x32_bf16 v[48:51], a[28:31], a[64:67], v[48:51]
    v_mfma_f32_16x16x32_bf16 v[80:83], a[28:31], a[48:51], v[80:83]
    s_waitcnt lgkmcnt(8)
    v_mfma_f32_16x16x32_bf16 v[20:23], a[32:35], a[40:43], v[20:23]
    v_mfma_f32_16x16x32_bf16 v[52:55], a[32:35], a[64:67], v[52:55]
    v_mfma_f32_16x16x32_bf16 v[84:87], a[32:35], a[48:51], v[84:87]
    s_waitcnt vmcnt(6)
    s_waitcnt lgkmcnt(0)
    s_barrier
    v_mfma_f32_16x16x32_bf16 v[24:27], a[36:39], a[40:43], v[24:27]
    ds_read_b64_tr_b16 a[12:13], v168 offset:16384
    ds_read_b64_tr_b16 a[14:15], v168 offset:16896
    ds_read_b128 a[60:63], v177 offset:2048
    ds_read_b128 a[44:47], v177 offset:4096
    v_mfma_f32_16x16x32_bf16 v[56:59], a[36:39], a[64:67], v[56:59]
    ds_read_b64_tr_b16 a[16:17], v169 offset:16384
    ds_read_b64_tr_b16 a[18:19], v169 offset:16896
    ds_read_b64_tr_b16 a[20:21], v170 offset:16384
    v_mfma_f32_16x16x32_bf16 v[88:91], a[36:39], a[48:51], v[88:91]
    ds_read_b64_tr_b16 a[22:23], v170 offset:16896
    ds_read_b64_tr_b16 a[24:25], v171 offset:16384
    ds_read_b64_tr_b16 a[26:27], v171 offset:16896
    v_mfma_f32_16x16x32_bf16 v[28:31], a[52:55], a[40:43], v[28:31]
    ds_read_b64_tr_b16 a[28:29], v168 offset:17408
    ds_read_b64_tr_b16 a[30:31], v168 offset:17920
    ds_read_b64_tr_b16 a[32:33], v169 offset:17408
    v_mfma_f32_16x16x32_bf16 v[60:63], a[52:55], a[64:67], v[60:63]
    ds_read_b64_tr_b16 a[34:35], v169 offset:17920
    ds_read_b64_tr_b16 a[36:37], v170 offset:17408
    ds_read_b64_tr_b16 a[38:39], v170 offset:17920
    s_add_u32 m0, s52, 16384
    v_mfma_f32_16x16x32_bf16 v[92:95], a[52:55], a[48:51], v[92:95]
    ds_read_b64_tr_b16 a[40:41], v171 offset:17408
    ds_read_b64_tr_b16 a[42:43], v171 offset:17920
    ds_read_b128 a[64:67], v179 offset:24576
    s_mov_b32 s48, 3407872
    v_mfma_f32_16x16x32_bf16 v[96:99], a[0:3], a[56:59], v[96:99]
    ds_read_b64_tr_b16 a[48:49], v172 offset:16384
    ds_read_b64_tr_b16 a[50:51], v172 offset:16896
    ds_read_b64_tr_b16 a[52:53], v173 offset:16384
    buffer_load_dwordx4 v181, s[32:35], s48 offen lds
    v_mfma_f32_16x16x32_bf16 v[100:103], a[4:7], a[56:59], v[100:103]
    ds_read_b64_tr_b16 a[54:55], v173 offset:16896
    s_add_u32 m0, s52, 17280
    s_nop 0
    buffer_load_dwordx4 v181, s[32:35], s48 offen offset:128 lds
    s_waitcnt lgkmcnt(15)
    v_mfma_f32_16x16x32_bf16 v[0:3], a[12:15], a[8:11], v[0:3]
    v_mfma_f32_16x16x32_bf16 v[32:35], a[12:15], a[60:63], v[32:35]
    v_mfma_f32_16x16x32_bf16 v[64:67], a[12:15], a[44:47], v[64:67]
    v_mfma_f32_16x16x32_bf16 v[4:7], a[16:19], a[8:11], v[4:7]
    v_mfma_f32_16x16x32_bf16 v[36:39], a[16:19], a[60:63], v[36:39]
    v_mfma_f32_16x16x32_bf16 v[68:71], a[16:19], a[44:47], v[68:71]
    v_mfma_f32_16x16x32_bf16 v[8:11], a[20:23], a[8:11], v[8:11]
    v_mfma_f32_16x16x32_bf16 v[40:43], a[20:23], a[60:63], v[40:43]
    v_mfma_f32_16x16x32_bf16 v[72:75], a[20:23], a[44:47], v[72:75]
    s_waitcnt lgkmcnt(11)
    v_mfma_f32_16x16x32_bf16 v[12:15], a[24:27], a[8:11], v[12:15]
    v_mfma_f32_16x16x32_bf16 v[44:47], a[24:27], a[60:63], v[44:47]
    v_mfma_f32_16x16x32_bf16 v[76:79], a[24:27], a[44:47], v[76:79]
    v_mfma_f32_16x16x32_bf16 v[16:19], a[28:31], a[8:11], v[16:19]
    v_mfma_f32_16x16x32_bf16 v[48:51], a[28:31], a[60:63], v[48:51]
    v_mfma_f32_16x16x32_bf16 v[80:83], a[28:31], a[44:47], v[80:83]
    s_waitcnt lgkmcnt(7)
    v_mfma_f32_16x16x32_bf16 v[20:23], a[32:35], a[8:11], v[20:23]
    v_mfma_f32_16x16x32_bf16 v[52:55], a[32:35], a[60:63], v[52:55]
    v_mfma_f32_16x16x32_bf16 v[84:87], a[32:35], a[44:47], v[84:87]
    s_waitcnt vmcnt(2)
    s_waitcnt lgkmcnt(0)
    s_barrier
    v_mfma_f32_16x16x32_bf16 v[24:27], a[36:39], a[8:11], v[24:27]
    ds_read_b128 a[0:3], v104 offset:0
    ds_read_b64_tr_b16 a[4:5], v168 offset:0
    ds_read_b64_tr_b16 a[6:7], v168 offset:512
    v_mfma_f32_16x16x32_bf16 v[56:59], a[36:39], a[60:63], v[56:59]
    ds_read_b128 a[56:59], v104 offset:2048
    ds_read_b128 a[12:15], v104 offset:4096
    ds_read_b64_tr_b16 a[16:17], v169 offset:0
    v_mfma_f32_16x16x32_bf16 v[88:91], a[36:39], a[44:47], v[88:91]
    ds_read_b64_tr_b16 a[18:19], v169 offset:512
    ds_read_b64_tr_b16 a[20:21], v170 offset:0
    ds_read_b64_tr_b16 a[22:23], v170 offset:512
    v_mfma_f32_16x16x32_bf16 v[28:31], a[40:43], a[8:11], v[28:31]
    ds_read_b64_tr_b16 a[24:25], v171 offset:0
    ds_read_b64_tr_b16 a[26:27], v171 offset:512
    ds_read_b64_tr_b16 a[28:29], v168 offset:1024
    v_mfma_f32_16x16x32_bf16 v[60:63], a[40:43], a[60:63], v[60:63]
    ds_read_b64_tr_b16 a[30:31], v168 offset:1536
    ds_read_b64_tr_b16 a[32:33], v169 offset:1024
    ds_read_b64_tr_b16 a[34:35], v169 offset:1536
    s_add_u32 m0, s52, 24576
    v_mfma_f32_16x16x32_bf16 v[92:95], a[40:43], a[44:47], v[92:95]
    ds_read_b64_tr_b16 a[36:37], v170 offset:1024
    ds_read_b64_tr_b16 a[38:39], v170 offset:1536
    ds_read_b64_tr_b16 a[8:9], v171 offset:1024
    s_mov_b32 s48, 3670016
    v_mfma_f32_16x16x32_bf16 v[96:99], a[48:51], a[64:67], v[96:99]
    ds_read_b64_tr_b16 a[10:11], v171 offset:1536
    ds_read_b128 a[60:63], v106 offset:24576
    ds_read_b64_tr_b16 a[40:41], v172 offset:0
    buffer_load_dwordx4 v181, s[32:35], s48 offen lds
    v_mfma_f32_16x16x32_bf16 v[100:103], a[52:55], a[64:67], v[100:103]
    ds_read_b64_tr_b16 a[42:43], v172 offset:512
    ds_read_b64_tr_b16 a[44:45], v173 offset:0
    ds_read_b64_tr_b16 a[46:47], v173 offset:512
    s_add_u32 m0, s52, 25472
    s_waitcnt lgkmcnt(15)
    v_mfma_f32_16x16x32_bf16 v[0:3], a[4:7], a[0:3], v[0:3]
    ds_read_b128 a[48:51], v105 offset:0
    buffer_load_dwordx4 v181, s[32:35], s48 offen offset:128 lds
    s_add_u32 m0, s51, 122880
    s_mov_b32 s63, 896
    v_mfma_f32_16x16x32_bf16 v[32:35], a[4:7], a[56:59], v[32:35]
    buffer_load_dwordx4 v180, s[28:31], s63 offen lds
    s_add_u32 m0, s51, 131072
    s_mov_b32 s63, 66432
    buffer_load_dwordx4 v180, s[28:31], s63 offen lds
    v_mfma_f32_16x16x32_bf16 v[64:67], a[4:7], a[12:15], v[64:67]
    s_add_u32 m0, s51, 139264
    s_mov_b32 s63, 131968
    buffer_load_dwordx4 v180, s[28:31], s63 offen lds
    s_add_u32 m0, s51, 147456
    v_mfma_f32_16x16x32_bf16 v[4:7], a[16:19], a[0:3], v[4:7]
    s_mov_b32 s63, 197504
    buffer_load_dwordx4 v180, s[28:31], s63 offen lds
    v_mfma_f32_16x16x32_bf16 v[36:39], a[16:19], a[56:59], v[36:39]
    v_mfma_f32_16x16x32_bf16 v[68:71], a[16:19], a[12:15], v[68:71]
    v_mfma_f32_16x16x32_bf16 v[8:11], a[20:23], a[0:3], v[8:11]
    v_mfma_f32_16x16x32_bf16 v[40:43], a[20:23], a[56:59], v[40:43]
    v_mfma_f32_16x16x32_bf16 v[72:75], a[20:23], a[12:15], v[72:75]
    s_waitcnt lgkmcnt(12)
    v_mfma_f32_16x16x32_bf16 v[12:15], a[24:27], a[0:3], v[12:15]
    v_mfma_f32_16x16x32_bf16 v[44:47], a[24:27], a[56:59], v[44:47]
    v_mfma_f32_16x16x32_bf16 v[76:79], a[24:27], a[12:15], v[76:79]
    v_mfma_f32_16x16x32_bf16 v[16:19], a[28:31], a[0:3], v[16:19]
    v_mfma_f32_16x16x32_bf16 v[48:51], a[28:31], a[56:59], v[48:51]
    v_mfma_f32_16x16x32_bf16 v[80:83], a[28:31], a[12:15], v[80:83]
    s_waitcnt lgkmcnt(8)
    v_mfma_f32_16x16x32_bf16 v[20:23], a[32:35], a[0:3], v[20:23]
    v_mfma_f32_16x16x32_bf16 v[52:55], a[32:35], a[56:59], v[52:55]
    v_mfma_f32_16x16x32_bf16 v[84:87], a[32:35], a[12:15], v[84:87]
    s_waitcnt vmcnt(6)
    s_waitcnt lgkmcnt(0)
    s_barrier
    v_mfma_f32_16x16x32_bf16 v[24:27], a[36:39], a[0:3], v[24:27]
    ds_read_b64_tr_b16 a[52:53], v168 offset:8192
    ds_read_b64_tr_b16 a[54:55], v168 offset:8704
    ds_read_b128 a[64:67], v105 offset:2048
    ds_read_b128 a[4:7], v105 offset:4096
    v_mfma_f32_16x16x32_bf16 v[56:59], a[36:39], a[56:59], v[56:59]
    ds_read_b64_tr_b16 a[16:17], v169 offset:8192
    ds_read_b64_tr_b16 a[18:19], v169 offset:8704
    ds_read_b64_tr_b16 a[20:21], v170 offset:8192
    v_mfma_f32_16x16x32_bf16 v[88:91], a[36:39], a[12:15], v[88:91]
    ds_read_b64_tr_b16 a[22:23], v170 offset:8704
    ds_read_b64_tr_b16 a[24:25], v171 offset:8192
    ds_read_b64_tr_b16 a[26:27], v171 offset:8704
    v_mfma_f32_16x16x32_bf16 v[28:31], a[8:11], a[0:3], v[28:31]
    ds_read_b64_tr_b16 a[28:29], v168 offset:9216
    ds_read_b64_tr_b16 a[30:31], v168 offset:9728
    ds_read_b64_tr_b16 a[32:33], v169 offset:9216
    v_mfma_f32_16x16x32_bf16 v[60:63], a[8:11], a[56:59], v[60:63]
    ds_read_b64_tr_b16 a[34:35], v169 offset:9728
    ds_read_b64_tr_b16 a[36:37], v170 offset:9216
    ds_read_b64_tr_b16 a[38:39], v170 offset:9728
    s_add_u32 m0, s52, 8192
    v_mfma_f32_16x16x32_bf16 v[92:95], a[8:11], a[12:15], v[92:95]
    ds_read_b64_tr_b16 a[0:1], v171 offset:9216
    ds_read_b64_tr_b16 a[2:3], v171 offset:9728
    ds_read_b128 a[56:59], v107 offset:24576
    s_mov_b32 s48, 3932160
    v_mfma_f32_16x16x32_bf16 v[96:99], a[40:43], a[60:63], v[96:99]
    ds_read_b64_tr_b16 a[8:9], v172 offset:8192
    ds_read_b64_tr_b16 a[10:11], v172 offset:8704
    ds_read_b64_tr_b16 a[12:13], v173 offset:8192
    buffer_load_dwordx4 v181, s[32:35], s48 offen lds
    v_mfma_f32_16x16x32_bf16 v[100:103], a[44:47], a[60:63], v[100:103]
    ds_read_b64_tr_b16 a[14:15], v173 offset:8704
    s_add_u32 m0, s52, 9088
    s_nop 0
    buffer_load_dwordx4 v181, s[32:35], s48 offen offset:128 lds
    s_waitcnt lgkmcnt(15)
    v_mfma_f32_16x16x32_bf16 v[0:3], a[52:55], a[48:51], v[0:3]
    v_mfma_f32_16x16x32_bf16 v[32:35], a[52:55], a[64:67], v[32:35]
    v_mfma_f32_16x16x32_bf16 v[64:67], a[52:55], a[4:7], v[64:67]
    v_mfma_f32_16x16x32_bf16 v[4:7], a[16:19], a[48:51], v[4:7]
    v_mfma_f32_16x16x32_bf16 v[36:39], a[16:19], a[64:67], v[36:39]
    v_mfma_f32_16x16x32_bf16 v[68:71], a[16:19], a[4:7], v[68:71]
    v_mfma_f32_16x16x32_bf16 v[8:11], a[20:23], a[48:51], v[8:11]
    v_mfma_f32_16x16x32_bf16 v[40:43], a[20:23], a[64:67], v[40:43]
    v_mfma_f32_16x16x32_bf16 v[72:75], a[20:23], a[4:7], v[72:75]
    s_waitcnt lgkmcnt(11)
    v_mfma_f32_16x16x32_bf16 v[12:15], a[24:27], a[48:51], v[12:15]
    v_mfma_f32_16x16x32_bf16 v[44:47], a[24:27], a[64:67], v[44:47]
    buffer_load_dword v110, v108, s[92:95], 0 offen
    v_mfma_f32_16x16x32_bf16 v[76:79], a[24:27], a[4:7], v[76:79]
    v_mfma_f32_16x16x32_bf16 v[16:19], a[28:31], a[48:51], v[16:19]
    v_mfma_f32_16x16x32_bf16 v[48:51], a[28:31], a[64:67], v[48:51]
    v_mfma_f32_16x16x32_bf16 v[80:83], a[28:31], a[4:7], v[80:83]
    s_waitcnt lgkmcnt(7)
    v_mfma_f32_16x16x32_bf16 v[20:23], a[32:35], a[48:51], v[20:23]
    v_mfma_f32_16x16x32_bf16 v[52:55], a[32:35], a[64:67], v[52:55]
    v_mfma_f32_16x16x32_bf16 v[84:87], a[32:35], a[4:7], v[84:87]
    s_waitcnt vmcnt(3)
    s_waitcnt lgkmcnt(0)
    s_barrier
    v_mfma_f32_16x16x32_bf16 v[24:27], a[36:39], a[48:51], v[24:27]
    ds_read_b128 a[40:43], v176 offset:0
    ds_read_b64_tr_b16 a[44:45], v168 offset:16384
    ds_read_b64_tr_b16 a[46:47], v168 offset:16896
    v_mfma_f32_16x16x32_bf16 v[56:59], a[36:39], a[64:67], v[56:59]
    ds_read_b128 a[60:63], v176 offset:2048
    ds_read_b128 a[52:55], v176 offset:4096
    ds_read_b64_tr_b16 a[16:17], v169 offset:16384
    v_mfma_f32_16x16x32_bf16 v[88:91], a[36:39], a[4:7], v[88:91]
    ds_read_b64_tr_b16 a[18:19], v169 offset:16896
    ds_read_b64_tr_b16 a[20:21], v170 offset:16384
    ds_read_b64_tr_b16 a[22:23], v170 offset:16896
    v_mfma_f32_16x16x32_bf16 v[28:31], a[0:3], a[48:51], v[28:31]
    ds_read_b64_tr_b16 a[24:25], v171 offset:16384
    ds_read_b64_tr_b16 a[26:27], v171 offset:16896
    ds_read_b64_tr_b16 a[28:29], v168 offset:17408
    v_mfma_f32_16x16x32_bf16 v[60:63], a[0:3], a[64:67], v[60:63]
    ds_read_b64_tr_b16 a[30:31], v168 offset:17920
    ds_read_b64_tr_b16 a[32:33], v169 offset:17408
    ds_read_b64_tr_b16 a[34:35], v169 offset:17920
    v_mfma_f32_16x16x32_bf16 v[92:95], a[0:3], a[4:7], v[92:95]
    ds_read_b64_tr_b16 a[36:37], v170 offset:17408
    ds_read_b64_tr_b16 a[38:39], v170 offset:17920
    ds_read_b64_tr_b16 a[48:49], v171 offset:17408
    v_mfma_f32_16x16x32_bf16 v[96:99], a[8:11], a[56:59], v[96:99]
    ds_read_b64_tr_b16 a[50:51], v171 offset:17920
    ds_read_b128 a[64:67], v178 offset:24576
    ds_read_b64_tr_b16 a[0:1], v172 offset:16384
    v_mfma_f32_16x16x32_bf16 v[100:103], a[12:15], a[56:59], v[100:103]
    ds_read_b64_tr_b16 a[2:3], v172 offset:16896
    ds_read_b64_tr_b16 a[4:5], v173 offset:16384
    ds_read_b64_tr_b16 a[6:7], v173 offset:16896
    s_waitcnt lgkmcnt(15)
    v_mfma_f32_16x16x32_bf16 v[0:3], a[44:47], a[40:43], v[0:3]
    ds_read_b128 a[8:11], v177 offset:0
    v_mfma_f32_16x16x32_bf16 v[32:35], a[44:47], a[60:63], v[32:35]
    v_mfma_f32_16x16x32_bf16 v[64:67], a[44:47], a[52:55], v[64:67]
    v_mfma_f32_16x16x32_bf16 v[4:7], a[16:19], a[40:43], v[4:7]
    v_mfma_f32_16x16x32_bf16 v[36:39], a[16:19], a[60:63], v[36:39]
    v_mfma_f32_16x16x32_bf16 v[68:71], a[16:19], a[52:55], v[68:71]
    v_mfma_f32_16x16x32_bf16 v[8:11], a[20:23], a[40:43], v[8:11]
    v_mfma_f32_16x16x32_bf16 v[40:43], a[20:23], a[60:63], v[40:43]
    v_mfma_f32_16x16x32_bf16 v[72:75], a[20:23], a[52:55], v[72:75]
    s_waitcnt lgkmcnt(12)
    v_mfma_f32_16x16x32_bf16 v[12:15], a[24:27], a[40:43], v[12:15]
    v_mfma_f32_16x16x32_bf16 v[44:47], a[24:27], a[60:63], v[44:47]
    v_mfma_f32_16x16x32_bf16 v[76:79], a[24:27], a[52:55], v[76:79]
    v_mfma_f32_16x16x32_bf16 v[16:19], a[28:31], a[40:43], v[16:19]
    v_mfma_f32_16x16x32_bf16 v[48:51], a[28:31], a[60:63], v[48:51]
    v_mfma_f32_16x16x32_bf16 v[80:83], a[28:31], a[52:55], v[80:83]
    s_waitcnt lgkmcnt(8)
    v_mfma_f32_16x16x32_bf16 v[20:23], a[32:35], a[40:43], v[20:23]
    v_mfma_f32_16x16x32_bf16 v[52:55], a[32:35], a[60:63], v[52:55]
    v_mfma_f32_16x16x32_bf16 v[84:87], a[32:35], a[52:55], v[84:87]
    s_waitcnt vmcnt(1)
    s_waitcnt lgkmcnt(0)
    s_barrier
    v_mfma_f32_16x16x32_bf16 v[24:27], a[36:39], a[40:43], v[24:27]
    ds_read_b64_tr_b16 a[12:13], v168 offset:0
    ds_read_b64_tr_b16 a[14:15], v168 offset:512
    ds_read_b128 a[56:59], v177 offset:2048
    ds_read_b128 a[44:47], v177 offset:4096
    v_mfma_f32_16x16x32_bf16 v[56:59], a[36:39], a[60:63], v[56:59]
    ds_read_b64_tr_b16 a[16:17], v169 offset:0
    ds_read_b64_tr_b16 a[18:19], v169 offset:512
    ds_read_b64_tr_b16 a[20:21], v170 offset:0
    v_mfma_f32_16x16x32_bf16 v[88:91], a[36:39], a[52:55], v[88:91]
    ds_read_b64_tr_b16 a[22:23], v170 offset:512
    ds_read_b64_tr_b16 a[24:25], v171 offset:0
    ds_read_b64_tr_b16 a[26:27], v171 offset:512
    v_mfma_f32_16x16x32_bf16 v[28:31], a[48:51], a[40:43], v[28:31]
    ds_read_b64_tr_b16 a[28:29], v168 offset:1024
    ds_read_b64_tr_b16 a[30:31], v168 offset:1536
    ds_read_b64_tr_b16 a[32:33], v169 offset:1024
    v_mfma_f32_16x16x32_bf16 v[60:63], a[48:51], a[60:63], v[60:63]
    ds_read_b64_tr_b16 a[34:35], v169 offset:1536
    ds_read_b64_tr_b16 a[36:37], v170 offset:1024
    ds_read_b64_tr_b16 a[38:39], v170 offset:1536
    v_mfma_f32_16x16x32_bf16 v[92:95], a[48:51], a[52:55], v[92:95]
    ds_read_b64_tr_b16 a[40:41], v171 offset:1024
    ds_read_b64_tr_b16 a[42:43], v171 offset:1536
    ds_read_b128 a[60:63], v179 offset:24576
    v_mfma_f32_16x16x32_bf16 v[96:99], a[0:3], a[64:67], v[96:99]
    ds_read_b64_tr_b16 a[48:49], v172 offset:0
    ds_read_b64_tr_b16 a[50:51], v172 offset:512
    ds_read_b64_tr_b16 a[52:53], v173 offset:0
    v_mfma_f32_16x16x32_bf16 v[100:103], a[4:7], a[64:67], v[100:103]
    ds_read_b64_tr_b16 a[54:55], v173 offset:512
    s_waitcnt lgkmcnt(15)
    v_mfma_f32_16x16x32_bf16 v[0:3], a[12:15], a[8:11], v[0:3]
    v_mfma_f32_16x16x32_bf16 v[32:35], a[12:15], a[56:59], v[32:35]
    v_mfma_f32_16x16x32_bf16 v[64:67], a[12:15], a[44:47], v[64:67]
    v_mfma_f32_16x16x32_bf16 v[4:7], a[16:19], a[8:11], v[4:7]
    v_mfma_f32_16x16x32_bf16 v[36:39], a[16:19], a[56:59], v[36:39]
    v_mfma_f32_16x16x32_bf16 v[68:71], a[16:19], a[44:47], v[68:71]
    v_mfma_f32_16x16x32_bf16 v[8:11], a[20:23], a[8:11], v[8:11]
    v_mfma_f32_16x16x32_bf16 v[40:43], a[20:23], a[56:59], v[40:43]
    v_mfma_f32_16x16x32_bf16 v[72:75], a[20:23], a[44:47], v[72:75]
    s_waitcnt lgkmcnt(11)
    v_mfma_f32_16x16x32_bf16 v[12:15], a[24:27], a[8:11], v[12:15]
    v_mfma_f32_16x16x32_bf16 v[44:47], a[24:27], a[56:59], v[44:47]
    v_mfma_f32_16x16x32_bf16 v[76:79], a[24:27], a[44:47], v[76:79]
    v_mfma_f32_16x16x32_bf16 v[16:19], a[28:31], a[8:11], v[16:19]
    v_mfma_f32_16x16x32_bf16 v[48:51], a[28:31], a[56:59], v[48:51]
    v_mfma_f32_16x16x32_bf16 v[80:83], a[28:31], a[44:47], v[80:83]
    s_waitcnt lgkmcnt(7)
    v_mfma_f32_16x16x32_bf16 v[20:23], a[32:35], a[8:11], v[20:23]
    v_mfma_f32_16x16x32_bf16 v[52:55], a[32:35], a[56:59], v[52:55]
    v_mfma_f32_16x16x32_bf16 v[84:87], a[32:35], a[44:47], v[84:87]
    v_mfma_f32_16x16x32_bf16 v[24:27], a[36:39], a[8:11], v[24:27]
    v_mfma_f32_16x16x32_bf16 v[56:59], a[36:39], a[56:59], v[56:59]
    v_mfma_f32_16x16x32_bf16 v[88:91], a[36:39], a[44:47], v[88:91]
    s_waitcnt lgkmcnt(3)
    v_mfma_f32_16x16x32_bf16 v[28:31], a[40:43], a[8:11], v[28:31]
    v_mfma_f32_16x16x32_bf16 v[60:63], a[40:43], a[56:59], v[60:63]
    v_mfma_f32_16x16x32_bf16 v[92:95], a[40:43], a[44:47], v[92:95]
    s_waitcnt lgkmcnt(0)
    v_mfma_f32_16x16x32_bf16 v[96:99], a[48:51], a[60:63], v[96:99]
    v_mfma_f32_16x16x32_bf16 v[100:103], a[52:55], a[60:63], v[100:103]
    s_barrier
    s_cmp_lg_u32 s57, 0
    s_cbranch_scc1 L_concat_heads__mha_block_cached__gqa_block_cached__near_ridge_kernel_nordy
    v_mov_b32 v108, 0
    s_waitcnt vmcnt(0)
    v_mov_b32 v110, 1
    s_mov_b64 exec, 1
    buffer_store_byte v110, v108, s[20:23], s2 offen sc1
    s_mov_b64 exec, -1
L_concat_heads__mha_block_cached__gqa_block_cached__near_ridge_kernel_nordy:
    s_mov_b32 s49, 8192
    s_add_u32 m0, s53, 40960
    s_nop 0
    buffer_load_dwordx4 v174, s[36:39], s49 offen nt lds
    s_add_u32 m0, s53, 41856
    s_nop 0
    buffer_load_dwordx4 v174, s[36:39], s49 offen offset:128 nt lds
    s_mov_b32 s49, 8192
    s_add_u32 m0, s52, 8192
    s_nop 0
    buffer_load_dwordx4 v175, s[40:43], s49 offen nt lds
    s_add_u32 m0, s52, 9088
    s_nop 0
    buffer_load_dwordx4 v175, s[40:43], s49 offen offset:128 nt lds
    s_mov_b32 s49, 16384
    s_add_u32 m0, s53, 49152
    s_nop 0
    buffer_load_dwordx4 v174, s[36:39], s49 offen nt lds
    s_add_u32 m0, s53, 50048
    s_nop 0
    buffer_load_dwordx4 v174, s[36:39], s49 offen offset:128 nt lds
    s_mov_b32 s49, 16384
    s_add_u32 m0, s52, 16384
    s_nop 0
    buffer_load_dwordx4 v175, s[40:43], s49 offen nt lds
    s_add_u32 m0, s52, 17280
    s_nop 0
    buffer_load_dwordx4 v175, s[40:43], s49 offen offset:128 nt lds
    v_mov_b32 v181, s3
    v_lshl_add_u32 v181, v181, 10, v185
    v_mul_f32 v96, s58, v96
    v_mul_f32 v97, s58, v97
    v_mul_f32 v98, s58, v98
    v_mul_f32 v99, s58, v99
    v_mul_f32 v100, s58, v100
    v_mul_f32 v101, s58, v101
    v_mul_f32 v102, s58, v102
    v_mul_f32 v103, s58, v103
    v_cvt_pk_bf16_f32 v128, v96, v97
    v_cvt_pk_bf16_f32 v129, v98, v99
    v_cvt_pk_bf16_f32 v130, v100, v101
    v_cvt_pk_bf16_f32 v131, v102, v103
    s_nop 0
    v_permlane32_swap_b32 v128, v130
    v_permlane32_swap_b32 v129, v131
    s_nop 0
    v_permlane16_swap_b32 v128, v130
    v_permlane16_swap_b32 v129, v131
    ds_write_b128 v181, v[128:131]
    v_mul_f32 v0, s58, v0
    v_mul_f32 v1, s58, v1
    v_mul_f32 v2, s58, v2
    v_mul_f32 v3, s58, v3
    v_mul_f32 v4, s58, v4
    v_mul_f32 v5, s58, v5
    v_mul_f32 v6, s58, v6
    v_mul_f32 v7, s58, v7
    v_cvt_pk_bf16_f32 v132, v0, v1
    v_cvt_pk_bf16_f32 v133, v2, v3
    v_cvt_pk_bf16_f32 v134, v4, v5
    v_cvt_pk_bf16_f32 v135, v6, v7
    s_nop 0
    v_permlane32_swap_b32 v132, v134
    v_permlane32_swap_b32 v133, v135
    s_nop 0
    v_permlane16_swap_b32 v132, v134
    v_permlane16_swap_b32 v133, v135
    v_accvgpr_write_b32 a0, v132
    v_accvgpr_write_b32 a1, v133
    v_accvgpr_write_b32 a2, v134
    v_accvgpr_write_b32 a3, v135
    v_mul_f32 v8, s58, v8
    v_mul_f32 v9, s58, v9
    v_mul_f32 v10, s58, v10
    v_mul_f32 v11, s58, v11
    v_mul_f32 v12, s58, v12
    v_mul_f32 v13, s58, v13
    v_mul_f32 v14, s58, v14
    v_mul_f32 v15, s58, v15
    v_cvt_pk_bf16_f32 v136, v8, v9
    v_cvt_pk_bf16_f32 v137, v10, v11
    v_cvt_pk_bf16_f32 v138, v12, v13
    v_cvt_pk_bf16_f32 v139, v14, v15
    s_nop 0
    v_permlane32_swap_b32 v136, v138
    v_permlane32_swap_b32 v137, v139
    s_nop 0
    v_permlane16_swap_b32 v136, v138
    v_permlane16_swap_b32 v137, v139
    v_accvgpr_write_b32 a4, v136
    v_accvgpr_write_b32 a5, v137
    v_accvgpr_write_b32 a6, v138
    v_accvgpr_write_b32 a7, v139
    v_mul_f32 v16, s58, v16
    v_mul_f32 v17, s58, v17
    v_mul_f32 v18, s58, v18
    v_mul_f32 v19, s58, v19
    v_mul_f32 v20, s58, v20
    v_mul_f32 v21, s58, v21
    v_mul_f32 v22, s58, v22
    v_mul_f32 v23, s58, v23
    v_cvt_pk_bf16_f32 v140, v16, v17
    v_cvt_pk_bf16_f32 v141, v18, v19
    v_cvt_pk_bf16_f32 v142, v20, v21
    v_cvt_pk_bf16_f32 v143, v22, v23
    s_nop 0
    v_permlane32_swap_b32 v140, v142
    v_permlane32_swap_b32 v141, v143
    s_nop 0
    v_permlane16_swap_b32 v140, v142
    v_permlane16_swap_b32 v141, v143
    v_accvgpr_write_b32 a8, v140
    v_accvgpr_write_b32 a9, v141
    v_accvgpr_write_b32 a10, v142
    v_accvgpr_write_b32 a11, v143
    v_mul_f32 v24, s58, v24
    v_mul_f32 v25, s58, v25
    v_mul_f32 v26, s58, v26
    v_mul_f32 v27, s58, v27
    v_mul_f32 v28, s58, v28
    v_mul_f32 v29, s58, v29
    v_mul_f32 v30, s58, v30
    v_mul_f32 v31, s58, v31
    v_cvt_pk_bf16_f32 v144, v24, v25
    v_cvt_pk_bf16_f32 v145, v26, v27
    v_cvt_pk_bf16_f32 v146, v28, v29
    v_cvt_pk_bf16_f32 v147, v30, v31
    s_nop 0
    v_permlane32_swap_b32 v144, v146
    v_permlane32_swap_b32 v145, v147
    s_nop 0
    v_permlane16_swap_b32 v144, v146
    v_permlane16_swap_b32 v145, v147
    v_accvgpr_write_b32 a12, v144
    v_accvgpr_write_b32 a13, v145
    v_accvgpr_write_b32 a14, v146
    v_accvgpr_write_b32 a15, v147
    v_mul_f32 v32, s58, v32
    v_mul_f32 v33, s58, v33
    v_mul_f32 v34, s58, v34
    v_mul_f32 v35, s58, v35
    v_mul_f32 v36, s58, v36
    v_mul_f32 v37, s58, v37
    v_mul_f32 v38, s58, v38
    v_mul_f32 v39, s58, v39
    v_cvt_pk_bf16_f32 v148, v32, v33
    v_cvt_pk_bf16_f32 v149, v34, v35
    v_cvt_pk_bf16_f32 v150, v36, v37
    v_cvt_pk_bf16_f32 v151, v38, v39
    s_nop 0
    v_permlane32_swap_b32 v148, v150
    v_permlane32_swap_b32 v149, v151
    s_nop 0
    v_permlane16_swap_b32 v148, v150
    v_permlane16_swap_b32 v149, v151
    v_accvgpr_write_b32 a16, v148
    v_accvgpr_write_b32 a17, v149
    v_accvgpr_write_b32 a18, v150
    v_accvgpr_write_b32 a19, v151
    v_mul_f32 v40, s58, v40
    v_mul_f32 v41, s58, v41
    v_mul_f32 v42, s58, v42
    v_mul_f32 v43, s58, v43
    v_mul_f32 v44, s58, v44
    v_mul_f32 v45, s58, v45
    v_mul_f32 v46, s58, v46
    v_mul_f32 v47, s58, v47
    v_cvt_pk_bf16_f32 v128, v40, v41
    v_cvt_pk_bf16_f32 v129, v42, v43
    v_cvt_pk_bf16_f32 v130, v44, v45
    v_cvt_pk_bf16_f32 v131, v46, v47
    s_nop 0
    v_permlane32_swap_b32 v128, v130
    v_permlane32_swap_b32 v129, v131
    s_nop 0
    v_permlane16_swap_b32 v128, v130
    v_permlane16_swap_b32 v129, v131
    v_accvgpr_write_b32 a20, v128
    v_accvgpr_write_b32 a21, v129
    v_accvgpr_write_b32 a22, v130
    v_accvgpr_write_b32 a23, v131
    v_mul_f32 v48, s58, v48
    v_mul_f32 v49, s58, v49
    v_mul_f32 v50, s58, v50
    v_mul_f32 v51, s58, v51
    v_mul_f32 v52, s58, v52
    v_mul_f32 v53, s58, v53
    v_mul_f32 v54, s58, v54
    v_mul_f32 v55, s58, v55
    v_cvt_pk_bf16_f32 v132, v48, v49
    v_cvt_pk_bf16_f32 v133, v50, v51
    v_cvt_pk_bf16_f32 v134, v52, v53
    v_cvt_pk_bf16_f32 v135, v54, v55
    s_nop 0
    v_permlane32_swap_b32 v132, v134
    v_permlane32_swap_b32 v133, v135
    s_nop 0
    v_permlane16_swap_b32 v132, v134
    v_permlane16_swap_b32 v133, v135
    v_accvgpr_write_b32 a24, v132
    v_accvgpr_write_b32 a25, v133
    v_accvgpr_write_b32 a26, v134
    v_accvgpr_write_b32 a27, v135
    v_mul_f32 v56, s58, v56
    v_mul_f32 v57, s58, v57
    v_mul_f32 v58, s58, v58
    v_mul_f32 v59, s58, v59
    v_mul_f32 v60, s58, v60
    v_mul_f32 v61, s58, v61
    v_mul_f32 v62, s58, v62
    v_mul_f32 v63, s58, v63
    v_cvt_pk_bf16_f32 v136, v56, v57
    v_cvt_pk_bf16_f32 v137, v58, v59
    v_cvt_pk_bf16_f32 v138, v60, v61
    v_cvt_pk_bf16_f32 v139, v62, v63
    s_nop 0
    v_permlane32_swap_b32 v136, v138
    v_permlane32_swap_b32 v137, v139
    s_nop 0
    v_permlane16_swap_b32 v136, v138
    v_permlane16_swap_b32 v137, v139
    v_accvgpr_write_b32 a28, v136
    v_accvgpr_write_b32 a29, v137
    v_accvgpr_write_b32 a30, v138
    v_accvgpr_write_b32 a31, v139
    v_mul_f32 v64, s58, v64
    v_mul_f32 v65, s58, v65
    v_mul_f32 v66, s58, v66
    v_mul_f32 v67, s58, v67
    v_mul_f32 v68, s58, v68
    v_mul_f32 v69, s58, v69
    v_mul_f32 v70, s58, v70
    v_mul_f32 v71, s58, v71
    v_cvt_pk_bf16_f32 v140, v64, v65
    v_cvt_pk_bf16_f32 v141, v66, v67
    v_cvt_pk_bf16_f32 v142, v68, v69
    v_cvt_pk_bf16_f32 v143, v70, v71
    s_nop 0
    v_permlane32_swap_b32 v140, v142
    v_permlane32_swap_b32 v141, v143
    s_nop 0
    v_permlane16_swap_b32 v140, v142
    v_permlane16_swap_b32 v141, v143
    v_accvgpr_write_b32 a32, v140
    v_accvgpr_write_b32 a33, v141
    v_accvgpr_write_b32 a34, v142
    v_accvgpr_write_b32 a35, v143
    v_mul_f32 v72, s58, v72
    v_mul_f32 v73, s58, v73
    v_mul_f32 v74, s58, v74
    v_mul_f32 v75, s58, v75
    v_mul_f32 v76, s58, v76
    v_mul_f32 v77, s58, v77
    v_mul_f32 v78, s58, v78
    v_mul_f32 v79, s58, v79
    v_cvt_pk_bf16_f32 v144, v72, v73
    v_cvt_pk_bf16_f32 v145, v74, v75
    v_cvt_pk_bf16_f32 v146, v76, v77
    v_cvt_pk_bf16_f32 v147, v78, v79
    s_nop 0
    v_permlane32_swap_b32 v144, v146
    v_permlane32_swap_b32 v145, v147
    s_nop 0
    v_permlane16_swap_b32 v144, v146
    v_permlane16_swap_b32 v145, v147
    v_accvgpr_write_b32 a36, v144
    v_accvgpr_write_b32 a37, v145
    v_accvgpr_write_b32 a38, v146
    v_accvgpr_write_b32 a39, v147
    v_mul_f32 v80, s58, v80
    v_mul_f32 v81, s58, v81
    v_mul_f32 v82, s58, v82
    v_mul_f32 v83, s58, v83
    v_mul_f32 v84, s58, v84
    v_mul_f32 v85, s58, v85
    v_mul_f32 v86, s58, v86
    v_mul_f32 v87, s58, v87
    v_cvt_pk_bf16_f32 v148, v80, v81
    v_cvt_pk_bf16_f32 v149, v82, v83
    v_cvt_pk_bf16_f32 v150, v84, v85
    v_cvt_pk_bf16_f32 v151, v86, v87
    s_nop 0
    v_permlane32_swap_b32 v148, v150
    v_permlane32_swap_b32 v149, v151
    s_nop 0
    v_permlane16_swap_b32 v148, v150
    v_permlane16_swap_b32 v149, v151
    v_accvgpr_write_b32 a40, v148
    v_accvgpr_write_b32 a41, v149
    v_accvgpr_write_b32 a42, v150
    v_accvgpr_write_b32 a43, v151
    v_mul_f32 v88, s58, v88
    v_mul_f32 v89, s58, v89
    v_mul_f32 v90, s58, v90
    v_mul_f32 v91, s58, v91
    v_mul_f32 v92, s58, v92
    v_mul_f32 v93, s58, v93
    v_mul_f32 v94, s58, v94
    v_mul_f32 v95, s58, v95
    v_cvt_pk_bf16_f32 v128, v88, v89
    v_cvt_pk_bf16_f32 v129, v90, v91
    v_cvt_pk_bf16_f32 v130, v92, v93
    v_cvt_pk_bf16_f32 v131, v94, v95
    s_nop 0
    v_permlane32_swap_b32 v128, v130
    v_permlane32_swap_b32 v129, v131
    s_nop 0
    v_permlane16_swap_b32 v128, v130
    v_permlane16_swap_b32 v129, v131
    v_accvgpr_write_b32 a44, v128
    v_accvgpr_write_b32 a45, v129
    v_accvgpr_write_b32 a46, v130
    v_accvgpr_write_b32 a47, v131
    v_lshrrev_b32 v181, 4, v184
    v_and_b32 v0, 15, v181
    v_lshrrev_b32 v1, 4, v181
    v_bfe_u32 v2, v181, 2, 2
    v_and_b32 v3, 3, v181
    s_mov_b32 s7, s101
    s_mov_b32 s54, s101
    v_lshrrev_b32 v4, 3, v0
    v_lshlrev_b32 v4, 11, v4
    v_and_b32 v5, 7, v0
    v_lshl_add_u32 v4, v5, 7, v4
    v_add_u32 v4, s7, v4
    v_lshrrev_b32 v5, 1, v0
    v_xor_b32 v5, v5, v1
    v_lshl_add_u32 v168, v5, 4, v4
    v_xor_b32 v5, 4, v5
    v_lshl_add_u32 v169, v5, 4, v4
    v_lshrrev_b32 v4, 1, v1
    v_lshlrev_b32 v4, 11, v4
    v_and_b32 v5, 1, v1
    v_lshl_add_u32 v4, v5, 9, v4
    v_lshl_add_u32 v4, v2, 7, v4
    v_lshl_add_u32 v4, v3, 3, v4
    v_add_u32 v4, s54, v4
    v_lshrrev_b32 v3, 1, v2
    v_lshl_or_b32 v5, v5, 1, v3
    v_xor_b32 v3, 0, v5
    v_lshl_add_u32 v170, v3, 5, v4
    v_xor_b32 v3, 1, v5
    v_lshl_add_u32 v171, v3, 5, v4
    v_xor_b32 v3, 2, v5
    v_lshl_add_u32 v172, v3, 5, v4
    v_xor_b32 v3, 3, v5
    v_lshl_add_u32 v173, v3, 5, v4
    s_setprio 1
    s_mov_b32 s49, 24576
    v_mov_b32 v0, 0
    v_mov_b32 v1, 0
    v_mov_b32 v2, 0
    v_mov_b32 v3, 0
    v_mov_b32 v4, 0
    v_mov_b32 v5, 0
    v_mov_b32 v6, 0
    v_mov_b32 v7, 0
    v_mov_b32 v8, 0
    v_mov_b32 v9, 0
    v_mov_b32 v10, 0
    v_mov_b32 v11, 0
    v_mov_b32 v12, 0
    v_mov_b32 v13, 0
    v_mov_b32 v14, 0
    v_mov_b32 v15, 0
    v_mov_b32 v16, 0
    v_mov_b32 v17, 0
    v_mov_b32 v18, 0
    v_mov_b32 v19, 0
    v_mov_b32 v20, 0
    v_mov_b32 v21, 0
    v_mov_b32 v22, 0
    v_mov_b32 v23, 0
    v_mov_b32 v24, 0
    v_mov_b32 v25, 0
    v_mov_b32 v26, 0
    v_mov_b32 v27, 0
    v_mov_b32 v28, 0
    v_mov_b32 v29, 0
    v_mov_b32 v30, 0
    v_mov_b32 v31, 0
    v_mov_b32 v32, 0
    v_mov_b32 v33, 0
    v_mov_b32 v34, 0
    v_mov_b32 v35, 0
    v_mov_b32 v36, 0
    v_mov_b32 v37, 0
    v_mov_b32 v38, 0
    v_mov_b32 v39, 0
    v_mov_b32 v40, 0
    v_mov_b32 v41, 0
    v_mov_b32 v42, 0
    v_mov_b32 v43, 0
    v_mov_b32 v44, 0
    v_mov_b32 v45, 0
    v_mov_b32 v46, 0
    v_mov_b32 v47, 0
    v_mov_b32 v48, 0
    v_mov_b32 v49, 0
    v_mov_b32 v50, 0
    v_mov_b32 v51, 0
    v_mov_b32 v52, 0
    v_mov_b32 v53, 0
    v_mov_b32 v54, 0
    v_mov_b32 v55, 0
    v_mov_b32 v56, 0
    v_mov_b32 v57, 0
    v_mov_b32 v58, 0
    v_mov_b32 v59, 0
    v_mov_b32 v60, 0
    v_mov_b32 v61, 0
    v_mov_b32 v62, 0
    v_mov_b32 v63, 0
    v_mov_b32 v64, 0
    v_mov_b32 v65, 0
    v_mov_b32 v66, 0
    v_mov_b32 v67, 0
    v_mov_b32 v68, 0
    v_mov_b32 v69, 0
    v_mov_b32 v70, 0
    v_mov_b32 v71, 0
    v_mov_b32 v72, 0
    v_mov_b32 v73, 0
    v_mov_b32 v74, 0
    v_mov_b32 v75, 0
    v_mov_b32 v76, 0
    v_mov_b32 v77, 0
    v_mov_b32 v78, 0
    v_mov_b32 v79, 0
    v_mov_b32 v80, 0
    v_mov_b32 v81, 0
    v_mov_b32 v82, 0
    v_mov_b32 v83, 0
    v_mov_b32 v84, 0
    v_mov_b32 v85, 0
    v_mov_b32 v86, 0
    v_mov_b32 v87, 0
    v_mov_b32 v88, 0
    v_mov_b32 v89, 0
    v_mov_b32 v90, 0
    v_mov_b32 v91, 0
    v_mov_b32 v92, 0
    v_mov_b32 v93, 0
    v_mov_b32 v94, 0
    v_mov_b32 v95, 0
    v_mov_b32 v96, 0
    v_mov_b32 v97, 0
    v_mov_b32 v98, 0
    v_mov_b32 v99, 0
    v_mov_b32 v100, 0
    v_mov_b32 v101, 0
    v_mov_b32 v102, 0
    v_mov_b32 v103, 0
    v_mov_b32 v104, 0
    v_mov_b32 v105, 0
    v_mov_b32 v106, 0
    v_mov_b32 v107, 0
    v_mov_b32 v108, 0
    v_mov_b32 v109, 0
    s_waitcnt vmcnt(8)
    v_mov_b32 v110, 0
    v_mov_b32 v111, 0
    v_mov_b32 v112, 0
    v_mov_b32 v113, 0
    v_mov_b32 v114, 0
    v_mov_b32 v115, 0
    v_mov_b32 v116, 0
    v_mov_b32 v117, 0
    v_mov_b32 v118, 0
    v_mov_b32 v119, 0
    v_mov_b32 v120, 0
    v_mov_b32 v121, 0
    v_mov_b32 v122, 0
    v_mov_b32 v123, 0
    v_mov_b32 v124, 0
    v_mov_b32 v125, 0
    v_mov_b32 v126, 0
    v_mov_b32 v127, 0
    v_mov_b32 v164, 0
    v_mov_b32 v165, 0
    v_mov_b32 v166, 0
    v_mov_b32 v167, 0
    s_lshl_b32 s55, s56, 1
    s_add_u32 s55, s55, s3
    s_and_b32 s55, s55, 3
    s_waitcnt vmcnt(8) lgkmcnt(0)
    s_add_u32 s16, s16, 4
    v_mov_b32 v187, 1
    s_mov_b64 exec, 1
    ds_add_rtn_u32 v187, v186, v187
    s_mov_b64 exec, -1
    s_waitcnt lgkmcnt(0)
    v_readfirstlane_b32 s17, v187
    s_nop 0
    s_add_u32 s17, s17, 1
    s_cmp_ge_u32 s17, s16
    s_cbranch_scc1 L_gb0_d
    s_mov_b32 s18, 0
L_gb0_l:
    ds_read_b32 v187, v186
    s_add_u32 s18, s18, 1
    s_cmp_ge_u32 s18, 0x200000
    s_cbranch_scc1 L_gb0_d
    s_waitcnt lgkmcnt(0)
    v_readfirstlane_b32 s17, v187
    s_nop 0
    s_cmp_ge_u32 s17, s16
    s_cbranch_scc0 L_gb0_l
L_gb0_d:
    ds_read_b128 a[48:51], v168 offset:32768
    ds_read_b128 a[52:55], v169 offset:32768
    ds_read_b128 a[56:59], v168 offset:33792
    ds_read_b128 a[60:63], v169 offset:33792
    s_waitcnt lgkmcnt(3)
    v_mfma_f32_16x16x32_bf16 v[128:131], a[48:51], a[0:3], 0
    v_mfma_f32_16x16x32_bf16 v[132:135], a[48:51], a[16:19], 0
    v_mfma_f32_16x16x32_bf16 v[136:139], a[48:51], a[32:35], 0
    s_waitcnt lgkmcnt(2)
    v_mfma_f32_16x16x32_bf16 v[128:131], a[52:55], a[4:7], v[128:131]
    v_mfma_f32_16x16x32_bf16 v[132:135], a[52:55], a[20:23], v[132:135]
    v_mfma_f32_16x16x32_bf16 v[136:139], a[52:55], a[36:39], v[136:139]
    s_waitcnt lgkmcnt(1)
    v_mfma_f32_16x16x32_bf16 v[128:131], a[56:59], a[8:11], v[128:131]
    v_mfma_f32_16x16x32_bf16 v[132:135], a[56:59], a[24:27], v[132:135]
    v_mfma_f32_16x16x32_bf16 v[136:139], a[56:59], a[40:43], v[136:139]
    s_waitcnt lgkmcnt(0)
    v_mfma_f32_16x16x32_bf16 v[128:131], a[60:63], a[12:15], v[128:131]
    v_mfma_f32_16x16x32_bf16 v[132:135], a[60:63], a[28:31], v[132:135]
    v_mfma_f32_16x16x32_bf16 v[136:139], a[60:63], a[44:47], v[136:139]
    s_nop 5
    v_exp_f32 v128, v128
    v_exp_f32 v129, v129
    v_exp_f32 v130, v130
    v_exp_f32 v131, v131
    v_exp_f32 v132, v132
    v_exp_f32 v133, v133
    v_exp_f32 v134, v134
    v_exp_f32 v135, v135
    v_exp_f32 v136, v136
    v_exp_f32 v137, v137
    v_exp_f32 v138, v138
    v_exp_f32 v139, v139
    s_mov_b32 s50, 0
.p2align 3
L_concat_heads__mha_block_cached__gqa_block_cached__near_ridge_kernel_f_loop:
    s_cmp_eq_u32 s55, 0
    s_cbranch_scc1 L_concat_heads__mha_block_cached__gqa_block_cached__near_ridge_kernel_f_o0
    ds_read_b128 a[48:51], v168 offset:36864
    ds_read_b128 a[52:55], v169 offset:36864
    ds_read_b128 a[56:59], v168 offset:37888
    s_waitcnt vmcnt(6)
    s_add_u32 s16, s16, 4
    v_mov_b32 v187, 1
    s_mov_b64 exec, 1
    ds_add_rtn_u32 v187, v186, v187
    s_mov_b64 exec, -1
    s_waitcnt lgkmcnt(0)
    v_readfirstlane_b32 s17, v187
    s_nop 0
    s_add_u32 s17, s17, 1
    s_cmp_ge_u32 s17, s16
    s_cbranch_scc1 L_gb1_d
    s_mov_b32 s18, 0
L_gb1_l:
    ds_read_b32 v187, v186
    s_add_u32 s18, s18, 1
    s_cmp_ge_u32 s18, 0x200000
    s_cbranch_scc1 L_gb1_d
    s_waitcnt lgkmcnt(0)
    v_readfirstlane_b32 s17, v187
    s_nop 0
    s_cmp_ge_u32 s17, s16
    s_cbranch_scc0 L_gb1_l
L_gb1_d:
    v_mfma_f32_16x16x32_bf16 v[140:143], a[48:51], a[0:3], 0
    ds_read_b128 a[60:63], v169 offset:37888
    v_cvt_pk_bf16_f32 v152, v128, v129
    v_cvt_pk_bf16_f32 v153, v130, v131
    v_mfma_f32_16x16x32_bf16 v[144:147], a[48:51], a[16:19], 0
    ds_read_b128 a[64:67], v168 offset:40960
    v_add_f32 v164, v164, v128
    v_add_f32 v164, v164, v129
    v_mfma_f32_16x16x32_bf16 v[148:151], a[48:51], a[32:35], 0
    ds_read_b128 a[48:51], v169 offset:40960
    v_add_f32 v164, v164, v130
    v_add_f32 v164, v164, v131
    v_mfma_f32_16x16x32_bf16 v[140:143], a[52:55], a[4:7], v[140:143]
    s_add_u32 m0, s53, 57344
    v_cvt_pk_bf16_f32 v156, v132, v133
    v_cvt_pk_bf16_f32 v157, v134, v135
    v_mfma_f32_16x16x32_bf16 v[144:147], a[52:55], a[20:23], v[144:147]
    buffer_load_dwordx4 v174, s[36:39], s49 offen nt lds
    s_add_u32 m0, s53, 58240
    v_add_f32 v165, v165, v132
    v_add_f32 v165, v165, v133
    v_mfma_f32_16x16x32_bf16 v[148:151], a[52:55], a[36:39], v[148:151]
    ds_read_b128 a[52:55], v168 offset:41984
    buffer_load_dwordx4 v174, s[36:39], s49 offen offset:128 nt lds
    v_add_f32 v165, v165, v134
    v_add_f32 v165, v165, v135
    v_mfma_f32_16x16x32_bf16 v[140:143], a[56:59], a[8:11], v[140:143]
    s_add_u32 m0, s52, 24576
    s_nop 0
    buffer_load_dwordx4 v175, s[40:43], s49 offen nt lds
    v_cvt_pk_bf16_f32 v160, v136, v137
    v_cvt_pk_bf16_f32 v161, v138, v139
    v_mfma_f32_16x16x32_bf16 v[144:147], a[56:59], a[24:27], v[144:147]
    s_add_u32 m0, s52, 25472
    s_nop 0
    buffer_load_dwordx4 v175, s[40:43], s49 offen offset:128 nt lds
    v_add_f32 v166, v166, v136
    v_add_f32 v166, v166, v137
    v_mfma_f32_16x16x32_bf16 v[148:151], a[56:59], a[40:43], v[148:151]
    ds_read_b128 a[56:59], v169 offset:41984
    s_add_u32 s49, s49, 8192
    s_waitcnt lgkmcnt(3)
    v_add_f32 v166, v166, v138
    v_add_f32 v166, v166, v139
    v_mfma_f32_16x16x32_bf16 v[140:143], a[60:63], a[12:15], v[140:143]
    v_mfma_f32_16x16x32_bf16 v[144:147], a[60:63], a[28:31], v[144:147]
    v_mfma_f32_16x16x32_bf16 v[148:151], a[60:63], a[44:47], v[148:151]
    ds_read_b64_tr_b16 a[60:61], v170 offset:0
    ds_read_b64_tr_b16 a[62:63], v170 offset:4096
    v_mfma_f32_16x16x32_bf16 v[128:131], a[64:67], a[0:3], 0
    s_nop 2
    v_exp_f32 v140, v140
    v_mfma_f32_16x16x32_bf16 v[132:135], a[64:67], a[16:19], 0
    v_exp_f32 v141, v141
    v_mfma_f32_16x16x32_bf16 v[136:139], a[64:67], a[32:35], 0
    ds_read_b64_tr_b16 a[64:65], v171 offset:0
    s_waitcnt lgkmcnt(4)
    v_exp_f32 v142, v142
    v_mfma_f32_16x16x32_bf16 v[128:131], a[48:51], a[4:7], v[128:131]
    ds_read_b64_tr_b16 a[66:67], v171 offset:4096
    v_exp_f32 v143, v143
    v_mfma_f32_16x16x32_bf16 v[132:135], a[48:51], a[20:23], v[132:135]
    v_cvt_pk_bf16_f32 v154, v140, v141
    v_cvt_pk_bf16_f32 v155, v142, v143
    v_mfma_f32_16x16x32_bf16 v[136:139], a[48:51], a[36:39], v[136:139]
    ds_read_b64_tr_b16 a[48:49], v172 offset:0
    v_exp_f32 v144, v144
    v_mfma_f32_16x16x32_bf16 v[128:131], a[52:55], a[8:11], v[128:131]
    ds_read_b64_tr_b16 a[50:51], v172 offset:4096
    v_exp_f32 v145, v145
    v_mfma_f32_16x16x32_bf16 v[132:135], a[52:55], a[24:27], v[132:135]
    v_exp_f32 v146, v146
    v_mfma_f32_16x16x32_bf16 v[136:139], a[52:55], a[40:43], v[136:139]
    ds_read_b64_tr_b16 a[52:53], v173 offset:0
    s_waitcnt lgkmcnt(6)
    v_exp_f32 v147, v147
    v_mfma_f32_16x16x32_bf16 v[128:131], a[56:59], a[12:15], v[128:131]
    ds_read_b64_tr_b16 a[54:55], v173 offset:4096
    v_cvt_pk_bf16_f32 v158, v144, v145
    v_cvt_pk_bf16_f32 v159, v146, v147
    v_mfma_f32_16x16x32_bf16 v[132:135], a[56:59], a[28:31], v[132:135]
    v_exp_f32 v148, v148
    v_mfma_f32_16x16x32_bf16 v[136:139], a[56:59], a[44:47], v[136:139]
    ds_read_b64_tr_b16 a[56:57], v170 offset:1024
    s_waitcnt lgkmcnt(6)
    v_exp_f32 v149, v149
    v_mfma_f32_16x16x32_bf16 v[0:3], a[60:63], v[152:155], v[0:3]
    ds_read_b64_tr_b16 a[58:59], v170 offset:5120
    v_exp_f32 v150, v150
    v_mfma_f32_16x16x32_bf16 v[32:35], a[60:63], v[156:159], v[32:35]
    v_exp_f32 v151, v151
    v_cvt_pk_bf16_f32 v162, v148, v149
    v_cvt_pk_bf16_f32 v163, v150, v151
    s_nop 1
    v_mfma_f32_16x16x32_bf16 v[64:67], a[60:63], v[160:163], v[64:67]
    ds_read_b64_tr_b16 a[60:61], v171 offset:1024
    s_waitcnt lgkmcnt(6)
    v_add_f32 v164, v164, v140
    v_add_f32 v164, v164, v141
    v_mfma_f32_16x16x32_bf16 v[4:7], a[64:67], v[152:155], v[4:7]
    ds_read_b64_tr_b16 a[62:63], v171 offset:5120
    v_add_f32 v164, v164, v142
    v_add_f32 v164, v164, v143
    v_mfma_f32_16x16x32_bf16 v[36:39], a[64:67], v[156:159], v[36:39]
    v_add_f32 v165, v165, v144
    v_add_f32 v165, v165, v145
    v_mfma_f32_16x16x32_bf16 v[68:71], a[64:67], v[160:163], v[68:71]
    ds_read_b64_tr_b16 a[64:65], v172 offset:1024
    s_waitcnt lgkmcnt(6)
    v_add_f32 v165, v165, v146
    v_add_f32 v165, v165, v147
    v_mfma_f32_16x16x32_bf16 v[8:11], a[48:51], v[152:155], v[8:11]
    ds_read_b64_tr_b16 a[66:67], v172 offset:5120
    v_add_f32 v166, v166, v148
    v_add_f32 v166, v166, v149
    v_mfma_f32_16x16x32_bf16 v[40:43], a[48:51], v[156:159], v[40:43]
    v_add_f32 v166, v166, v150
    v_add_f32 v166, v166, v151
    v_mfma_f32_16x16x32_bf16 v[72:75], a[48:51], v[160:163], v[72:75]
    ds_read_b64_tr_b16 a[48:49], v173 offset:1024
    s_waitcnt lgkmcnt(6)
    v_exp_f32 v128, v128
    v_mfma_f32_16x16x32_bf16 v[12:15], a[52:55], v[152:155], v[12:15]
    ds_read_b64_tr_b16 a[50:51], v173 offset:5120
    v_exp_f32 v129, v129
    v_mfma_f32_16x16x32_bf16 v[44:47], a[52:55], v[156:159], v[44:47]
    v_exp_f32 v130, v130
    v_mfma_f32_16x16x32_bf16 v[76:79], a[52:55], v[160:163], v[76:79]
    s_waitcnt lgkmcnt(5)
    v_exp_f32 v131, v131
    v_mfma_f32_16x16x32_bf16 v[16:19], a[56:59], v[152:155], v[16:19]
    v_exp_f32 v132, v132
    v_mfma_f32_16x16x32_bf16 v[48:51], a[56:59], v[156:159], v[48:51]
    v_exp_f32 v133, v133
    v_mfma_f32_16x16x32_bf16 v[80:83], a[56:59], v[160:163], v[80:83]
    s_waitcnt lgkmcnt(3)
    v_exp_f32 v134, v134
    v_mfma_f32_16x16x32_bf16 v[20:23], a[60:63], v[152:155], v[20:23]
    v_exp_f32 v135, v135
    v_mfma_f32_16x16x32_bf16 v[52:55], a[60:63], v[156:159], v[52:55]
    v_exp_f32 v136, v136
    v_mfma_f32_16x16x32_bf16 v[84:87], a[60:63], v[160:163], v[84:87]
    s_waitcnt lgkmcnt(1)
    v_exp_f32 v137, v137
    v_mfma_f32_16x16x32_bf16 v[24:27], a[64:67], v[152:155], v[24:27]
    v_exp_f32 v138, v138
    v_mfma_f32_16x16x32_bf16 v[56:59], a[64:67], v[156:159], v[56:59]
    v_exp_f32 v139, v139
    v_mfma_f32_16x16x32_bf16 v[88:91], a[64:67], v[160:163], v[88:91]
    s_waitcnt lgkmcnt(0)
    v_mfma_f32_16x16x32_bf16 v[28:31], a[48:51], v[152:155], v[28:31]
    v_mfma_f32_16x16x32_bf16 v[60:63], a[48:51], v[156:159], v[60:63]
    v_mfma_f32_16x16x32_bf16 v[92:95], a[48:51], v[160:163], v[92:95]
    s_branch L_concat_heads__mha_block_cached__gqa_block_cached__near_ridge_kernel_f_j0
L_concat_heads__mha_block_cached__gqa_block_cached__near_ridge_kernel_f_o0:
    ds_read_b128 a[48:51], v168 offset:36864
    ds_read_b128 a[52:55], v185 offset:0
    ds_read_b128 a[56:59], v168 offset:32768
    s_waitcnt vmcnt(6)
    s_add_u32 s16, s16, 4
    v_mov_b32 v187, 1
    s_mov_b64 exec, 1
    ds_add_rtn_u32 v187, v186, v187
    s_mov_b64 exec, -1
    s_waitcnt lgkmcnt(0)
    v_readfirstlane_b32 s17, v187
    s_nop 0
    s_add_u32 s17, s17, 1
    s_cmp_ge_u32 s17, s16
    s_cbranch_scc1 L_gb2_d
    s_mov_b32 s18, 0
L_gb2_l:
    ds_read_b32 v187, v186
    s_add_u32 s18, s18, 1
    s_cmp_ge_u32 s18, 0x200000
    s_cbranch_scc1 L_gb2_d
    s_waitcnt lgkmcnt(0)
    v_readfirstlane_b32 s17, v187
    s_nop 0
    s_cmp_ge_u32 s17, s16
    s_cbranch_scc0 L_gb2_l
L_gb2_d:
    v_mfma_f32_16x16x32_bf16 v[140:143], a[48:51], a[0:3], 0
    ds_read_b128 a[60:63], v169 offset:36864
    v_cvt_pk_bf16_f32 v152, v128, v129
    v_cvt_pk_bf16_f32 v153, v130, v131
    v_mfma_f32_16x16x32_bf16 v[144:147], a[48:51], a[16:19], 0
    ds_read_b128 a[64:67], v185 offset:1024
    v_add_f32 v164, v164, v128
    v_add_f32 v164, v164, v129
    v_mfma_f32_16x16x32_bf16 v[148:151], a[48:51], a[32:35], 0
    s_add_u32 m0, s53, 57344
    v_add_f32 v164, v164, v130
    v_add_f32 v164, v164, v131
    v_mfma_f32_16x16x32_bf16 v[180:183], a[48:51], a[52:55], 0
    ds_read_b128 a[48:51], v169 offset:32768
    v_cvt_pk_bf16_f32 v156, v132, v133
    v_cvt_pk_bf16_f32 v157, v134, v135
    v_mfma_f32_16x16x32_bf16 v[176:179], a[56:59], a[52:55], 0
    ds_read_b128 a[52:55], v168 offset:37888
    buffer_load_dwordx4 v174, s[36:39], s49 offen nt lds
    s_waitcnt lgkmcnt(2)
    v_add_f32 v165, v165, v132
    v_add_f32 v165, v165, v133
    v_mfma_f32_16x16x32_bf16 v[140:143], a[60:63], a[4:7], v[140:143]
    ds_read_b128 a[56:59], v185 offset:2048
    s_add_u32 m0, s53, 58240
    v_add_f32 v165, v165, v134
    v_add_f32 v165, v165, v135
    v_mfma_f32_16x16x32_bf16 v[144:147], a[60:63], a[20:23], v[144:147]
    buffer_load_dwordx4 v174, s[36:39], s49 offen offset:128 nt lds
    s_add_u32 m0, s52, 24576
    v_cvt_pk_bf16_f32 v160, v136, v137
    v_cvt_pk_bf16_f32 v161, v138, v139
    v_mfma_f32_16x16x32_bf16 v[148:151], a[60:63], a[36:39], v[148:151]
    buffer_load_dwordx4 v175, s[40:43], s49 offen nt lds
    s_add_u32 m0, s52, 25472
    v_add_f32 v166, v166, v136
    v_add_f32 v166, v166, v137
    v_mfma_f32_16x16x32_bf16 v[180:183], a[60:63], a[64:67], v[180:183]
    ds_read_b128 a[60:63], v168 offset:33792
    buffer_load_dwordx4 v175, s[40:43], s49 offen offset:128 nt lds
    s_waitcnt lgkmcnt(2)
    v_add_f32 v166, v166, v138
    v_add_f32 v166, v166, v139
    v_mfma_f32_16x16x32_bf16 v[176:179], a[48:51], a[64:67], v[176:179]
    ds_read_b128 a[48:51], v169 offset:37888
    ds_read_b128 a[64:67], v185 offset:3072
    s_add_u32 s49, s49, 8192
    v_mfma_f32_16x16x32_bf16 v[140:143], a[52:55], a[8:11], v[140:143]
    v_mfma_f32_16x16x32_bf16 v[144:147], a[52:55], a[24:27], v[144:147]
    v_mfma_f32_16x16x32_bf16 v[148:151], a[52:55], a[40:43], v[148:151]
    s_waitcnt lgkmcnt(2)
    v_mfma_f32_16x16x32_bf16 v[180:183], a[52:55], a[56:59], v[180:183]
    ds_read_b128 a[52:55], v169 offset:33792
    v_mfma_f32_16x16x32_bf16 v[176:179], a[60:63], a[56:59], v[176:179]
    ds_read_b128 a[56:59], v168 offset:40960
    ds_read_b128 a[60:63], v169 offset:40960
    s_waitcnt lgkmcnt(3)
    v_mfma_f32_16x16x32_bf16 v[140:143], a[48:51], a[12:15], v[140:143]
    v_mfma_f32_16x16x32_bf16 v[144:147], a[48:51], a[28:31], v[144:147]
    v_mfma_f32_16x16x32_bf16 v[148:151], a[48:51], a[44:47], v[148:151]
    v_mfma_f32_16x16x32_bf16 v[180:183], a[48:51], a[64:67], v[180:183]
    ds_read_b128 a[48:51], v168 offset:41984
    s_waitcnt lgkmcnt(2)
    s_nop 2
    v_exp_f32 v140, v140
    v_mfma_f32_16x16x32_bf16 v[176:179], a[52:55], a[64:67], v[176:179]
    ds_read_b128 a[52:55], v169 offset:41984
    v_exp_f32 v141, v141
    v_mfma_f32_16x16x32_bf16 v[128:131], a[56:59], a[0:3], 0
    ds_read_b64_tr_b16 a[64:65], v170 offset:0
    v_exp_f32 v142, v142
    v_mfma_f32_16x16x32_bf16 v[132:135], a[56:59], a[16:19], 0
    ds_read_b64_tr_b16 a[66:67], v170 offset:4096
    v_exp_f32 v143, v143
    v_mfma_f32_16x16x32_bf16 v[136:139], a[56:59], a[32:35], 0
    ds_read_b64_tr_b16 a[56:57], v171 offset:0
    s_waitcnt lgkmcnt(4)
    v_cvt_pk_bf16_f32 v154, v140, v141
    v_cvt_pk_bf16_f32 v155, v142, v143
    v_mfma_f32_16x16x32_bf16 v[128:131], a[60:63], a[4:7], v[128:131]
    ds_read_b64_tr_b16 a[58:59], v171 offset:4096
    v_exp_f32 v144, v144
    v_mfma_f32_16x16x32_bf16 v[132:135], a[60:63], a[20:23], v[132:135]
    v_exp_f32 v145, v145
    v_mfma_f32_16x16x32_bf16 v[136:139], a[60:63], a[36:39], v[136:139]
    ds_read_b64_tr_b16 a[60:61], v172 offset:0
    v_exp_f32 v146, v146
    v_mfma_f32_16x16x32_bf16 v[128:131], a[48:51], a[8:11], v[128:131]
    ds_read_b64_tr_b16 a[62:63], v172 offset:4096
    v_exp_f32 v147, v147
    v_mfma_f32_16x16x32_bf16 v[132:135], a[48:51], a[24:27], v[132:135]
    v_cvt_pk_bf16_f32 v158, v144, v145
    v_cvt_pk_bf16_f32 v159, v146, v147
    v_mfma_f32_16x16x32_bf16 v[136:139], a[48:51], a[40:43], v[136:139]
    ds_read_b64_tr_b16 a[48:49], v173 offset:0
    s_waitcnt lgkmcnt(6)
    v_exp_f32 v148, v148
    v_mfma_f32_16x16x32_bf16 v[128:131], a[52:55], a[12:15], v[128:131]
    ds_read_b64_tr_b16 a[50:51], v173 offset:4096
    v_exp_f32 v149, v149
    v_mfma_f32_16x16x32_bf16 v[132:135], a[52:55], a[28:31], v[132:135]
    v_exp_f32 v150, v150
    v_mfma_f32_16x16x32_bf16 v[136:139], a[52:55], a[44:47], v[136:139]
    ds_read_b64_tr_b16 a[52:53], v170 offset:1024
    s_waitcnt lgkmcnt(6)
    v_exp_f32 v151, v151
    v_mfma_f32_16x16x32_bf16 v[0:3], a[64:67], v[152:155], v[0:3]
    ds_read_b64_tr_b16 a[54:55], v170 offset:5120
    v_cvt_pk_bf16_f32 v162, v148, v149
    v_cvt_pk_bf16_f32 v163, v150, v151
    v_mfma_f32_16x16x32_bf16 v[32:35], a[64:67], v[156:159], v[32:35]
    ds_read_b64_tr_b16 a[64:65], v171 offset:1024
    s_waitcnt lgkmcnt(6)
    v_exp_f32 v176, v176
    v_mfma_f32_16x16x32_bf16 v[4:7], a[56:59], v[152:155], v[4:7]
    ds_read_b64_tr_b16 a[66:67], v171 offset:5120
    v_exp_f32 v177, v177
    v_mfma_f32_16x16x32_bf16 v[36:39], a[56:59], v[156:159], v[36:39]
    ds_read_b64_tr_b16 a[56:57], v172 offset:1024
    s_waitcnt lgkmcnt(6)
    v_exp_f32 v178, v178
    v_mfma_f32_16x16x32_bf16 v[8:11], a[60:63], v[152:155], v[8:11]
    ds_read_b64_tr_b16 a[58:59], v172 offset:5120
    v_exp_f32 v179, v179
    v_mfma_f32_16x16x32_bf16 v[40:43], a[60:63], v[156:159], v[40:43]
    ds_read_b64_tr_b16 a[60:61], v173 offset:1024
    s_waitcnt lgkmcnt(6)
    v_exp_f32 v180, v180
    v_mfma_f32_16x16x32_bf16 v[12:15], a[48:51], v[152:155], v[12:15]
    ds_read_b64_tr_b16 a[62:63], v173 offset:5120
    v_exp_f32 v181, v181
    v_mfma_f32_16x16x32_bf16 v[44:47], a[48:51], v[156:159], v[44:47]
    ds_read_b64_tr_b16 a[48:49], v170 offset:0
    s_waitcnt lgkmcnt(6)
    v_exp_f32 v182, v182
    v_mfma_f32_16x16x32_bf16 v[16:19], a[52:55], v[152:155], v[16:19]
    ds_read_b64_tr_b16 a[50:51], v170 offset:4096
    v_exp_f32 v183, v183
    v_mfma_f32_16x16x32_bf16 v[48:51], a[52:55], v[156:159], v[48:51]
    ds_read_b64_tr_b16 a[52:53], v171 offset:0
    s_waitcnt lgkmcnt(6)
    v_add_f32 v167, v167, v176
    v_add_f32 v167, v167, v177
    v_mfma_f32_16x16x32_bf16 v[20:23], a[64:67], v[152:155], v[20:23]
    ds_read_b64_tr_b16 a[54:55], v171 offset:4096
    v_add_f32 v167, v167, v178
    v_add_f32 v167, v167, v179
    v_mfma_f32_16x16x32_bf16 v[52:55], a[64:67], v[156:159], v[52:55]
    ds_read_b64_tr_b16 a[64:65], v172 offset:0
    s_waitcnt lgkmcnt(6)
    v_add_f32 v167, v167, v180
    v_add_f32 v167, v167, v181
    v_mfma_f32_16x16x32_bf16 v[24:27], a[56:59], v[152:155], v[24:27]
    ds_read_b64_tr_b16 a[66:67], v172 offset:4096
    v_add_f32 v167, v167, v182
    v_add_f32 v167, v167, v183
    v_mfma_f32_16x16x32_bf16 v[56:59], a[56:59], v[156:159], v[56:59]
    ds_read_b64_tr_b16 a[56:57], v173 offset:0
    s_waitcnt lgkmcnt(6)
    v_cvt_pk_bf16_f32 v176, v176, v177
    v_cvt_pk_bf16_f32 v177, v178, v179
    v_mfma_f32_16x16x32_bf16 v[28:31], a[60:63], v[152:155], v[28:31]
    ds_read_b64_tr_b16 a[58:59], v173 offset:4096
    v_cvt_pk_bf16_f32 v178, v180, v181
    v_cvt_pk_bf16_f32 v179, v182, v183
    v_mfma_f32_16x16x32_bf16 v[60:63], a[60:63], v[156:159], v[60:63]
    ds_read_b64_tr_b16 a[60:61], v170 offset:1024
    s_waitcnt lgkmcnt(6)
    v_add_f32 v164, v164, v140
    v_add_f32 v164, v164, v141
    v_mfma_f32_16x16x32_bf16 v[64:67], a[48:51], v[160:163], v[64:67]
    ds_read_b64_tr_b16 a[62:63], v170 offset:5120
    v_add_f32 v164, v164, v142
    v_add_f32 v164, v164, v143
    v_mfma_f32_16x16x32_bf16 v[96:99], a[48:51], v[176:179], v[96:99]
    ds_read_b64_tr_b16 a[48:49], v171 offset:1024
    s_waitcnt lgkmcnt(6)
    v_add_f32 v165, v165, v144
    v_add_f32 v165, v165, v145
    v_mfma_f32_16x16x32_bf16 v[68:71], a[52:55], v[160:163], v[68:71]
    ds_read_b64_tr_b16 a[50:51], v171 offset:5120
    v_add_f32 v165, v165, v146
    v_add_f32 v165, v165, v147
    v_mfma_f32_16x16x32_bf16 v[100:103], a[52:55], v[176:179], v[100:103]
    ds_read_b64_tr_b16 a[52:53], v172 offset:1024
    s_waitcnt lgkmcnt(6)
    v_add_f32 v166, v166, v148
    v_add_f32 v166, v166, v149
    v_mfma_f32_16x16x32_bf16 v[72:75], a[64:67], v[160:163], v[72:75]
    ds_read_b64_tr_b16 a[54:55], v172 offset:5120
    v_add_f32 v166, v166, v150
    v_add_f32 v166, v166, v151
    v_mfma_f32_16x16x32_bf16 v[104:107], a[64:67], v[176:179], v[104:107]
    ds_read_b64_tr_b16 a[64:65], v173 offset:1024
    s_waitcnt lgkmcnt(6)
    v_exp_f32 v128, v128
    v_mfma_f32_16x16x32_bf16 v[76:79], a[56:59], v[160:163], v[76:79]
    ds_read_b64_tr_b16 a[66:67], v173 offset:5120
    v_exp_f32 v129, v129
    v_mfma_f32_16x16x32_bf16 v[108:111], a[56:59], v[176:179], v[108:111]
    s_waitcnt lgkmcnt(5)
    v_exp_f32 v130, v130
    v_mfma_f32_16x16x32_bf16 v[80:83], a[60:63], v[160:163], v[80:83]
    v_exp_f32 v131, v131
    v_mfma_f32_16x16x32_bf16 v[112:115], a[60:63], v[176:179], v[112:115]
    s_waitcnt lgkmcnt(3)
    v_exp_f32 v132, v132
    v_mfma_f32_16x16x32_bf16 v[84:87], a[48:51], v[160:163], v[84:87]
    v_exp_f32 v133, v133
    v_mfma_f32_16x16x32_bf16 v[116:119], a[48:51], v[176:179], v[116:119]
    s_waitcnt lgkmcnt(1)
    v_exp_f32 v134, v134
    v_mfma_f32_16x16x32_bf16 v[88:91], a[52:55], v[160:163], v[88:91]
    v_exp_f32 v135, v135
    v_mfma_f32_16x16x32_bf16 v[120:123], a[52:55], v[176:179], v[120:123]
    s_waitcnt lgkmcnt(0)
    v_exp_f32 v136, v136
    v_mfma_f32_16x16x32_bf16 v[92:95], a[64:67], v[160:163], v[92:95]
    v_exp_f32 v137, v137
    v_mfma_f32_16x16x32_bf16 v[124:127], a[64:67], v[176:179], v[124:127]
    v_exp_f32 v138, v138
    v_exp_f32 v139, v139
L_concat_heads__mha_block_cached__gqa_block_cached__near_ridge_kernel_f_j0:
    s_cmp_eq_u32 s55, 1
    s_cbranch_scc1 L_concat_heads__mha_block_cached__gqa_block_cached__near_ridge_kernel_f_o1
    ds_read_b128 a[48:51], v168 offset:45056
    ds_read_b128 a[52:55], v169 offset:45056
    ds_read_b128 a[56:59], v168 offset:46080
    s_waitcnt vmcnt(6)
    s_add_u32 s16, s16, 4
    v_mov_b32 v187, 1
    s_mov_b64 exec, 1
    ds_add_rtn_u32 v187, v186, v187
    s_mov_b64 exec, -1
    s_waitcnt lgkmcnt(0)
    v_readfirstlane_b32 s17, v187
    s_nop 0
    s_add_u32 s17, s17, 1
    s_cmp_ge_u32 s17, s16
    s_cbranch_scc1 L_gb3_d
    s_mov_b32 s18, 0
L_gb3_l:
    ds_read_b32 v187, v186
    s_add_u32 s18, s18, 1
    s_cmp_ge_u32 s18, 0x200000
    s_cbranch_scc1 L_gb3_d
    s_waitcnt lgkmcnt(0)
    v_readfirstlane_b32 s17, v187
    s_nop 0
    s_cmp_ge_u32 s17, s16
    s_cbranch_scc0 L_gb3_l
L_gb3_d:
    v_mfma_f32_16x16x32_bf16 v[140:143], a[48:51], a[0:3], 0
    ds_read_b128 a[60:63], v169 offset:46080
    v_cvt_pk_bf16_f32 v152, v128, v129
    v_cvt_pk_bf16_f32 v153, v130, v131
    v_mfma_f32_16x16x32_bf16 v[144:147], a[48:51], a[16:19], 0
    ds_read_b128 a[64:67], v168 offset:49152
    v_add_f32 v164, v164, v128
    v_add_f32 v164, v164, v129
    v_mfma_f32_16x16x32_bf16 v[148:151], a[48:51], a[32:35], 0
    ds_read_b128 a[48:51], v169 offset:49152
    v_add_f32 v164, v164, v130
    v_add_f32 v164, v164, v131
    v_mfma_f32_16x16x32_bf16 v[140:143], a[52:55], a[4:7], v[140:143]
    s_add_u32 m0, s53, 32768
    v_cvt_pk_bf16_f32 v156, v132, v133
    v_cvt_pk_bf16_f32 v157, v134, v135
    v_mfma_f32_16x16x32_bf16 v[144:147], a[52:55], a[20:23], v[144:147]
    buffer_load_dwordx4 v174, s[36:39], s49 offen nt lds
    s_add_u32 m0, s53, 33664
    v_add_f32 v165, v165, v132
    v_add_f32 v165, v165, v133
    v_mfma_f32_16x16x32_bf16 v[148:151], a[52:55], a[36:39], v[148:151]
    ds_read_b128 a[52:55], v168 offset:50176
    buffer_load_dwordx4 v174, s[36:39], s49 offen offset:128 nt lds
    v_add_f32 v165, v165, v134
    v_add_f32 v165, v165, v135
    v_mfma_f32_16x16x32_bf16 v[140:143], a[56:59], a[8:11], v[140:143]
    s_add_u32 m0, s52, 0
    s_nop 0
    buffer_load_dwordx4 v175, s[40:43], s49 offen nt lds
    v_cvt_pk_bf16_f32 v160, v136, v137
    v_cvt_pk_bf16_f32 v161, v138, v139
    v_mfma_f32_16x16x32_bf16 v[144:147], a[56:59], a[24:27], v[144:147]
    s_add_u32 m0, s52, 896
    s_nop 0
    buffer_load_dwordx4 v175, s[40:43], s49 offen offset:128 nt lds
    v_add_f32 v166, v166, v136
    v_add_f32 v166, v166, v137
    v_mfma_f32_16x16x32_bf16 v[148:151], a[56:59], a[40:43], v[148:151]
    ds_read_b128 a[56:59], v169 offset:50176
    s_add_u32 s49, s49, 8192
    s_waitcnt lgkmcnt(3)
    v_add_f32 v166, v166, v138
    v_add_f32 v166, v166, v139
    v_mfma_f32_16x16x32_bf16 v[140:143], a[60:63], a[12:15], v[140:143]
    v_mfma_f32_16x16x32_bf16 v[144:147], a[60:63], a[28:31], v[144:147]
    v_mfma_f32_16x16x32_bf16 v[148:151], a[60:63], a[44:47], v[148:151]
    ds_read_b64_tr_b16 a[60:61], v170 offset:8192
    ds_read_b64_tr_b16 a[62:63], v170 offset:12288
    v_mfma_f32_16x16x32_bf16 v[128:131], a[64:67], a[0:3], 0
    s_nop 2
    v_exp_f32 v140, v140
    v_mfma_f32_16x16x32_bf16 v[132:135], a[64:67], a[16:19], 0
    v_exp_f32 v141, v141
    v_mfma_f32_16x16x32_bf16 v[136:139], a[64:67], a[32:35], 0
    ds_read_b64_tr_b16 a[64:65], v171 offset:8192
    s_waitcnt lgkmcnt(4)
    v_exp_f32 v142, v142
    v_mfma_f32_16x16x32_bf16 v[128:131], a[48:51], a[4:7], v[128:131]
    ds_read_b64_tr_b16 a[66:67], v171 offset:12288
    v_exp_f32 v143, v143
    v_mfma_f32_16x16x32_bf16 v[132:135], a[48:51], a[20:23], v[132:135]
    v_cvt_pk_bf16_f32 v154, v140, v141
    v_cvt_pk_bf16_f32 v155, v142, v143
    v_mfma_f32_16x16x32_bf16 v[136:139], a[48:51], a[36:39], v[136:139]
    ds_read_b64_tr_b16 a[48:49], v172 offset:8192
    v_exp_f32 v144, v144
    v_mfma_f32_16x16x32_bf16 v[128:131], a[52:55], a[8:11], v[128:131]
    ds_read_b64_tr_b16 a[50:51], v172 offset:12288
    v_exp_f32 v145, v145
    v_mfma_f32_16x16x32_bf16 v[132:135], a[52:55], a[24:27], v[132:135]
    v_exp_f32 v146, v146
    v_mfma_f32_16x16x32_bf16 v[136:139], a[52:55], a[40:43], v[136:139]
    ds_read_b64_tr_b16 a[52:53], v173 offset:8192
    s_waitcnt lgkmcnt(6)
    v_exp_f32 v147, v147
    v_mfma_f32_16x16x32_bf16 v[128:131], a[56:59], a[12:15], v[128:131]
    ds_read_b64_tr_b16 a[54:55], v173 offset:12288
    v_cvt_pk_bf16_f32 v158, v144, v145
    v_cvt_pk_bf16_f32 v159, v146, v147
    v_mfma_f32_16x16x32_bf16 v[132:135], a[56:59], a[28:31], v[132:135]
    v_exp_f32 v148, v148
    v_mfma_f32_16x16x32_bf16 v[136:139], a[56:59], a[44:47], v[136:139]
    ds_read_b64_tr_b16 a[56:57], v170 offset:9216
    s_waitcnt lgkmcnt(6)
    v_exp_f32 v149, v149
    v_mfma_f32_16x16x32_bf16 v[0:3], a[60:63], v[152:155], v[0:3]
    ds_read_b64_tr_b16 a[58:59], v170 offset:13312
    v_exp_f32 v150, v150
    v_mfma_f32_16x16x32_bf16 v[32:35], a[60:63], v[156:159], v[32:35]
    v_exp_f32 v151, v151
    v_cvt_pk_bf16_f32 v162, v148, v149
    v_cvt_pk_bf16_f32 v163, v150, v151
    s_nop 1
    v_mfma_f32_16x16x32_bf16 v[64:67], a[60:63], v[160:163], v[64:67]
    ds_read_b64_tr_b16 a[60:61], v171 offset:9216
    s_waitcnt lgkmcnt(6)
    v_add_f32 v164, v164, v140
    v_add_f32 v164, v164, v141
    v_mfma_f32_16x16x32_bf16 v[4:7], a[64:67], v[152:155], v[4:7]
    ds_read_b64_tr_b16 a[62:63], v171 offset:13312
    v_add_f32 v164, v164, v142
    v_add_f32 v164, v164, v143
    v_mfma_f32_16x16x32_bf16 v[36:39], a[64:67], v[156:159], v[36:39]
    v_add_f32 v165, v165, v144
    v_add_f32 v165, v165, v145
    v_mfma_f32_16x16x32_bf16 v[68:71], a[64:67], v[160:163], v[68:71]
    ds_read_b64_tr_b16 a[64:65], v172 offset:9216
    s_waitcnt lgkmcnt(6)
    v_add_f32 v165, v165, v146
    v_add_f32 v165, v165, v147
    v_mfma_f32_16x16x32_bf16 v[8:11], a[48:51], v[152:155], v[8:11]
    ds_read_b64_tr_b16 a[66:67], v172 offset:13312
    v_add_f32 v166, v166, v148
    v_add_f32 v166, v166, v149
    v_mfma_f32_16x16x32_bf16 v[40:43], a[48:51], v[156:159], v[40:43]
    v_add_f32 v166, v166, v150
    v_add_f32 v166, v166, v151
    v_mfma_f32_16x16x32_bf16 v[72:75], a[48:51], v[160:163], v[72:75]
    ds_read_b64_tr_b16 a[48:49], v173 offset:9216
    s_waitcnt lgkmcnt(6)
    v_exp_f32 v128, v128
    v_mfma_f32_16x16x32_bf16 v[12:15], a[52:55], v[152:155], v[12:15]
    ds_read_b64_tr_b16 a[50:51], v173 offset:13312
    v_exp_f32 v129, v129
    v_mfma_f32_16x16x32_bf16 v[44:47], a[52:55], v[156:159], v[44:47]
    v_exp_f32 v130, v130
    v_mfma_f32_16x16x32_bf16 v[76:79], a[52:55], v[160:163], v[76:79]
    s_waitcnt lgkmcnt(5)
    v_exp_f32 v131, v131
    v_mfma_f32_16x16x32_bf16 v[16:19], a[56:59], v[152:155], v[16:19]
    v_exp_f32 v132, v132
    v_mfma_f32_16x16x32_bf16 v[48:51], a[56:59], v[156:159], v[48:51]
    v_exp_f32 v133, v133
    v_mfma_f32_16x16x32_bf16 v[80:83], a[56:59], v[160:163], v[80:83]
    s_waitcnt lgkmcnt(3)
    v_exp_f32 v134, v134
    v_mfma_f32_16x16x32_bf16 v[20:23], a[60:63], v[152:155], v[20:23]
    v_exp_f32 v135, v135
    v_mfma_f32_16x16x32_bf16 v[52:55], a[60:63], v[156:159], v[52:55]
    v_exp_f32 v136, v136
    v_mfma_f32_16x16x32_bf16 v[84:87], a[60:63], v[160:163], v[84:87]
    s_waitcnt lgkmcnt(1)
    v_exp_f32 v137, v137
    v_mfma_f32_16x16x32_bf16 v[24:27], a[64:67], v[152:155], v[24:27]
    v_exp_f32 v138, v138
    v_mfma_f32_16x16x32_bf16 v[56:59], a[64:67], v[156:159], v[56:59]
    v_exp_f32 v139, v139
    v_mfma_f32_16x16x32_bf16 v[88:91], a[64:67], v[160:163], v[88:91]
    s_waitcnt lgkmcnt(0)
    v_mfma_f32_16x16x32_bf16 v[28:31], a[48:51], v[152:155], v[28:31]
    v_mfma_f32_16x16x32_bf16 v[60:63], a[48:51], v[156:159], v[60:63]
    v_mfma_f32_16x16x32_bf16 v[92:95], a[48:51], v[160:163], v[92:95]
    s_branch L_concat_heads__mha_block_cached__gqa_block_cached__near_ridge_kernel_f_j1
L_concat_heads__mha_block_cached__gqa_block_cached__near_ridge_kernel_f_o1:
    ds_read_b128 a[48:51], v168 offset:45056
    ds_read_b128 a[52:55], v185 offset:0
    ds_read_b128 a[56:59], v168 offset:40960
    s_waitcnt vmcnt(6)
    s_add_u32 s16, s16, 4
    v_mov_b32 v187, 1
    s_mov_b64 exec, 1
    ds_add_rtn_u32 v187, v186, v187
    s_mov_b64 exec, -1
    s_waitcnt lgkmcnt(0)
    v_readfirstlane_b32 s17, v187
    s_nop 0
    s_add_u32 s17, s17, 1
    s_cmp_ge_u32 s17, s16
    s_cbranch_scc1 L_gb4_d
    s_mov_b32 s18, 0
L_gb4_l:
    ds_read_b32 v187, v186
    s_add_u32 s18, s18, 1
    s_cmp_ge_u32 s18, 0x200000
    s_cbranch_scc1 L_gb4_d
    s_waitcnt lgkmcnt(0)
    v_readfirstlane_b32 s17, v187
    s_nop 0
    s_cmp_ge_u32 s17, s16
    s_cbranch_scc0 L_gb4_l
L_gb4_d:
    v_mfma_f32_16x16x32_bf16 v[140:143], a[48:51], a[0:3], 0
    ds_read_b128 a[60:63], v169 offset:45056
    v_cvt_pk_bf16_f32 v152, v128, v129
    v_cvt_pk_bf16_f32 v153, v130, v131
    v_mfma_f32_16x16x32_bf16 v[144:147], a[48:51], a[16:19], 0
    ds_read_b128 a[64:67], v185 offset:1024
    v_add_f32 v164, v164, v128
    v_add_f32 v164, v164, v129
    v_mfma_f32_16x16x32_bf16 v[148:151], a[48:51], a[32:35], 0
    s_add_u32 m0, s53, 32768
    v_add_f32 v164, v164, v130
    v_add_f32 v164, v164, v131
    v_mfma_f32_16x16x32_bf16 v[180:183], a[48:51], a[52:55], 0
    ds_read_b128 a[48:51], v169 offset:40960
    v_cvt_pk_bf16_f32 v156, v132, v133
    v_cvt_pk_bf16_f32 v157, v134, v135
    v_mfma_f32_16x16x32_bf16 v[176:179], a[56:59], a[52:55], 0
    ds_read_b128 a[52:55], v168 offset:46080
    buffer_load_dwordx4 v174, s[36:39], s49 offen nt lds
    s_waitcnt lgkmcnt(2)
    v_add_f32 v165, v165, v132
    v_add_f32 v165, v165, v133
    v_mfma_f32_16x16x32_bf16 v[140:143], a[60:63], a[4:7], v[140:143]
    ds_read_b128 a[56:59], v185 offset:2048
    s_add_u32 m0, s53, 33664
    v_add_f32 v165, v165, v134
    v_add_f32 v165, v165, v135
    v_mfma_f32_16x16x32_bf16 v[144:147], a[60:63], a[20:23], v[144:147]
    buffer_load_dwordx4 v174, s[36:39], s49 offen offset:128 nt lds
    s_add_u32 m0, s52, 0
    v_cvt_pk_bf16_f32 v160, v136, v137
    v_cvt_pk_bf16_f32 v161, v138, v139
    v_mfma_f32_16x16x32_bf16 v[148:151], a[60:63], a[36:39], v[148:151]
    buffer_load_dwordx4 v175, s[40:43], s49 offen nt lds
    s_add_u32 m0, s52, 896
    v_add_f32 v166, v166, v136
    v_add_f32 v166, v166, v137
    v_mfma_f32_16x16x32_bf16 v[180:183], a[60:63], a[64:67], v[180:183]
    ds_read_b128 a[60:63], v168 offset:41984
    buffer_load_dwordx4 v175, s[40:43], s49 offen offset:128 nt lds
    s_waitcnt lgkmcnt(2)
    v_add_f32 v166, v166, v138
    v_add_f32 v166, v166, v139
    v_mfma_f32_16x16x32_bf16 v[176:179], a[48:51], a[64:67], v[176:179]
    ds_read_b128 a[48:51], v169 offset:46080
    ds_read_b128 a[64:67], v185 offset:3072
    s_add_u32 s49, s49, 8192
    v_mfma_f32_16x16x32_bf16 v[140:143], a[52:55], a[8:11], v[140:143]
    v_mfma_f32_16x16x32_bf16 v[144:147], a[52:55], a[24:27], v[144:147]
    v_mfma_f32_16x16x32_bf16 v[148:151], a[52:55], a[40:43], v[148:151]
    s_waitcnt lgkmcnt(2)
    v_mfma_f32_16x16x32_bf16 v[180:183], a[52:55], a[56:59], v[180:183]
    ds_read_b128 a[52:55], v169 offset:41984
    v_mfma_f32_16x16x32_bf16 v[176:179], a[60:63], a[56:59], v[176:179]
    ds_read_b128 a[56:59], v168 offset:49152
    ds_read_b128 a[60:63], v169 offset:49152
    s_waitcnt lgkmcnt(3)
    v_mfma_f32_16x16x32_bf16 v[140:143], a[48:51], a[12:15], v[140:143]
    v_mfma_f32_16x16x32_bf16 v[144:147], a[48:51], a[28:31], v[144:147]
    v_mfma_f32_16x16x32_bf16 v[148:151], a[48:51], a[44:47], v[148:151]
    v_mfma_f32_16x16x32_bf16 v[180:183], a[48:51], a[64:67], v[180:183]
    ds_read_b128 a[48:51], v168 offset:50176
    s_waitcnt lgkmcnt(2)
    s_nop 2
    v_exp_f32 v140, v140
    v_mfma_f32_16x16x32_bf16 v[176:179], a[52:55], a[64:67], v[176:179]
    ds_read_b128 a[52:55], v169 offset:50176
    v_exp_f32 v141, v141
    v_mfma_f32_16x16x32_bf16 v[128:131], a[56:59], a[0:3], 0
    ds_read_b64_tr_b16 a[64:65], v170 offset:8192
    v_exp_f32 v142, v142
    v_mfma_f32_16x16x32_bf16 v[132:135], a[56:59], a[16:19], 0
    ds_read_b64_tr_b16 a[66:67], v170 offset:12288
    v_exp_f32 v143, v143
    v_mfma_f32_16x16x32_bf16 v[136:139], a[56:59], a[32:35], 0
    ds_read_b64_tr_b16 a[56:57], v171 offset:8192
    s_waitcnt lgkmcnt(4)
    v_cvt_pk_bf16_f32 v154, v140, v141
    v_cvt_pk_bf16_f32 v155, v142, v143
    v_mfma_f32_16x16x32_bf16 v[128:131], a[60:63], a[4:7], v[128:131]
    ds_read_b64_tr_b16 a[58:59], v171 offset:12288
    v_exp_f32 v144, v144
    v_mfma_f32_16x16x32_bf16 v[132:135], a[60:63], a[20:23], v[132:135]
    v_exp_f32 v145, v145
    v_mfma_f32_16x16x32_bf16 v[136:139], a[60:63], a[36:39], v[136:139]
    ds_read_b64_tr_b16 a[60:61], v172 offset:8192
    v_exp_f32 v146, v146
    v_mfma_f32_16x16x32_bf16 v[128:131], a[48:51], a[8:11], v[128:131]
    ds_read_b64_tr_b16 a[62:63], v172 offset:12288
    v_exp_f32 v147, v147
    v_mfma_f32_16x16x32_bf16 v[132:135], a[48:51], a[24:27], v[132:135]
    v_cvt_pk_bf16_f32 v158, v144, v145
    v_cvt_pk_bf16_f32 v159, v146, v147
    v_mfma_f32_16x16x32_bf16 v[136:139], a[48:51], a[40:43], v[136:139]
    ds_read_b64_tr_b16 a[48:49], v173 offset:8192
    s_waitcnt lgkmcnt(6)
    v_exp_f32 v148, v148
    v_mfma_f32_16x16x32_bf16 v[128:131], a[52:55], a[12:15], v[128:131]
    ds_read_b64_tr_b16 a[50:51], v173 offset:12288
    v_exp_f32 v149, v149
    v_mfma_f32_16x16x32_bf16 v[132:135], a[52:55], a[28:31], v[132:135]
    v_exp_f32 v150, v150
    v_mfma_f32_16x16x32_bf16 v[136:139], a[52:55], a[44:47], v[136:139]
    ds_read_b64_tr_b16 a[52:53], v170 offset:9216
    s_waitcnt lgkmcnt(6)
    v_exp_f32 v151, v151
    v_mfma_f32_16x16x32_bf16 v[0:3], a[64:67], v[152:155], v[0:3]
    ds_read_b64_tr_b16 a[54:55], v170 offset:13312
    v_cvt_pk_bf16_f32 v162, v148, v149
    v_cvt_pk_bf16_f32 v163, v150, v151
    v_mfma_f32_16x16x32_bf16 v[32:35], a[64:67], v[156:159], v[32:35]
    ds_read_b64_tr_b16 a[64:65], v171 offset:9216
    s_waitcnt lgkmcnt(6)
    v_exp_f32 v176, v176
    v_mfma_f32_16x16x32_bf16 v[4:7], a[56:59], v[152:155], v[4:7]
    ds_read_b64_tr_b16 a[66:67], v171 offset:13312
    v_exp_f32 v177, v177
    v_mfma_f32_16x16x32_bf16 v[36:39], a[56:59], v[156:159], v[36:39]
    ds_read_b64_tr_b16 a[56:57], v172 offset:9216
    s_waitcnt lgkmcnt(6)
    v_exp_f32 v178, v178
    v_mfma_f32_16x16x32_bf16 v[8:11], a[60:63], v[152:155], v[8:11]
    ds_read_b64_tr_b16 a[58:59], v172 offset:13312
    v_exp_f32 v179, v179
    v_mfma_f32_16x16x32_bf16 v[40:43], a[60:63], v[156:159], v[40:43]
    ds_read_b64_tr_b16 a[60:61], v173 offset:9216
    s_waitcnt lgkmcnt(6)
    v_exp_f32 v180, v180
    v_mfma_f32_16x16x32_bf16 v[12:15], a[48:51], v[152:155], v[12:15]
    ds_read_b64_tr_b16 a[62:63], v173 offset:13312
    v_exp_f32 v181, v181
    v_mfma_f32_16x16x32_bf16 v[44:47], a[48:51], v[156:159], v[44:47]
    ds_read_b64_tr_b16 a[48:49], v170 offset:8192
    s_waitcnt lgkmcnt(6)
    v_exp_f32 v182, v182
    v_mfma_f32_16x16x32_bf16 v[16:19], a[52:55], v[152:155], v[16:19]
    ds_read_b64_tr_b16 a[50:51], v170 offset:12288
    v_exp_f32 v183, v183
    v_mfma_f32_16x16x32_bf16 v[48:51], a[52:55], v[156:159], v[48:51]
    ds_read_b64_tr_b16 a[52:53], v171 offset:8192
    s_waitcnt lgkmcnt(6)
    v_add_f32 v167, v167, v176
    v_add_f32 v167, v167, v177
    v_mfma_f32_16x16x32_bf16 v[20:23], a[64:67], v[152:155], v[20:23]
    ds_read_b64_tr_b16 a[54:55], v171 offset:12288
    v_add_f32 v167, v167, v178
    v_add_f32 v167, v167, v179
    v_mfma_f32_16x16x32_bf16 v[52:55], a[64:67], v[156:159], v[52:55]
    ds_read_b64_tr_b16 a[64:65], v172 offset:8192
    s_waitcnt lgkmcnt(6)
    v_add_f32 v167, v167, v180
    v_add_f32 v167, v167, v181
    v_mfma_f32_16x16x32_bf16 v[24:27], a[56:59], v[152:155], v[24:27]
    ds_read_b64_tr_b16 a[66:67], v172 offset:12288
    v_add_f32 v167, v167, v182
    v_add_f32 v167, v167, v183
    v_mfma_f32_16x16x32_bf16 v[56:59], a[56:59], v[156:159], v[56:59]
    ds_read_b64_tr_b16 a[56:57], v173 offset:8192
    s_waitcnt lgkmcnt(6)
    v_cvt_pk_bf16_f32 v176, v176, v177
    v_cvt_pk_bf16_f32 v177, v178, v179
    v_mfma_f32_16x16x32_bf16 v[28:31], a[60:63], v[152:155], v[28:31]
    ds_read_b64_tr_b16 a[58:59], v173 offset:12288
    v_cvt_pk_bf16_f32 v178, v180, v181
    v_cvt_pk_bf16_f32 v179, v182, v183
    v_mfma_f32_16x16x32_bf16 v[60:63], a[60:63], v[156:159], v[60:63]
    ds_read_b64_tr_b16 a[60:61], v170 offset:9216
    s_waitcnt lgkmcnt(6)
    v_add_f32 v164, v164, v140
    v_add_f32 v164, v164, v141
    v_mfma_f32_16x16x32_bf16 v[64:67], a[48:51], v[160:163], v[64:67]
    ds_read_b64_tr_b16 a[62:63], v170 offset:13312
    v_add_f32 v164, v164, v142
    v_add_f32 v164, v164, v143
    v_mfma_f32_16x16x32_bf16 v[96:99], a[48:51], v[176:179], v[96:99]
    ds_read_b64_tr_b16 a[48:49], v171 offset:9216
    s_waitcnt lgkmcnt(6)
    v_add_f32 v165, v165, v144
    v_add_f32 v165, v165, v145
    v_mfma_f32_16x16x32_bf16 v[68:71], a[52:55], v[160:163], v[68:71]
    ds_read_b64_tr_b16 a[50:51], v171 offset:13312
    v_add_f32 v165, v165, v146
    v_add_f32 v165, v165, v147
    v_mfma_f32_16x16x32_bf16 v[100:103], a[52:55], v[176:179], v[100:103]
    ds_read_b64_tr_b16 a[52:53], v172 offset:9216
    s_waitcnt lgkmcnt(6)
    v_add_f32 v166, v166, v148
    v_add_f32 v166, v166, v149
    v_mfma_f32_16x16x32_bf16 v[72:75], a[64:67], v[160:163], v[72:75]
    ds_read_b64_tr_b16 a[54:55], v172 offset:13312
    v_add_f32 v166, v166, v150
    v_add_f32 v166, v166, v151
    v_mfma_f32_16x16x32_bf16 v[104:107], a[64:67], v[176:179], v[104:107]
    ds_read_b64_tr_b16 a[64:65], v173 offset:9216
    s_waitcnt lgkmcnt(6)
    v_exp_f32 v128, v128
    v_mfma_f32_16x16x32_bf16 v[76:79], a[56:59], v[160:163], v[76:79]
    ds_read_b64_tr_b16 a[66:67], v173 offset:13312
    v_exp_f32 v129, v129
    v_mfma_f32_16x16x32_bf16 v[108:111], a[56:59], v[176:179], v[108:111]
    s_waitcnt lgkmcnt(5)
    v_exp_f32 v130, v130
    v_mfma_f32_16x16x32_bf16 v[80:83], a[60:63], v[160:163], v[80:83]
    v_exp_f32 v131, v131
    v_mfma_f32_16x16x32_bf16 v[112:115], a[60:63], v[176:179], v[112:115]
    s_waitcnt lgkmcnt(3)
    v_exp_f32 v132, v132
    v_mfma_f32_16x16x32_bf16 v[84:87], a[48:51], v[160:163], v[84:87]
    v_exp_f32 v133, v133
    v_mfma_f32_16x16x32_bf16 v[116:119], a[48:51], v[176:179], v[116:119]
    s_waitcnt lgkmcnt(1)
    v_exp_f32 v134, v134
    v_mfma_f32_16x16x32_bf16 v[88:91], a[52:55], v[160:163], v[88:91]
    v_exp_f32 v135, v135
    v_mfma_f32_16x16x32_bf16 v[120:123], a[52:55], v[176:179], v[120:123]
    s_waitcnt lgkmcnt(0)
    v_exp_f32 v136, v136
    v_mfma_f32_16x16x32_bf16 v[92:95], a[64:67], v[160:163], v[92:95]
    v_exp_f32 v137, v137
    v_mfma_f32_16x16x32_bf16 v[124:127], a[64:67], v[176:179], v[124:127]
    v_exp_f32 v138, v138
    v_exp_f32 v139, v139
L_concat_heads__mha_block_cached__gqa_block_cached__near_ridge_kernel_f_j1:
    s_cmp_eq_u32 s55, 2
    s_cbranch_scc1 L_concat_heads__mha_block_cached__gqa_block_cached__near_ridge_kernel_f_o2
    ds_read_b128 a[48:51], v168 offset:53248
    ds_read_b128 a[52:55], v169 offset:53248
    ds_read_b128 a[56:59], v168 offset:54272
    s_waitcnt vmcnt(6)
    s_add_u32 s16, s16, 4
    v_mov_b32 v187, 1
    s_mov_b64 exec, 1
    ds_add_rtn_u32 v187, v186, v187
    s_mov_b64 exec, -1
    s_waitcnt lgkmcnt(0)
    v_readfirstlane_b32 s17, v187
    s_nop 0
    s_add_u32 s17, s17, 1
    s_cmp_ge_u32 s17, s16
    s_cbranch_scc1 L_gb5_d
    s_mov_b32 s18, 0
L_gb5_l:
    ds_read_b32 v187, v186
    s_add_u32 s18, s18, 1
    s_cmp_ge_u32 s18, 0x200000
    s_cbranch_scc1 L_gb5_d
    s_waitcnt lgkmcnt(0)
    v_readfirstlane_b32 s17, v187
    s_nop 0
    s_cmp_ge_u32 s17, s16
    s_cbranch_scc0 L_gb5_l
L_gb5_d:
    v_mfma_f32_16x16x32_bf16 v[140:143], a[48:51], a[0:3], 0
    ds_read_b128 a[60:63], v169 offset:54272
    v_cvt_pk_bf16_f32 v152, v128, v129
    v_cvt_pk_bf16_f32 v153, v130, v131
    v_mfma_f32_16x16x32_bf16 v[144:147], a[48:51], a[16:19], 0
    ds_read_b128 a[64:67], v168 offset:57344
    v_add_f32 v164, v164, v128
    v_add_f32 v164, v164, v129
    v_mfma_f32_16x16x32_bf16 v[148:151], a[48:51], a[32:35], 0
    ds_read_b128 a[48:51], v169 offset:57344
    v_add_f32 v164, v164, v130
    v_add_f32 v164, v164, v131
    v_mfma_f32_16x16x32_bf16 v[140:143], a[52:55], a[4:7], v[140:143]
    s_add_u32 m0, s53, 40960
    v_cvt_pk_bf16_f32 v156, v132, v133
    v_cvt_pk_bf16_f32 v157, v134, v135
    v_mfma_f32_16x16x32_bf16 v[144:147], a[52:55], a[20:23], v[144:147]
    buffer_load_dwordx4 v174, s[36:39], s49 offen nt lds
    s_add_u32 m0, s53, 41856
    v_add_f32 v165, v165, v132
    v_add_f32 v165, v165, v133
    v_mfma_f32_16x16x32_bf16 v[148:151], a[52:55], a[36:39], v[148:151]
    ds_read_b128 a[52:55], v168 offset:58368
    buffer_load_dwordx4 v174, s[36:39], s49 offen offset:128 nt lds
    v_add_f32 v165, v165, v134
    v_add_f32 v165, v165, v135
    v_mfma_f32_16x16x32_bf16 v[140:143], a[56:59], a[8:11], v[140:143]
    s_add_u32 m0, s52, 8192
    s_nop 0
    buffer_load_dwordx4 v175, s[40:43], s49 offen nt lds
    v_cvt_pk_bf16_f32 v160, v136, v137
    v_cvt_pk_bf16_f32 v161, v138, v139
    v_mfma_f32_16x16x32_bf16 v[144:147], a[56:59], a[24:27], v[144:147]
    s_add_u32 m0, s52, 9088
    s_nop 0
    buffer_load_dwordx4 v175, s[40:43], s49 offen offset:128 nt lds
    v_add_f32 v166, v166, v136
    v_add_f32 v166, v166, v137
    v_mfma_f32_16x16x32_bf16 v[148:151], a[56:59], a[40:43], v[148:151]
    ds_read_b128 a[56:59], v169 offset:58368
    s_add_u32 s49, s49, 8192
    s_waitcnt lgkmcnt(3)
    v_add_f32 v166, v166, v138
    v_add_f32 v166, v166, v139
    v_mfma_f32_16x16x32_bf16 v[140:143], a[60:63], a[12:15], v[140:143]
    v_mfma_f32_16x16x32_bf16 v[144:147], a[60:63], a[28:31], v[144:147]
    v_mfma_f32_16x16x32_bf16 v[148:151], a[60:63], a[44:47], v[148:151]
    ds_read_b64_tr_b16 a[60:61], v170 offset:16384
    ds_read_b64_tr_b16 a[62:63], v170 offset:20480
    v_mfma_f32_16x16x32_bf16 v[128:131], a[64:67], a[0:3], 0
    s_nop 2
    v_exp_f32 v140, v140
    v_mfma_f32_16x16x32_bf16 v[132:135], a[64:67], a[16:19], 0
    v_exp_f32 v141, v141
    v_mfma_f32_16x16x32_bf16 v[136:139], a[64:67], a[32:35], 0
    ds_read_b64_tr_b16 a[64:65], v171 offset:16384
    s_waitcnt lgkmcnt(4)
    v_exp_f32 v142, v142
    v_mfma_f32_16x16x32_bf16 v[128:131], a[48:51], a[4:7], v[128:131]
    ds_read_b64_tr_b16 a[66:67], v171 offset:20480
    v_exp_f32 v143, v143
    v_mfma_f32_16x16x32_bf16 v[132:135], a[48:51], a[20:23], v[132:135]
    v_cvt_pk_bf16_f32 v154, v140, v141
    v_cvt_pk_bf16_f32 v155, v142, v143
    v_mfma_f32_16x16x32_bf16 v[136:139], a[48:51], a[36:39], v[136:139]
    ds_read_b64_tr_b16 a[48:49], v172 offset:16384
    v_exp_f32 v144, v144
    v_mfma_f32_16x16x32_bf16 v[128:131], a[52:55], a[8:11], v[128:131]
    ds_read_b64_tr_b16 a[50:51], v172 offset:20480
    v_exp_f32 v145, v145
    v_mfma_f32_16x16x32_bf16 v[132:135], a[52:55], a[24:27], v[132:135]
    v_exp_f32 v146, v146
    v_mfma_f32_16x16x32_bf16 v[136:139], a[52:55], a[40:43], v[136:139]
    ds_read_b64_tr_b16 a[52:53], v173 offset:16384
    s_waitcnt lgkmcnt(6)
    v_exp_f32 v147, v147
    v_mfma_f32_16x16x32_bf16 v[128:131], a[56:59], a[12:15], v[128:131]
    ds_read_b64_tr_b16 a[54:55], v173 offset:20480
    v_cvt_pk_bf16_f32 v158, v144, v145
    v_cvt_pk_bf16_f32 v159, v146, v147
    v_mfma_f32_16x16x32_bf16 v[132:135], a[56:59], a[28:31], v[132:135]
    v_exp_f32 v148, v148
    v_mfma_f32_16x16x32_bf16 v[136:139], a[56:59], a[44:47], v[136:139]
    ds_read_b64_tr_b16 a[56:57], v170 offset:17408
    s_waitcnt lgkmcnt(6)
    v_exp_f32 v149, v149
    v_mfma_f32_16x16x32_bf16 v[0:3], a[60:63], v[152:155], v[0:3]
    ds_read_b64_tr_b16 a[58:59], v170 offset:21504
    v_exp_f32 v150, v150
    v_mfma_f32_16x16x32_bf16 v[32:35], a[60:63], v[156:159], v[32:35]
    v_exp_f32 v151, v151
    v_cvt_pk_bf16_f32 v162, v148, v149
    v_cvt_pk_bf16_f32 v163, v150, v151
    s_nop 1
    v_mfma_f32_16x16x32_bf16 v[64:67], a[60:63], v[160:163], v[64:67]
    ds_read_b64_tr_b16 a[60:61], v171 offset:17408
    s_waitcnt lgkmcnt(6)
    v_add_f32 v164, v164, v140
    v_add_f32 v164, v164, v141
    v_mfma_f32_16x16x32_bf16 v[4:7], a[64:67], v[152:155], v[4:7]
    ds_read_b64_tr_b16 a[62:63], v171 offset:21504
    v_add_f32 v164, v164, v142
    v_add_f32 v164, v164, v143
    v_mfma_f32_16x16x32_bf16 v[36:39], a[64:67], v[156:159], v[36:39]
    v_add_f32 v165, v165, v144
    v_add_f32 v165, v165, v145
    v_mfma_f32_16x16x32_bf16 v[68:71], a[64:67], v[160:163], v[68:71]
    ds_read_b64_tr_b16 a[64:65], v172 offset:17408
    s_waitcnt lgkmcnt(6)
    v_add_f32 v165, v165, v146
    v_add_f32 v165, v165, v147
    v_mfma_f32_16x16x32_bf16 v[8:11], a[48:51], v[152:155], v[8:11]
    ds_read_b64_tr_b16 a[66:67], v172 offset:21504
    v_add_f32 v166, v166, v148
    v_add_f32 v166, v166, v149
    v_mfma_f32_16x16x32_bf16 v[40:43], a[48:51], v[156:159], v[40:43]
    v_add_f32 v166, v166, v150
    v_add_f32 v166, v166, v151
    v_mfma_f32_16x16x32_bf16 v[72:75], a[48:51], v[160:163], v[72:75]
    ds_read_b64_tr_b16 a[48:49], v173 offset:17408
    s_waitcnt lgkmcnt(6)
    v_exp_f32 v128, v128
    v_mfma_f32_16x16x32_bf16 v[12:15], a[52:55], v[152:155], v[12:15]
    ds_read_b64_tr_b16 a[50:51], v173 offset:21504
    v_exp_f32 v129, v129
    v_mfma_f32_16x16x32_bf16 v[44:47], a[52:55], v[156:159], v[44:47]
    v_exp_f32 v130, v130
    v_mfma_f32_16x16x32_bf16 v[76:79], a[52:55], v[160:163], v[76:79]
    s_waitcnt lgkmcnt(5)
    v_exp_f32 v131, v131
    v_mfma_f32_16x16x32_bf16 v[16:19], a[56:59], v[152:155], v[16:19]
    v_exp_f32 v132, v132
    v_mfma_f32_16x16x32_bf16 v[48:51], a[56:59], v[156:159], v[48:51]
    v_exp_f32 v133, v133
    v_mfma_f32_16x16x32_bf16 v[80:83], a[56:59], v[160:163], v[80:83]
    s_waitcnt lgkmcnt(3)
    v_exp_f32 v134, v134
    v_mfma_f32_16x16x32_bf16 v[20:23], a[60:63], v[152:155], v[20:23]
    v_exp_f32 v135, v135
    v_mfma_f32_16x16x32_bf16 v[52:55], a[60:63], v[156:159], v[52:55]
    v_exp_f32 v136, v136
    v_mfma_f32_16x16x32_bf16 v[84:87], a[60:63], v[160:163], v[84:87]
    s_waitcnt lgkmcnt(1)
    v_exp_f32 v137, v137
    v_mfma_f32_16x16x32_bf16 v[24:27], a[64:67], v[152:155], v[24:27]
    v_exp_f32 v138, v138
    v_mfma_f32_16x16x32_bf16 v[56:59], a[64:67], v[156:159], v[56:59]
    v_exp_f32 v139, v139
    v_mfma_f32_16x16x32_bf16 v[88:91], a[64:67], v[160:163], v[88:91]
    s_waitcnt lgkmcnt(0)
    v_mfma_f32_16x16x32_bf16 v[28:31], a[48:51], v[152:155], v[28:31]
    v_mfma_f32_16x16x32_bf16 v[60:63], a[48:51], v[156:159], v[60:63]
    v_mfma_f32_16x16x32_bf16 v[92:95], a[48:51], v[160:163], v[92:95]
    s_branch L_concat_heads__mha_block_cached__gqa_block_cached__near_ridge_kernel_f_j2
L_concat_heads__mha_block_cached__gqa_block_cached__near_ridge_kernel_f_o2:
    ds_read_b128 a[48:51], v168 offset:53248
    ds_read_b128 a[52:55], v185 offset:0
    ds_read_b128 a[56:59], v168 offset:49152
    s_waitcnt vmcnt(6)
    s_add_u32 s16, s16, 4
    v_mov_b32 v187, 1
    s_mov_b64 exec, 1
    ds_add_rtn_u32 v187, v186, v187
    s_mov_b64 exec, -1
    s_waitcnt lgkmcnt(0)
    v_readfirstlane_b32 s17, v187
    s_nop 0
    s_add_u32 s17, s17, 1
    s_cmp_ge_u32 s17, s16
    s_cbranch_scc1 L_gb6_d
    s_mov_b32 s18, 0
L_gb6_l:
    ds_read_b32 v187, v186
    s_add_u32 s18, s18, 1
    s_cmp_ge_u32 s18, 0x200000
    s_cbranch_scc1 L_gb6_d
    s_waitcnt lgkmcnt(0)
    v_readfirstlane_b32 s17, v187
    s_nop 0
    s_cmp_ge_u32 s17, s16
    s_cbranch_scc0 L_gb6_l
L_gb6_d:
    v_mfma_f32_16x16x32_bf16 v[140:143], a[48:51], a[0:3], 0
    ds_read_b128 a[60:63], v169 offset:53248
    v_cvt_pk_bf16_f32 v152, v128, v129
    v_cvt_pk_bf16_f32 v153, v130, v131
    v_mfma_f32_16x16x32_bf16 v[144:147], a[48:51], a[16:19], 0
    ds_read_b128 a[64:67], v185 offset:1024
    v_add_f32 v164, v164, v128
    v_add_f32 v164, v164, v129
    v_mfma_f32_16x16x32_bf16 v[148:151], a[48:51], a[32:35], 0
    s_add_u32 m0, s53, 40960
    v_add_f32 v164, v164, v130
    v_add_f32 v164, v164, v131
    v_mfma_f32_16x16x32_bf16 v[180:183], a[48:51], a[52:55], 0
    ds_read_b128 a[48:51], v169 offset:49152
    v_cvt_pk_bf16_f32 v156, v132, v133
    v_cvt_pk_bf16_f32 v157, v134, v135
    v_mfma_f32_16x16x32_bf16 v[176:179], a[56:59], a[52:55], 0
    ds_read_b128 a[52:55], v168 offset:54272
    buffer_load_dwordx4 v174, s[36:39], s49 offen nt lds
    s_waitcnt lgkmcnt(2)
    v_add_f32 v165, v165, v132
    v_add_f32 v165, v165, v133
    v_mfma_f32_16x16x32_bf16 v[140:143], a[60:63], a[4:7], v[140:143]
    ds_read_b128 a[56:59], v185 offset:2048
    s_add_u32 m0, s53, 41856
    v_add_f32 v165, v165, v134
    v_add_f32 v165, v165, v135
    v_mfma_f32_16x16x32_bf16 v[144:147], a[60:63], a[20:23], v[144:147]
    buffer_load_dwordx4 v174, s[36:39], s49 offen offset:128 nt lds
    s_add_u32 m0, s52, 8192
    v_cvt_pk_bf16_f32 v160, v136, v137
    v_cvt_pk_bf16_f32 v161, v138, v139
    v_mfma_f32_16x16x32_bf16 v[148:151], a[60:63], a[36:39], v[148:151]
    buffer_load_dwordx4 v175, s[40:43], s49 offen nt lds
    s_add_u32 m0, s52, 9088
    v_add_f32 v166, v166, v136
    v_add_f32 v166, v166, v137
    v_mfma_f32_16x16x32_bf16 v[180:183], a[60:63], a[64:67], v[180:183]
    ds_read_b128 a[60:63], v168 offset:50176
    buffer_load_dwordx4 v175, s[40:43], s49 offen offset:128 nt lds
    s_waitcnt lgkmcnt(2)
    v_add_f32 v166, v166, v138
    v_add_f32 v166, v166, v139
    v_mfma_f32_16x16x32_bf16 v[176:179], a[48:51], a[64:67], v[176:179]
    ds_read_b128 a[48:51], v169 offset:54272
    ds_read_b128 a[64:67], v185 offset:3072
    s_add_u32 s49, s49, 8192
    v_mfma_f32_16x16x32_bf16 v[140:143], a[52:55], a[8:11], v[140:143]
    v_mfma_f32_16x16x32_bf16 v[144:147], a[52:55], a[24:27], v[144:147]
    v_mfma_f32_16x16x32_bf16 v[148:151], a[52:55], a[40:43], v[148:151]
    s_waitcnt lgkmcnt(2)
    v_mfma_f32_16x16x32_bf16 v[180:183], a[52:55], a[56:59], v[180:183]
    ds_read_b128 a[52:55], v169 offset:50176
    v_mfma_f32_16x16x32_bf16 v[176:179], a[60:63], a[56:59], v[176:179]
    ds_read_b128 a[56:59], v168 offset:57344
    ds_read_b128 a[60:63], v169 offset:57344
    s_waitcnt lgkmcnt(3)
    v_mfma_f32_16x16x32_bf16 v[140:143], a[48:51], a[12:15], v[140:143]
    v_mfma_f32_16x16x32_bf16 v[144:147], a[48:51], a[28:31], v[144:147]
    v_mfma_f32_16x16x32_bf16 v[148:151], a[48:51], a[44:47], v[148:151]
    v_mfma_f32_16x16x32_bf16 v[180:183], a[48:51], a[64:67], v[180:183]
    ds_read_b128 a[48:51], v168 offset:58368
    s_waitcnt lgkmcnt(2)
    s_nop 2
    v_exp_f32 v140, v140
    v_mfma_f32_16x16x32_bf16 v[176:179], a[52:55], a[64:67], v[176:179]
    ds_read_b128 a[52:55], v169 offset:58368
    v_exp_f32 v141, v141
    v_mfma_f32_16x16x32_bf16 v[128:131], a[56:59], a[0:3], 0
    ds_read_b64_tr_b16 a[64:65], v170 offset:16384
    v_exp_f32 v142, v142
    v_mfma_f32_16x16x32_bf16 v[132:135], a[56:59], a[16:19], 0
    ds_read_b64_tr_b16 a[66:67], v170 offset:20480
    v_exp_f32 v143, v143
    v_mfma_f32_16x16x32_bf16 v[136:139], a[56:59], a[32:35], 0
    ds_read_b64_tr_b16 a[56:57], v171 offset:16384
    s_waitcnt lgkmcnt(4)
    v_cvt_pk_bf16_f32 v154, v140, v141
    v_cvt_pk_bf16_f32 v155, v142, v143
    v_mfma_f32_16x16x32_bf16 v[128:131], a[60:63], a[4:7], v[128:131]
    ds_read_b64_tr_b16 a[58:59], v171 offset:20480
    v_exp_f32 v144, v144
    v_mfma_f32_16x16x32_bf16 v[132:135], a[60:63], a[20:23], v[132:135]
    v_exp_f32 v145, v145
    v_mfma_f32_16x16x32_bf16 v[136:139], a[60:63], a[36:39], v[136:139]
    ds_read_b64_tr_b16 a[60:61], v172 offset:16384
    v_exp_f32 v146, v146
    v_mfma_f32_16x16x32_bf16 v[128:131], a[48:51], a[8:11], v[128:131]
    ds_read_b64_tr_b16 a[62:63], v172 offset:20480
    v_exp_f32 v147, v147
    v_mfma_f32_16x16x32_bf16 v[132:135], a[48:51], a[24:27], v[132:135]
    v_cvt_pk_bf16_f32 v158, v144, v145
    v_cvt_pk_bf16_f32 v159, v146, v147
    v_mfma_f32_16x16x32_bf16 v[136:139], a[48:51], a[40:43], v[136:139]
    ds_read_b64_tr_b16 a[48:49], v173 offset:16384
    s_waitcnt lgkmcnt(6)
    v_exp_f32 v148, v148
    v_mfma_f32_16x16x32_bf16 v[128:131], a[52:55], a[12:15], v[128:131]
    ds_read_b64_tr_b16 a[50:51], v173 offset:20480
    v_exp_f32 v149, v149
    v_mfma_f32_16x16x32_bf16 v[132:135], a[52:55], a[28:31], v[132:135]
    v_exp_f32 v150, v150
    v_mfma_f32_16x16x32_bf16 v[136:139], a[52:55], a[44:47], v[136:139]
    ds_read_b64_tr_b16 a[52:53], v170 offset:17408
    s_waitcnt lgkmcnt(6)
    v_exp_f32 v151, v151
    v_mfma_f32_16x16x32_bf16 v[0:3], a[64:67], v[152:155], v[0:3]
    ds_read_b64_tr_b16 a[54:55], v170 offset:21504
    v_cvt_pk_bf16_f32 v162, v148, v149
    v_cvt_pk_bf16_f32 v163, v150, v151
    v_mfma_f32_16x16x32_bf16 v[32:35], a[64:67], v[156:159], v[32:35]
    ds_read_b64_tr_b16 a[64:65], v171 offset:17408
    s_waitcnt lgkmcnt(6)
    v_exp_f32 v176, v176
    v_mfma_f32_16x16x32_bf16 v[4:7], a[56:59], v[152:155], v[4:7]
    ds_read_b64_tr_b16 a[66:67], v171 offset:21504
    v_exp_f32 v177, v177
    v_mfma_f32_16x16x32_bf16 v[36:39], a[56:59], v[156:159], v[36:39]
    ds_read_b64_tr_b16 a[56:57], v172 offset:17408
    s_waitcnt lgkmcnt(6)
    v_exp_f32 v178, v178
    v_mfma_f32_16x16x32_bf16 v[8:11], a[60:63], v[152:155], v[8:11]
    ds_read_b64_tr_b16 a[58:59], v172 offset:21504
    v_exp_f32 v179, v179
    v_mfma_f32_16x16x32_bf16 v[40:43], a[60:63], v[156:159], v[40:43]
    ds_read_b64_tr_b16 a[60:61], v173 offset:17408
    s_waitcnt lgkmcnt(6)
    v_exp_f32 v180, v180
    v_mfma_f32_16x16x32_bf16 v[12:15], a[48:51], v[152:155], v[12:15]
    ds_read_b64_tr_b16 a[62:63], v173 offset:21504
    v_exp_f32 v181, v181
    v_mfma_f32_16x16x32_bf16 v[44:47], a[48:51], v[156:159], v[44:47]
    ds_read_b64_tr_b16 a[48:49], v170 offset:16384
    s_waitcnt lgkmcnt(6)
    v_exp_f32 v182, v182
    v_mfma_f32_16x16x32_bf16 v[16:19], a[52:55], v[152:155], v[16:19]
    ds_read_b64_tr_b16 a[50:51], v170 offset:20480
    v_exp_f32 v183, v183
    v_mfma_f32_16x16x32_bf16 v[48:51], a[52:55], v[156:159], v[48:51]
    ds_read_b64_tr_b16 a[52:53], v171 offset:16384
    s_waitcnt lgkmcnt(6)
    v_add_f32 v167, v167, v176
    v_add_f32 v167, v167, v177
    v_mfma_f32_16x16x32_bf16 v[20:23], a[64:67], v[152:155], v[20:23]
    ds_read_b64_tr_b16 a[54:55], v171 offset:20480
    v_add_f32 v167, v167, v178
    v_add_f32 v167, v167, v179
    v_mfma_f32_16x16x32_bf16 v[52:55], a[64:67], v[156:159], v[52:55]
    ds_read_b64_tr_b16 a[64:65], v172 offset:16384
    s_waitcnt lgkmcnt(6)
    v_add_f32 v167, v167, v180
    v_add_f32 v167, v167, v181
    v_mfma_f32_16x16x32_bf16 v[24:27], a[56:59], v[152:155], v[24:27]
    ds_read_b64_tr_b16 a[66:67], v172 offset:20480
    v_add_f32 v167, v167, v182
    v_add_f32 v167, v167, v183
    v_mfma_f32_16x16x32_bf16 v[56:59], a[56:59], v[156:159], v[56:59]
    ds_read_b64_tr_b16 a[56:57], v173 offset:16384
    s_waitcnt lgkmcnt(6)
    v_cvt_pk_bf16_f32 v176, v176, v177
    v_cvt_pk_bf16_f32 v177, v178, v179
    v_mfma_f32_16x16x32_bf16 v[28:31], a[60:63], v[152:155], v[28:31]
    ds_read_b64_tr_b16 a[58:59], v173 offset:20480
    v_cvt_pk_bf16_f32 v178, v180, v181
    v_cvt_pk_bf16_f32 v179, v182, v183
    v_mfma_f32_16x16x32_bf16 v[60:63], a[60:63], v[156:159], v[60:63]
    ds_read_b64_tr_b16 a[60:61], v170 offset:17408
    s_waitcnt lgkmcnt(6)
    v_add_f32 v164, v164, v140
    v_add_f32 v164, v164, v141
    v_mfma_f32_16x16x32_bf16 v[64:67], a[48:51], v[160:163], v[64:67]
    ds_read_b64_tr_b16 a[62:63], v170 offset:21504
    v_add_f32 v164, v164, v142
    v_add_f32 v164, v164, v143
    v_mfma_f32_16x16x32_bf16 v[96:99], a[48:51], v[176:179], v[96:99]
    ds_read_b64_tr_b16 a[48:49], v171 offset:17408
    s_waitcnt lgkmcnt(6)
    v_add_f32 v165, v165, v144
    v_add_f32 v165, v165, v145
    v_mfma_f32_16x16x32_bf16 v[68:71], a[52:55], v[160:163], v[68:71]
    ds_read_b64_tr_b16 a[50:51], v171 offset:21504
    v_add_f32 v165, v165, v146
    v_add_f32 v165, v165, v147
    v_mfma_f32_16x16x32_bf16 v[100:103], a[52:55], v[176:179], v[100:103]
    ds_read_b64_tr_b16 a[52:53], v172 offset:17408
    s_waitcnt lgkmcnt(6)
    v_add_f32 v166, v166, v148
    v_add_f32 v166, v166, v149
    v_mfma_f32_16x16x32_bf16 v[72:75], a[64:67], v[160:163], v[72:75]
    ds_read_b64_tr_b16 a[54:55], v172 offset:21504
    v_add_f32 v166, v166, v150
    v_add_f32 v166, v166, v151
    v_mfma_f32_16x16x32_bf16 v[104:107], a[64:67], v[176:179], v[104:107]
    ds_read_b64_tr_b16 a[64:65], v173 offset:17408
    s_waitcnt lgkmcnt(6)
    v_exp_f32 v128, v128
    v_mfma_f32_16x16x32_bf16 v[76:79], a[56:59], v[160:163], v[76:79]
    ds_read_b64_tr_b16 a[66:67], v173 offset:21504
    v_exp_f32 v129, v129
    v_mfma_f32_16x16x32_bf16 v[108:111], a[56:59], v[176:179], v[108:111]
    s_waitcnt lgkmcnt(5)
    v_exp_f32 v130, v130
    v_mfma_f32_16x16x32_bf16 v[80:83], a[60:63], v[160:163], v[80:83]
    v_exp_f32 v131, v131
    v_mfma_f32_16x16x32_bf16 v[112:115], a[60:63], v[176:179], v[112:115]
    s_waitcnt lgkmcnt(3)
    v_exp_f32 v132, v132
    v_mfma_f32_16x16x32_bf16 v[84:87], a[48:51], v[160:163], v[84:87]
    v_exp_f32 v133, v133
    v_mfma_f32_16x16x32_bf16 v[116:119], a[48:51], v[176:179], v[116:119]
    s_waitcnt lgkmcnt(1)
    v_exp_f32 v134, v134
    v_mfma_f32_16x16x32_bf16 v[88:91], a[52:55], v[160:163], v[88:91]
    v_exp_f32 v135, v135
    v_mfma_f32_16x16x32_bf16 v[120:123], a[52:55], v[176:179], v[120:123]
    s_waitcnt lgkmcnt(0)
    v_exp_f32 v136, v136
    v_mfma_f32_16x16x32_bf16 v[92:95], a[64:67], v[160:163], v[92:95]
    v_exp_f32 v137, v137
    v_mfma_f32_16x16x32_bf16 v[124:127], a[64:67], v[176:179], v[124:127]
    v_exp_f32 v138, v138
    v_exp_f32 v139, v139
L_concat_heads__mha_block_cached__gqa_block_cached__near_ridge_kernel_f_j2:
    s_cmp_eq_u32 s55, 3
    s_cbranch_scc1 L_concat_heads__mha_block_cached__gqa_block_cached__near_ridge_kernel_f_o3
    ds_read_b128 a[48:51], v168 offset:61440
    ds_read_b128 a[52:55], v169 offset:61440
    ds_read_b128 a[56:59], v168 offset:62464
    s_waitcnt vmcnt(6)
    s_add_u32 s16, s16, 4
    v_mov_b32 v187, 1
    s_mov_b64 exec, 1
    ds_add_rtn_u32 v187, v186, v187
    s_mov_b64 exec, -1
    s_waitcnt lgkmcnt(0)
    v_readfirstlane_b32 s17, v187
    s_nop 0
    s_add_u32 s17, s17, 1
    s_cmp_ge_u32 s17, s16
    s_cbranch_scc1 L_gb7_d
    s_mov_b32 s18, 0
L_gb7_l:
    ds_read_b32 v187, v186
    s_add_u32 s18, s18, 1
    s_cmp_ge_u32 s18, 0x200000
    s_cbranch_scc1 L_gb7_d
    s_waitcnt lgkmcnt(0)
    v_readfirstlane_b32 s17, v187
    s_nop 0
    s_cmp_ge_u32 s17, s16
    s_cbranch_scc0 L_gb7_l
L_gb7_d:
    v_mfma_f32_16x16x32_bf16 v[140:143], a[48:51], a[0:3], 0
    ds_read_b128 a[60:63], v169 offset:62464
    v_cvt_pk_bf16_f32 v152, v128, v129
    v_cvt_pk_bf16_f32 v153, v130, v131
    v_mfma_f32_16x16x32_bf16 v[144:147], a[48:51], a[16:19], 0
    ds_read_b128 a[64:67], v168 offset:32768
    v_add_f32 v164, v164, v128
    v_add_f32 v164, v164, v129
    v_mfma_f32_16x16x32_bf16 v[148:151], a[48:51], a[32:35], 0
    ds_read_b128 a[48:51], v169 offset:32768
    v_add_f32 v164, v164, v130
    v_add_f32 v164, v164, v131
    v_mfma_f32_16x16x32_bf16 v[140:143], a[52:55], a[4:7], v[140:143]
    s_add_u32 m0, s53, 49152
    v_cvt_pk_bf16_f32 v156, v132, v133
    v_cvt_pk_bf16_f32 v157, v134, v135
    v_mfma_f32_16x16x32_bf16 v[144:147], a[52:55], a[20:23], v[144:147]
    buffer_load_dwordx4 v174, s[36:39], s49 offen nt lds
    s_add_u32 m0, s53, 50048
    v_add_f32 v165, v165, v132
    v_add_f32 v165, v165, v133
    v_mfma_f32_16x16x32_bf16 v[148:151], a[52:55], a[36:39], v[148:151]
    ds_read_b128 a[52:55], v168 offset:33792
    buffer_load_dwordx4 v174, s[36:39], s49 offen offset:128 nt lds
    v_add_f32 v165, v165, v134
    v_add_f32 v165, v165, v135
    v_mfma_f32_16x16x32_bf16 v[140:143], a[56:59], a[8:11], v[140:143]
    s_add_u32 m0, s52, 16384
    s_nop 0
    buffer_load_dwordx4 v175, s[40:43], s49 offen nt lds
    v_cvt_pk_bf16_f32 v160, v136, v137
    v_cvt_pk_bf16_f32 v161, v138, v139
    v_mfma_f32_16x16x32_bf16 v[144:147], a[56:59], a[24:27], v[144:147]
    s_add_u32 m0, s52, 17280
    s_nop 0
    buffer_load_dwordx4 v175, s[40:43], s49 offen offset:128 nt lds
    v_add_f32 v166, v166, v136
    v_add_f32 v166, v166, v137
    v_mfma_f32_16x16x32_bf16 v[148:151], a[56:59], a[40:43], v[148:151]
    ds_read_b128 a[56:59], v169 offset:33792
    s_add_u32 s49, s49, 8192
    s_waitcnt lgkmcnt(3)
    v_add_f32 v166, v166, v138
    v_add_f32 v166, v166, v139
    v_mfma_f32_16x16x32_bf16 v[140:143], a[60:63], a[12:15], v[140:143]
    v_mfma_f32_16x16x32_bf16 v[144:147], a[60:63], a[28:31], v[144:147]
    v_mfma_f32_16x16x32_bf16 v[148:151], a[60:63], a[44:47], v[148:151]
    ds_read_b64_tr_b16 a[60:61], v170 offset:24576
    ds_read_b64_tr_b16 a[62:63], v170 offset:28672
    v_mfma_f32_16x16x32_bf16 v[128:131], a[64:67], a[0:3], 0
    s_nop 2
    v_exp_f32 v140, v140
    v_mfma_f32_16x16x32_bf16 v[132:135], a[64:67], a[16:19], 0
    v_exp_f32 v141, v141
    v_mfma_f32_16x16x32_bf16 v[136:139], a[64:67], a[32:35], 0
    ds_read_b64_tr_b16 a[64:65], v171 offset:24576
    s_waitcnt lgkmcnt(4)
    v_exp_f32 v142, v142
    v_mfma_f32_16x16x32_bf16 v[128:131], a[48:51], a[4:7], v[128:131]
    ds_read_b64_tr_b16 a[66:67], v171 offset:28672
    v_exp_f32 v143, v143
    v_mfma_f32_16x16x32_bf16 v[132:135], a[48:51], a[20:23], v[132:135]
    v_cvt_pk_bf16_f32 v154, v140, v141
    v_cvt_pk_bf16_f32 v155, v142, v143
    v_mfma_f32_16x16x32_bf16 v[136:139], a[48:51], a[36:39], v[136:139]
    ds_read_b64_tr_b16 a[48:49], v172 offset:24576
    v_exp_f32 v144, v144
    v_mfma_f32_16x16x32_bf16 v[128:131], a[52:55], a[8:11], v[128:131]
    ds_read_b64_tr_b16 a[50:51], v172 offset:28672
    v_exp_f32 v145, v145
    v_mfma_f32_16x16x32_bf16 v[132:135], a[52:55], a[24:27], v[132:135]
    v_exp_f32 v146, v146
    v_mfma_f32_16x16x32_bf16 v[136:139], a[52:55], a[40:43], v[136:139]
    ds_read_b64_tr_b16 a[52:53], v173 offset:24576
    s_waitcnt lgkmcnt(6)
    v_exp_f32 v147, v147
    v_mfma_f32_16x16x32_bf16 v[128:131], a[56:59], a[12:15], v[128:131]
    ds_read_b64_tr_b16 a[54:55], v173 offset:28672
    v_cvt_pk_bf16_f32 v158, v144, v145
    v_cvt_pk_bf16_f32 v159, v146, v147
    v_mfma_f32_16x16x32_bf16 v[132:135], a[56:59], a[28:31], v[132:135]
    v_exp_f32 v148, v148
    v_mfma_f32_16x16x32_bf16 v[136:139], a[56:59], a[44:47], v[136:139]
    ds_read_b64_tr_b16 a[56:57], v170 offset:25600
    s_waitcnt lgkmcnt(6)
    v_exp_f32 v149, v149
    v_mfma_f32_16x16x32_bf16 v[0:3], a[60:63], v[152:155], v[0:3]
    ds_read_b64_tr_b16 a[58:59], v170 offset:29696
    v_exp_f32 v150, v150
    v_mfma_f32_16x16x32_bf16 v[32:35], a[60:63], v[156:159], v[32:35]
    v_exp_f32 v151, v151
    v_cvt_pk_bf16_f32 v162, v148, v149
    v_cvt_pk_bf16_f32 v163, v150, v151
    s_nop 1
    v_mfma_f32_16x16x32_bf16 v[64:67], a[60:63], v[160:163], v[64:67]
    ds_read_b64_tr_b16 a[60:61], v171 offset:25600
    s_waitcnt lgkmcnt(6)
    v_add_f32 v164, v164, v140
    v_add_f32 v164, v164, v141
    v_mfma_f32_16x16x32_bf16 v[4:7], a[64:67], v[152:155], v[4:7]
    ds_read_b64_tr_b16 a[62:63], v171 offset:29696
    v_add_f32 v164, v164, v142
    v_add_f32 v164, v164, v143
    v_mfma_f32_16x16x32_bf16 v[36:39], a[64:67], v[156:159], v[36:39]
    v_add_f32 v165, v165, v144
    v_add_f32 v165, v165, v145
    v_mfma_f32_16x16x32_bf16 v[68:71], a[64:67], v[160:163], v[68:71]
    ds_read_b64_tr_b16 a[64:65], v172 offset:25600
    s_waitcnt lgkmcnt(6)
    v_add_f32 v165, v165, v146
    v_add_f32 v165, v165, v147
    v_mfma_f32_16x16x32_bf16 v[8:11], a[48:51], v[152:155], v[8:11]
    ds_read_b64_tr_b16 a[66:67], v172 offset:29696
    v_add_f32 v166, v166, v148
    v_add_f32 v166, v166, v149
    v_mfma_f32_16x16x32_bf16 v[40:43], a[48:51], v[156:159], v[40:43]
    v_add_f32 v166, v166, v150
    v_add_f32 v166, v166, v151
    v_mfma_f32_16x16x32_bf16 v[72:75], a[48:51], v[160:163], v[72:75]
    ds_read_b64_tr_b16 a[48:49], v173 offset:25600
    s_waitcnt lgkmcnt(6)
    v_exp_f32 v128, v128
    v_mfma_f32_16x16x32_bf16 v[12:15], a[52:55], v[152:155], v[12:15]
    ds_read_b64_tr_b16 a[50:51], v173 offset:29696
    v_exp_f32 v129, v129
    v_mfma_f32_16x16x32_bf16 v[44:47], a[52:55], v[156:159], v[44:47]
    v_exp_f32 v130, v130
    v_mfma_f32_16x16x32_bf16 v[76:79], a[52:55], v[160:163], v[76:79]
    s_waitcnt lgkmcnt(5)
    v_exp_f32 v131, v131
    v_mfma_f32_16x16x32_bf16 v[16:19], a[56:59], v[152:155], v[16:19]
    v_exp_f32 v132, v132
    v_mfma_f32_16x16x32_bf16 v[48:51], a[56:59], v[156:159], v[48:51]
    v_exp_f32 v133, v133
    v_mfma_f32_16x16x32_bf16 v[80:83], a[56:59], v[160:163], v[80:83]
    s_waitcnt lgkmcnt(3)
    v_exp_f32 v134, v134
    v_mfma_f32_16x16x32_bf16 v[20:23], a[60:63], v[152:155], v[20:23]
    v_exp_f32 v135, v135
    v_mfma_f32_16x16x32_bf16 v[52:55], a[60:63], v[156:159], v[52:55]
    v_exp_f32 v136, v136
    v_mfma_f32_16x16x32_bf16 v[84:87], a[60:63], v[160:163], v[84:87]
    s_waitcnt lgkmcnt(1)
    v_exp_f32 v137, v137
    v_mfma_f32_16x16x32_bf16 v[24:27], a[64:67], v[152:155], v[24:27]
    v_exp_f32 v138, v138
    v_mfma_f32_16x16x32_bf16 v[56:59], a[64:67], v[156:159], v[56:59]
    v_exp_f32 v139, v139
    v_mfma_f32_16x16x32_bf16 v[88:91], a[64:67], v[160:163], v[88:91]
    s_waitcnt lgkmcnt(0)
    v_mfma_f32_16x16x32_bf16 v[28:31], a[48:51], v[152:155], v[28:31]
    v_mfma_f32_16x16x32_bf16 v[60:63], a[48:51], v[156:159], v[60:63]
    v_mfma_f32_16x16x32_bf16 v[92:95], a[48:51], v[160:163], v[92:95]
    s_branch L_concat_heads__mha_block_cached__gqa_block_cached__near_ridge_kernel_f_j3
L_concat_heads__mha_block_cached__gqa_block_cached__near_ridge_kernel_f_o3:
    ds_read_b128 a[48:51], v168 offset:61440
    ds_read_b128 a[52:55], v185 offset:0
    ds_read_b128 a[56:59], v168 offset:57344
    s_waitcnt vmcnt(6)
    s_add_u32 s16, s16, 4
    v_mov_b32 v187, 1
    s_mov_b64 exec, 1
    ds_add_rtn_u32 v187, v186, v187
    s_mov_b64 exec, -1
    s_waitcnt lgkmcnt(0)
    v_readfirstlane_b32 s17, v187
    s_nop 0
    s_add_u32 s17, s17, 1
    s_cmp_ge_u32 s17, s16
    s_cbranch_scc1 L_gb8_d
    s_mov_b32 s18, 0
L_gb8_l:
    ds_read_b32 v187, v186
    s_add_u32 s18, s18, 1
    s_cmp_ge_u32 s18, 0x200000
    s_cbranch_scc1 L_gb8_d
    s_waitcnt lgkmcnt(0)
    v_readfirstlane_b32 s17, v187
    s_nop 0
    s_cmp_ge_u32 s17, s16
    s_cbranch_scc0 L_gb8_l
L_gb8_d:
    v_mfma_f32_16x16x32_bf16 v[140:143], a[48:51], a[0:3], 0
    ds_read_b128 a[60:63], v169 offset:61440
    v_cvt_pk_bf16_f32 v152, v128, v129
    v_cvt_pk_bf16_f32 v153, v130, v131
    v_mfma_f32_16x16x32_bf16 v[144:147], a[48:51], a[16:19], 0
    ds_read_b128 a[64:67], v185 offset:1024
    v_add_f32 v164, v164, v128
    v_add_f32 v164, v164, v129
    v_mfma_f32_16x16x32_bf16 v[148:151], a[48:51], a[32:35], 0
    s_add_u32 m0, s53, 49152
    v_add_f32 v164, v164, v130
    v_add_f32 v164, v164, v131
    v_mfma_f32_16x16x32_bf16 v[180:183], a[48:51], a[52:55], 0
    ds_read_b128 a[48:51], v169 offset:57344
    v_cvt_pk_bf16_f32 v156, v132, v133
    v_cvt_pk_bf16_f32 v157, v134, v135
    v_mfma_f32_16x16x32_bf16 v[176:179], a[56:59], a[52:55], 0
    ds_read_b128 a[52:55], v168 offset:62464
    buffer_load_dwordx4 v174, s[36:39], s49 offen nt lds
    s_waitcnt lgkmcnt(2)
    v_add_f32 v165, v165, v132
    v_add_f32 v165, v165, v133
    v_mfma_f32_16x16x32_bf16 v[140:143], a[60:63], a[4:7], v[140:143]
    ds_read_b128 a[56:59], v185 offset:2048
    s_add_u32 m0, s53, 50048
    v_add_f32 v165, v165, v134
    v_add_f32 v165, v165, v135
    v_mfma_f32_16x16x32_bf16 v[144:147], a[60:63], a[20:23], v[144:147]
    buffer_load_dwordx4 v174, s[36:39], s49 offen offset:128 nt lds
    s_add_u32 m0, s52, 16384
    v_cvt_pk_bf16_f32 v160, v136, v137
    v_cvt_pk_bf16_f32 v161, v138, v139
    v_mfma_f32_16x16x32_bf16 v[148:151], a[60:63], a[36:39], v[148:151]
    buffer_load_dwordx4 v175, s[40:43], s49 offen nt lds
    s_add_u32 m0, s52, 17280
    v_add_f32 v166, v166, v136
    v_add_f32 v166, v166, v137
    v_mfma_f32_16x16x32_bf16 v[180:183], a[60:63], a[64:67], v[180:183]
    ds_read_b128 a[60:63], v168 offset:58368
    buffer_load_dwordx4 v175, s[40:43], s49 offen offset:128 nt lds
    s_waitcnt lgkmcnt(2)
    v_add_f32 v166, v166, v138
    v_add_f32 v166, v166, v139
    v_mfma_f32_16x16x32_bf16 v[176:179], a[48:51], a[64:67], v[176:179]
    ds_read_b128 a[48:51], v169 offset:62464
    ds_read_b128 a[64:67], v185 offset:3072
    s_add_u32 s49, s49, 8192
    v_mfma_f32_16x16x32_bf16 v[140:143], a[52:55], a[8:11], v[140:143]
    v_mfma_f32_16x16x32_bf16 v[144:147], a[52:55], a[24:27], v[144:147]
    v_mfma_f32_16x16x32_bf16 v[148:151], a[52:55], a[40:43], v[148:151]
    s_waitcnt lgkmcnt(2)
    v_mfma_f32_16x16x32_bf16 v[180:183], a[52:55], a[56:59], v[180:183]
    ds_read_b128 a[52:55], v169 offset:58368
    v_mfma_f32_16x16x32_bf16 v[176:179], a[60:63], a[56:59], v[176:179]
    ds_read_b128 a[56:59], v168 offset:32768
    ds_read_b128 a[60:63], v169 offset:32768
    s_waitcnt lgkmcnt(3)
    v_mfma_f32_16x16x32_bf16 v[140:143], a[48:51], a[12:15], v[140:143]
    v_mfma_f32_16x16x32_bf16 v[144:147], a[48:51], a[28:31], v[144:147]
    v_mfma_f32_16x16x32_bf16 v[148:151], a[48:51], a[44:47], v[148:151]
    v_mfma_f32_16x16x32_bf16 v[180:183], a[48:51], a[64:67], v[180:183]
    ds_read_b128 a[48:51], v168 offset:33792
    s_waitcnt lgkmcnt(2)
    s_nop 2
    v_exp_f32 v140, v140
    v_mfma_f32_16x16x32_bf16 v[176:179], a[52:55], a[64:67], v[176:179]
    ds_read_b128 a[52:55], v169 offset:33792
    v_exp_f32 v141, v141
    v_mfma_f32_16x16x32_bf16 v[128:131], a[56:59], a[0:3], 0
    ds_read_b64_tr_b16 a[64:65], v170 offset:24576
    v_exp_f32 v142, v142
    v_mfma_f32_16x16x32_bf16 v[132:135], a[56:59], a[16:19], 0
    ds_read_b64_tr_b16 a[66:67], v170 offset:28672
    v_exp_f32 v143, v143
    v_mfma_f32_16x16x32_bf16 v[136:139], a[56:59], a[32:35], 0
    ds_read_b64_tr_b16 a[56:57], v171 offset:24576
    s_waitcnt lgkmcnt(4)
    v_cvt_pk_bf16_f32 v154, v140, v141
    v_cvt_pk_bf16_f32 v155, v142, v143
    v_mfma_f32_16x16x32_bf16 v[128:131], a[60:63], a[4:7], v[128:131]
    ds_read_b64_tr_b16 a[58:59], v171 offset:28672
    v_exp_f32 v144, v144
    v_mfma_f32_16x16x32_bf16 v[132:135], a[60:63], a[20:23], v[132:135]
    v_exp_f32 v145, v145
    v_mfma_f32_16x16x32_bf16 v[136:139], a[60:63], a[36:39], v[136:139]
    ds_read_b64_tr_b16 a[60:61], v172 offset:24576
    v_exp_f32 v146, v146
    v_mfma_f32_16x16x32_bf16 v[128:131], a[48:51], a[8:11], v[128:131]
    ds_read_b64_tr_b16 a[62:63], v172 offset:28672
    v_exp_f32 v147, v147
    v_mfma_f32_16x16x32_bf16 v[132:135], a[48:51], a[24:27], v[132:135]
    v_cvt_pk_bf16_f32 v158, v144, v145
    v_cvt_pk_bf16_f32 v159, v146, v147
    v_mfma_f32_16x16x32_bf16 v[136:139], a[48:51], a[40:43], v[136:139]
    ds_read_b64_tr_b16 a[48:49], v173 offset:24576
    s_waitcnt lgkmcnt(6)
    v_exp_f32 v148, v148
    v_mfma_f32_16x16x32_bf16 v[128:131], a[52:55], a[12:15], v[128:131]
    ds_read_b64_tr_b16 a[50:51], v173 offset:28672
    v_exp_f32 v149, v149
    v_mfma_f32_16x16x32_bf16 v[132:135], a[52:55], a[28:31], v[132:135]
    v_exp_f32 v150, v150
    v_mfma_f32_16x16x32_bf16 v[136:139], a[52:55], a[44:47], v[136:139]
    ds_read_b64_tr_b16 a[52:53], v170 offset:25600
    s_waitcnt lgkmcnt(6)
    v_exp_f32 v151, v151
    v_mfma_f32_16x16x32_bf16 v[0:3], a[64:67], v[152:155], v[0:3]
    ds_read_b64_tr_b16 a[54:55], v170 offset:29696
    v_cvt_pk_bf16_f32 v162, v148, v149
    v_cvt_pk_bf16_f32 v163, v150, v151
    v_mfma_f32_16x16x32_bf16 v[32:35], a[64:67], v[156:159], v[32:35]
    ds_read_b64_tr_b16 a[64:65], v171 offset:25600
    s_waitcnt lgkmcnt(6)
    v_exp_f32 v176, v176
    v_mfma_f32_16x16x32_bf16 v[4:7], a[56:59], v[152:155], v[4:7]
    ds_read_b64_tr_b16 a[66:67], v171 offset:29696
    v_exp_f32 v177, v177
    v_mfma_f32_16x16x32_bf16 v[36:39], a[56:59], v[156:159], v[36:39]
    ds_read_b64_tr_b16 a[56:57], v172 offset:25600
    s_waitcnt lgkmcnt(6)
    v_exp_f32 v178, v178
    v_mfma_f32_16x16x32_bf16 v[8:11], a[60:63], v[152:155], v[8:11]
    ds_read_b64_tr_b16 a[58:59], v172 offset:29696
    v_exp_f32 v179, v179
    v_mfma_f32_16x16x32_bf16 v[40:43], a[60:63], v[156:159], v[40:43]
    ds_read_b64_tr_b16 a[60:61], v173 offset:25600
    s_waitcnt lgkmcnt(6)
    v_exp_f32 v180, v180
    v_mfma_f32_16x16x32_bf16 v[12:15], a[48:51], v[152:155], v[12:15]
    ds_read_b64_tr_b16 a[62:63], v173 offset:29696
    v_exp_f32 v181, v181
    v_mfma_f32_16x16x32_bf16 v[44:47], a[48:51], v[156:159], v[44:47]
    ds_read_b64_tr_b16 a[48:49], v170 offset:24576
    s_waitcnt lgkmcnt(6)
    v_exp_f32 v182, v182
    v_mfma_f32_16x16x32_bf16 v[16:19], a[52:55], v[152:155], v[16:19]
    ds_read_b64_tr_b16 a[50:51], v170 offset:28672
    v_exp_f32 v183, v183
    v_mfma_f32_16x16x32_bf16 v[48:51], a[52:55], v[156:159], v[48:51]
    ds_read_b64_tr_b16 a[52:53], v171 offset:24576
    s_waitcnt lgkmcnt(6)
    v_add_f32 v167, v167, v176
    v_add_f32 v167, v167, v177
    v_mfma_f32_16x16x32_bf16 v[20:23], a[64:67], v[152:155], v[20:23]
    ds_read_b64_tr_b16 a[54:55], v171 offset:28672
    v_add_f32 v167, v167, v178
    v_add_f32 v167, v167, v179
    v_mfma_f32_16x16x32_bf16 v[52:55], a[64:67], v[156:159], v[52:55]
    ds_read_b64_tr_b16 a[64:65], v172 offset:24576
    s_waitcnt lgkmcnt(6)
    v_add_f32 v167, v167, v180
    v_add_f32 v167, v167, v181
    v_mfma_f32_16x16x32_bf16 v[24:27], a[56:59], v[152:155], v[24:27]
    ds_read_b64_tr_b16 a[66:67], v172 offset:28672
    v_add_f32 v167, v167, v182
    v_add_f32 v167, v167, v183
    v_mfma_f32_16x16x32_bf16 v[56:59], a[56:59], v[156:159], v[56:59]
    ds_read_b64_tr_b16 a[56:57], v173 offset:24576
    s_waitcnt lgkmcnt(6)
    v_cvt_pk_bf16_f32 v176, v176, v177
    v_cvt_pk_bf16_f32 v177, v178, v179
    v_mfma_f32_16x16x32_bf16 v[28:31], a[60:63], v[152:155], v[28:31]
    ds_read_b64_tr_b16 a[58:59], v173 offset:28672
    v_cvt_pk_bf16_f32 v178, v180, v181
    v_cvt_pk_bf16_f32 v179, v182, v183
    v_mfma_f32_16x16x32_bf16 v[60:63], a[60:63], v[156:159], v[60:63]
    ds_read_b64_tr_b16 a[60:61], v170 offset:25600
    s_waitcnt lgkmcnt(6)
    v_add_f32 v164, v164, v140
    v_add_f32 v164, v164, v141
    v_mfma_f32_16x16x32_bf16 v[64:67], a[48:51], v[160:163], v[64:67]
    ds_read_b64_tr_b16 a[62:63], v170 offset:29696
    v_add_f32 v164, v164, v142
    v_add_f32 v164, v164, v143
    v_mfma_f32_16x16x32_bf16 v[96:99], a[48:51], v[176:179], v[96:99]
    ds_read_b64_tr_b16 a[48:49], v171 offset:25600
    s_waitcnt lgkmcnt(6)
    v_add_f32 v165, v165, v144
    v_add_f32 v165, v165, v145
    v_mfma_f32_16x16x32_bf16 v[68:71], a[52:55], v[160:163], v[68:71]
    ds_read_b64_tr_b16 a[50:51], v171 offset:29696
    v_add_f32 v165, v165, v146
    v_add_f32 v165, v165, v147
    v_mfma_f32_16x16x32_bf16 v[100:103], a[52:55], v[176:179], v[100:103]
    ds_read_b64_tr_b16 a[52:53], v172 offset:25600
    s_waitcnt lgkmcnt(6)
    v_add_f32 v166, v166, v148
    v_add_f32 v166, v166, v149
    v_mfma_f32_16x16x32_bf16 v[72:75], a[64:67], v[160:163], v[72:75]
    ds_read_b64_tr_b16 a[54:55], v172 offset:29696
    v_add_f32 v166, v166, v150
    v_add_f32 v166, v166, v151
    v_mfma_f32_16x16x32_bf16 v[104:107], a[64:67], v[176:179], v[104:107]
    ds_read_b64_tr_b16 a[64:65], v173 offset:25600
    s_waitcnt lgkmcnt(6)
    v_exp_f32 v128, v128
    v_mfma_f32_16x16x32_bf16 v[76:79], a[56:59], v[160:163], v[76:79]
    ds_read_b64_tr_b16 a[66:67], v173 offset:29696
    v_exp_f32 v129, v129
    v_mfma_f32_16x16x32_bf16 v[108:111], a[56:59], v[176:179], v[108:111]
    s_waitcnt lgkmcnt(5)
    v_exp_f32 v130, v130
    v_mfma_f32_16x16x32_bf16 v[80:83], a[60:63], v[160:163], v[80:83]
    v_exp_f32 v131, v131
    v_mfma_f32_16x16x32_bf16 v[112:115], a[60:63], v[176:179], v[112:115]
    s_waitcnt lgkmcnt(3)
    v_exp_f32 v132, v132
    v_mfma_f32_16x16x32_bf16 v[84:87], a[48:51], v[160:163], v[84:87]
    v_exp_f32 v133, v133
    v_mfma_f32_16x16x32_bf16 v[116:119], a[48:51], v[176:179], v[116:119]
    s_waitcnt lgkmcnt(1)
    v_exp_f32 v134, v134
    v_mfma_f32_16x16x32_bf16 v[88:91], a[52:55], v[160:163], v[88:91]
    v_exp_f32 v135, v135
    v_mfma_f32_16x16x32_bf16 v[120:123], a[52:55], v[176:179], v[120:123]
    s_waitcnt lgkmcnt(0)
    v_exp_f32 v136, v136
    v_mfma_f32_16x16x32_bf16 v[92:95], a[64:67], v[160:163], v[92:95]
    v_exp_f32 v137, v137
    v_mfma_f32_16x16x32_bf16 v[124:127], a[64:67], v[176:179], v[124:127]
    v_exp_f32 v138, v138
    v_exp_f32 v139, v139
L_concat_heads__mha_block_cached__gqa_block_cached__near_ridge_kernel_f_j3:
    s_add_u32 s50, s50, 1
    s_cmp_lt_u32 s50, 4
    s_cbranch_scc1 L_concat_heads__mha_block_cached__gqa_block_cached__near_ridge_kernel_f_loop
    s_waitcnt vmcnt(0) lgkmcnt(0)
    s_add_u32 s16, s16, 4
    v_mov_b32 v187, 1
    s_mov_b64 exec, 1
    ds_add_rtn_u32 v187, v186, v187
    s_mov_b64 exec, -1
    s_waitcnt lgkmcnt(0)
    v_readfirstlane_b32 s17, v187
    s_nop 0
    s_add_u32 s17, s17, 1
    s_cmp_ge_u32 s17, s16
    s_cbranch_scc1 L_gb9_d
    s_mov_b32 s18, 0
L_gb9_l:
    ds_read_b32 v187, v186
    s_add_u32 s18, s18, 1
    s_cmp_ge_u32 s18, 0x200000
    s_cbranch_scc1 L_gb9_d
    s_waitcnt lgkmcnt(0)
    v_readfirstlane_b32 s17, v187
    s_nop 0
    s_cmp_ge_u32 s17, s16
    s_cbranch_scc0 L_gb9_l
L_gb9_d:
    s_cmp_eq_u32 s56, 0
    s_cbranch_scc0 L_concat_heads__mha_block_cached__gqa_block_cached__near_ridge_kernel_ap
    s_setprio 0
L_concat_heads__mha_block_cached__gqa_block_cached__near_ridge_kernel_ap:
    v_mov_b32 v180, v164
    s_nop 1
    v_permlane32_swap_b32 v164, v180
    v_add_f32 v164, v164, v180
    v_mov_b32 v180, v164
    s_nop 1
    v_permlane16_swap_b32 v164, v180
    v_add_f32 v164, v164, v180
    v_mov_b32 v180, v165
    s_nop 1
    v_permlane32_swap_b32 v165, v180
    v_add_f32 v165, v165, v180
    v_mov_b32 v180, v165
    s_nop 1
    v_permlane16_swap_b32 v165, v180
    v_add_f32 v165, v165, v180
    v_mov_b32 v180, v166
    s_nop 1
    v_permlane32_swap_b32 v166, v180
    v_add_f32 v166, v166, v180
    v_mov_b32 v180, v166
    s_nop 1
    v_permlane16_swap_b32 v166, v180
    v_add_f32 v166, v166, v180
    v_mov_b32 v180, v167
    s_nop 1
    v_permlane32_swap_b32 v167, v180
    v_add_f32 v167, v167, v180
    v_mov_b32 v180, v167
    s_nop 1
    v_permlane16_swap_b32 v167, v180
    v_add_f32 v167, v167, v180
    v_mov_b32 v181, s3
    s_mov_b32 s54, s101
    v_lshl_add_u32 v182, v181, 13, v184
    v_add_u32 v182, s54, v182
    ds_write_b128 v182, v[96:99] offset:0
    ds_write_b128 v182, v[100:103] offset:1024
    ds_write_b128 v182, v[104:107] offset:2048
    ds_write_b128 v182, v[108:111] offset:3072
    ds_write_b128 v182, v[112:115] offset:4096
    ds_write_b128 v182, v[116:119] offset:5120
    ds_write_b128 v182, v[120:123] offset:6144
    ds_write_b128 v182, v[124:127] offset:7168
    v_lshrrev_b32 v180, 2, v184
    v_add_u32 v180, s100, v180
    v_lshl_add_u32 v182, v181, 8, v180
    ds_write_b32 v182, v167 offset:8192
    s_add_u32 s16, s16, 4
    v_mov_b32 v187, 1
    s_mov_b64 exec, 1
    ds_add_rtn_u32 v187, v186, v187
    s_mov_b64 exec, -1
    s_waitcnt lgkmcnt(0)
    v_readfirstlane_b32 s17, v187
    s_nop 0
    s_add_u32 s17, s17, 1
    s_cmp_ge_u32 s17, s16
    s_cbranch_scc1 L_gb10_d
    s_mov_b32 s18, 0
L_gb10_l:
    ds_read_b32 v187, v186
    s_add_u32 s18, s18, 1
    s_cmp_ge_u32 s18, 0x200000
    s_cbranch_scc1 L_gb10_d
    s_waitcnt lgkmcnt(0)
    v_readfirstlane_b32 s17, v187
    s_nop 0
    s_cmp_ge_u32 s17, s16
    s_cbranch_scc0 L_gb10_l
L_gb10_d:
    ds_read_b32 v128, v180 offset:8192
    ds_read_b32 v129, v180 offset:8448
    ds_read_b32 v130, v180 offset:8704
    ds_read_b32 v131, v180 offset:8960
    v_lshl_add_u32 v182, v181, 11, v184
    v_add_u32 v182, s54, v182
    ds_read_b128 v[96:99], v182 offset:0
    ds_read_b128 v[100:103], v182 offset:1024
    ds_read_b128 v[104:107], v182 offset:8192
    ds_read_b128 v[108:111], v182 offset:9216
    ds_read_b128 v[112:115], v182 offset:16384
    ds_read_b128 v[116:119], v182 offset:17408
    ds_read_b128 v[120:123], v182 offset:24576
    ds_read_b128 v[124:127], v182 offset:25600
    s_waitcnt lgkmcnt(10)
    v_add_f32 v128, v128, v129
    s_waitcnt lgkmcnt(8)
    v_add_f32 v130, v130, v131
    v_add_f32 v167, v128, v130
    v_cmp_nle_f32 vcc, s59, v164
    s_nop 0
    s_mov_b64 s[54:55], vcc
    v_cmp_nge_f32 vcc, s60, v164
    s_nop 0
    s_or_b64 s[54:55], s[54:55], vcc
    v_cmp_nle_f32 vcc, s59, v165
    s_nop 0
    s_or_b64 s[54:55], s[54:55], vcc
    v_cmp_nge_f32 vcc, s60, v165
    s_nop 0
    s_or_b64 s[54:55], s[54:55], vcc
    v_cmp_nle_f32 vcc, s59, v166
    s_nop 0
    s_or_b64 s[54:55], s[54:55], vcc
    v_cmp_nge_f32 vcc, s60, v166
    s_nop 0
    s_or_b64 s[54:55], s[54:55], vcc
    v_cmp_nle_f32 vcc, s59, v167
    s_nop 0
    s_or_b64 s[54:55], s[54:55], vcc
    v_cmp_nge_f32 vcc, s60, v167
    s_nop 0
    s_or_b64 s[54:55], s[54:55], vcc
    s_cmp_lg_u64 s[54:55], 0
    s_cselect_b32 s54, 1, 0
    v_mov_b32 v128, s54
    s_lshl_b32 s54, s3, 2
    s_add_u32 s54, s54, s100
    s_add_u32 s54, s54, 12288
    v_mov_b32 v129, s54
    ds_write_b32 v129, v128
    s_cmp_lg_u32 s3, 0
    s_cbranch_scc1 L_concat_heads__mha_block_cached__gqa_block_cached__near_ridge_kernel_rdy
    v_lshrrev_b32 v130, 4, v184
    v_and_b32 v131, 3, v130
    s_andn2_b32 s54, s2, 0x18
    s_andn2_b32 s55, s2, 3
    v_lshl_add_u32 v132, v131, 3, s54
    v_add_u32 v133, s55, v131
    v_cmp_gt_u32 vcc, 4, v130
    s_nop 1
    v_cndmask_b32 v132, v133, v132, vcc
    s_mov_b32 s50, 0
L_concat_heads__mha_block_cached__gqa_block_cached__near_ridge_kernel_rdyl:
    buffer_load_ubyte v133, v132, s[20:23], 0 offen sc1
    s_waitcnt vmcnt(0)
    v_cmp_eq_u32 vcc, 1, v133
    s_nop 0
    s_and_b32 s54, vcc_lo, 0xff
    s_cmp_eq_u32 s54, 0xff
    s_cbranch_scc1 L_concat_heads__mha_block_cached__gqa_block_cached__near_ridge_kernel_rdy
    s_sleep 8
    s_add_u32 s50, s50, 1
    s_cmp_lt_u32 s50, 0x100000
    s_cbranch_scc1 L_concat_heads__mha_block_cached__gqa_block_cached__near_ridge_kernel_rdyl
L_concat_heads__mha_block_cached__gqa_block_cached__near_ridge_kernel_rdy:
    s_add_u32 s16, s16, 4
    v_mov_b32 v187, 1
    s_mov_b64 exec, 1
    ds_add_rtn_u32 v187, v186, v187
    s_mov_b64 exec, -1
    s_waitcnt lgkmcnt(0)
    v_readfirstlane_b32 s17, v187
    s_nop 0
    s_add_u32 s17, s17, 1
    s_cmp_ge_u32 s17, s16
    s_cbranch_scc1 L_gb11_d
    s_mov_b32 s18, 0
L_gb11_l:
    ds_read_b32 v187, v186
    s_add_u32 s18, s18, 1
    s_cmp_ge_u32 s18, 0x200000
    s_cbranch_scc1 L_gb11_d
    s_waitcnt lgkmcnt(0)
    v_readfirstlane_b32 s17, v187
    s_nop 0
    s_cmp_ge_u32 s17, s16
    s_cbranch_scc0 L_gb11_l
L_gb11_d:
    v_mov_b32 v136, s100
    ds_read_b128 v[128:131], v136 offset:12288
    s_waitcnt lgkmcnt(0)
    v_or3_b32 v128, v128, v129, v130
    v_or_b32 v128, v128, v131
    s_nop 0
    v_readfirstlane_b32 s54, v128
    s_nop 0
    s_cmp_lg_u32 s54, 0
    s_cbranch_scc1 L_concat_heads__mha_block_cached__gqa_block_cached__near_ridge_kernel_slow
    v_rcp_f32 v164, v164
    v_rcp_f32 v165, v165
    v_rcp_f32 v166, v166
    v_rcp_f32 v167, v167
    v_add_f32 v96, v96, v104
    v_add_f32 v112, v112, v120
    v_add_f32 v97, v97, v105
    v_add_f32 v113, v113, v121
    v_add_f32 v98, v98, v106
    v_add_f32 v114, v114, v122
    v_add_f32 v99, v99, v107
    v_add_f32 v115, v115, v123
    v_add_f32 v100, v100, v108
    v_add_f32 v116, v116, v124
    v_add_f32 v101, v101, v109
    v_add_f32 v117, v117, v125
    v_add_f32 v102, v102, v110
    v_add_f32 v118, v118, v126
    v_add_f32 v103, v103, v111
    v_add_f32 v119, v119, v127
    v_add_f32 v96, v96, v112
    v_add_f32 v97, v97, v113
    v_add_f32 v98, v98, v114
    v_add_f32 v99, v99, v115
    v_add_f32 v100, v100, v116
    v_add_f32 v101, v101, v117
    v_add_f32 v102, v102, v118
    v_add_f32 v103, v103, v119
    v_mul_f32 v96, v96, v167
    v_mul_f32 v97, v97, v167
    v_mul_f32 v98, v98, v167
    v_mul_f32 v99, v99, v167
    v_mul_f32 v100, v100, v167
    v_mul_f32 v101, v101, v167
    v_mul_f32 v102, v102, v167
    v_mul_f32 v103, v103, v167
    v_cvt_pk_bf16_f32 v152, v96, v97
    v_cvt_pk_bf16_f32 v153, v98, v99
    v_cvt_pk_bf16_f32 v154, v100, v101
    v_cvt_pk_bf16_f32 v155, v102, v103
    s_lshl_b32 s54, s3, 10
    v_add_u32 v182, s54, v185
    s_add_u32 s54, s54, 1572864
    buffer_store_dwordx4 v[152:155], v184, s[44:47], s54 offen sc1
    ds_write_b128 v182, v[152:155] offset:4096
    s_add_u32 s54, s61, 0
    v_mul_f32 v0, v0, v164
    v_mul_f32 v1, v1, v164
    v_mul_f32 v2, v2, v164
    v_mul_f32 v3, v3, v164
    v_mul_f32 v4, v4, v164
    v_mul_f32 v5, v5, v164
    v_mul_f32 v6, v6, v164
    v_mul_f32 v7, v7, v164
    v_cvt_pk_bf16_f32 v104, v0, v1
    v_cvt_pk_bf16_f32 v105, v2, v3
    v_cvt_pk_bf16_f32 v106, v4, v5
    v_cvt_pk_bf16_f32 v107, v6, v7
    buffer_store_dwordx4 v[104:107], v184, s[44:47], s54 offen offset:0 sc1
    v_mul_f32 v8, v8, v164
    v_mul_f32 v9, v9, v164
    v_mul_f32 v10, v10, v164
    v_mul_f32 v11, v11, v164
    v_mul_f32 v12, v12, v164
    v_mul_f32 v13, v13, v164
    v_mul_f32 v14, v14, v164
    v_mul_f32 v15, v15, v164
    v_cvt_pk_bf16_f32 v108, v8, v9
    v_cvt_pk_bf16_f32 v109, v10, v11
    v_cvt_pk_bf16_f32 v110, v12, v13
    v_cvt_pk_bf16_f32 v111, v14, v15
    buffer_store_dwordx4 v[108:111], v184, s[44:47], s54 offen offset:1024 sc1
    v_mul_f32 v16, v16, v164
    v_mul_f32 v17, v17, v164
    v_mul_f32 v18, v18, v164
    v_mul_f32 v19, v19, v164
    v_mul_f32 v20, v20, v164
    v_mul_f32 v21, v21, v164
    v_mul_f32 v22, v22, v164
    v_mul_f32 v23, v23, v164
    v_cvt_pk_bf16_f32 v112, v16, v17
    v_cvt_pk_bf16_f32 v113, v18, v19
    v_cvt_pk_bf16_f32 v114, v20, v21
    v_cvt_pk_bf16_f32 v115, v22, v23
    buffer_store_dwordx4 v[112:115], v184, s[44:47], s54 offen offset:2048 sc1
    v_mul_f32 v24, v24, v164
    v_mul_f32 v25, v25, v164
    v_mul_f32 v26, v26, v164
    v_mul_f32 v27, v27, v164
    v_mul_f32 v28, v28, v164
    v_mul_f32 v29, v29, v164
    v_mul_f32 v30, v30, v164
    v_mul_f32 v31, v31, v164
    v_cvt_pk_bf16_f32 v116, v24, v25
    v_cvt_pk_bf16_f32 v117, v26, v27
    v_cvt_pk_bf16_f32 v118, v28, v29
    v_cvt_pk_bf16_f32 v119, v30, v31
    buffer_store_dwordx4 v[116:119], v184, s[44:47], s54 offen offset:3072 sc1
    s_add_u32 s54, s61, 131072
    v_mul_f32 v32, v32, v165
    v_mul_f32 v33, v33, v165
    v_mul_f32 v34, v34, v165
    v_mul_f32 v35, v35, v165
    v_mul_f32 v36, v36, v165
    v_mul_f32 v37, v37, v165
    v_mul_f32 v38, v38, v165
    v_mul_f32 v39, v39, v165
    v_cvt_pk_bf16_f32 v120, v32, v33
    v_cvt_pk_bf16_f32 v121, v34, v35
    v_cvt_pk_bf16_f32 v122, v36, v37
    v_cvt_pk_bf16_f32 v123, v38, v39
    buffer_store_dwordx4 v[120:123], v184, s[44:47], s54 offen offset:0 sc1
    v_mul_f32 v40, v40, v165
    v_mul_f32 v41, v41, v165
    v_mul_f32 v42, v42, v165
    v_mul_f32 v43, v43, v165
    v_mul_f32 v44, v44, v165
    v_mul_f32 v45, v45, v165
    v_mul_f32 v46, v46, v165
    v_mul_f32 v47, v47, v165
    v_cvt_pk_bf16_f32 v124, v40, v41
    v_cvt_pk_bf16_f32 v125, v42, v43
    v_cvt_pk_bf16_f32 v126, v44, v45
    v_cvt_pk_bf16_f32 v127, v46, v47
    buffer_store_dwordx4 v[124:127], v184, s[44:47], s54 offen offset:1024 sc1
    v_mul_f32 v48, v48, v165
    v_mul_f32 v49, v49, v165
    v_mul_f32 v50, v50, v165
    v_mul_f32 v51, v51, v165
    v_mul_f32 v52, v52, v165
    v_mul_f32 v53, v53, v165
    v_mul_f32 v54, v54, v165
    v_mul_f32 v55, v55, v165
    v_cvt_pk_bf16_f32 v128, v48, v49
    v_cvt_pk_bf16_f32 v129, v50, v51
    v_cvt_pk_bf16_f32 v130, v52, v53
    v_cvt_pk_bf16_f32 v131, v54, v55
    buffer_store_dwordx4 v[128:131], v184, s[44:47], s54 offen offset:2048 sc1
    v_mul_f32 v56, v56, v165
    v_mul_f32 v57, v57, v165
    v_mul_f32 v58, v58, v165
    v_mul_f32 v59, v59, v165
    v_mul_f32 v60, v60, v165
    v_mul_f32 v61, v61, v165
    v_mul_f32 v62, v62, v165
    v_mul_f32 v63, v63, v165
    v_cvt_pk_bf16_f32 v132, v56, v57
    v_cvt_pk_bf16_f32 v133, v58, v59
    v_cvt_pk_bf16_f32 v134, v60, v61
    v_cvt_pk_bf16_f32 v135, v62, v63
    buffer_store_dwordx4 v[132:135], v184, s[44:47], s54 offen offset:3072 sc1
    s_add_u32 s54, s61, 262144
    v_mul_f32 v64, v64, v166
    v_mul_f32 v65, v65, v166
    v_mul_f32 v66, v66, v166
    v_mul_f32 v67, v67, v166
    v_mul_f32 v68, v68, v166
    v_mul_f32 v69, v69, v166
    v_mul_f32 v70, v70, v166
    v_mul_f32 v71, v71, v166
    v_cvt_pk_bf16_f32 v136, v64, v65
    v_cvt_pk_bf16_f32 v137, v66, v67
    v_cvt_pk_bf16_f32 v138, v68, v69
    v_cvt_pk_bf16_f32 v139, v70, v71
    buffer_store_dwordx4 v[136:139], v184, s[44:47], s54 offen offset:0 sc1
    v_mul_f32 v72, v72, v166
    v_mul_f32 v73, v73, v166
    v_mul_f32 v74, v74, v166
    v_mul_f32 v75, v75, v166
    v_mul_f32 v76, v76, v166
    v_mul_f32 v77, v77, v166
    v_mul_f32 v78, v78, v166
    v_mul_f32 v79, v79, v166
    v_cvt_pk_bf16_f32 v140, v72, v73
    v_cvt_pk_bf16_f32 v141, v74, v75
    v_cvt_pk_bf16_f32 v142, v76, v77
    v_cvt_pk_bf16_f32 v143, v78, v79
    buffer_store_dwordx4 v[140:143], v184, s[44:47], s54 offen offset:1024 sc1
    v_mul_f32 v80, v80, v166
    v_mul_f32 v81, v81, v166
    v_mul_f32 v82, v82, v166
    v_mul_f32 v83, v83, v166
    v_mul_f32 v84, v84, v166
    v_mul_f32 v85, v85, v166
    v_mul_f32 v86, v86, v166
    v_mul_f32 v87, v87, v166
    v_cvt_pk_bf16_f32 v144, v80, v81
    v_cvt_pk_bf16_f32 v145, v82, v83
    v_cvt_pk_bf16_f32 v146, v84, v85
    v_cvt_pk_bf16_f32 v147, v86, v87
    buffer_store_dwordx4 v[144:147], v184, s[44:47], s54 offen offset:2048 sc1
    v_mul_f32 v88, v88, v166
    v_mul_f32 v89, v89, v166
    v_mul_f32 v90, v90, v166
    v_mul_f32 v91, v91, v166
    v_mul_f32 v92, v92, v166
    v_mul_f32 v93, v93, v166
    v_mul_f32 v94, v94, v166
    v_mul_f32 v95, v95, v166
    v_cvt_pk_bf16_f32 v148, v88, v89
    v_cvt_pk_bf16_f32 v149, v90, v91
    v_cvt_pk_bf16_f32 v150, v92, v93
    v_cvt_pk_bf16_f32 v151, v94, v95
    buffer_store_dwordx4 v[148:151], v184, s[44:47], s54 offen offset:3072 sc1
    s_waitcnt lgkmcnt(0)
    s_branch L_concat_heads__mha_block_cached__gqa_block_cached__near_ridge_kernel_oproj
L_concat_heads__mha_block_cached__gqa_block_cached__near_ridge_kernel_slow:
    s_nop 7
    s_add_u32 s16, s16, 4
    v_mov_b32 v187, 1
    s_mov_b64 exec, 1
    ds_add_rtn_u32 v187, v186, v187
    s_mov_b64 exec, -1
    s_waitcnt lgkmcnt(0)
    v_readfirstlane_b32 s17, v187
    s_nop 0
    s_add_u32 s17, s17, 1
    s_cmp_ge_u32 s17, s16
    s_cbranch_scc1 L_gb12_d
    s_mov_b32 s18, 0
L_gb12_l:
    ds_read_b32 v187, v186
    s_add_u32 s18, s18, 1
    s_cmp_ge_u32 s18, 0x200000
    s_cbranch_scc1 L_gb12_d
    s_waitcnt lgkmcnt(0)
    v_readfirstlane_b32 s17, v187
    s_nop 0
    s_cmp_ge_u32 s17, s16
    s_cbranch_scc0 L_gb12_l
L_gb12_d:
    s_mov_b32 s49, 0
    s_add_u32 m0, s53, 32768
    s_nop 0
    buffer_load_dwordx4 v174, s[36:39], s49 offen nt lds
    s_add_u32 m0, s53, 33664
    s_nop 0
    buffer_load_dwordx4 v174, s[36:39], s49 offen offset:128 nt lds
    s_mov_b32 s49, 0
    s_add_u32 m0, s52, 0
    s_nop 0
    buffer_load_dwordx4 v175, s[40:43], s49 offen nt lds
    s_add_u32 m0, s52, 896
    s_nop 0
    buffer_load_dwordx4 v175, s[40:43], s49 offen offset:128 nt lds
    s_mov_b32 s49, 8192
    s_add_u32 m0, s53, 40960
    s_nop 0
    buffer_load_dwordx4 v174, s[36:39], s49 offen nt lds
    s_add_u32 m0, s53, 41856
    s_nop 0
    buffer_load_dwordx4 v174, s[36:39], s49 offen offset:128 nt lds
    s_mov_b32 s49, 8192
    s_add_u32 m0, s52, 8192
    s_nop 0
    buffer_load_dwordx4 v175, s[40:43], s49 offen nt lds
    s_add_u32 m0, s52, 9088
    s_nop 0
    buffer_load_dwordx4 v175, s[40:43], s49 offen offset:128 nt lds
    s_mov_b32 s49, 16384
    s_add_u32 m0, s53, 49152
    s_nop 0
    buffer_load_dwordx4 v174, s[36:39], s49 offen nt lds
    s_add_u32 m0, s53, 50048
    s_nop 0
    buffer_load_dwordx4 v174, s[36:39], s49 offen offset:128 nt lds
    s_mov_b32 s49, 16384
    s_add_u32 m0, s52, 16384
    s_nop 0
    buffer_load_dwordx4 v175, s[40:43], s49 offen nt lds
    s_add_u32 m0, s52, 17280
    s_nop 0
    buffer_load_dwordx4 v175, s[40:43], s49 offen offset:128 nt lds
    s_mov_b32 s49, 24576
    v_mov_b32 v176, 0xff800000
    v_mov_b32 v177, 0xff800000
    v_mov_b32 v178, 0xff800000
    v_mov_b32 v179, 0xff800000
    s_lshl_b32 s55, s56, 1
    s_add_u32 s55, s55, s3
    s_and_b32 s55, s55, 3
    s_waitcnt vmcnt(8) lgkmcnt(0)
    s_add_u32 s16, s16, 4
    v_mov_b32 v187, 1
    s_mov_b64 exec, 1
    ds_add_rtn_u32 v187, v186, v187
    s_mov_b64 exec, -1
    s_waitcnt lgkmcnt(0)
    v_readfirstlane_b32 s17, v187
    s_nop 0
    s_add_u32 s17, s17, 1
    s_cmp_ge_u32 s17, s16
    s_cbranch_scc1 L_gb13_d
    s_mov_b32 s18, 0
L_gb13_l:
    ds_read_b32 v187, v186
    s_add_u32 s18, s18, 1
    s_cmp_ge_u32 s18, 0x200000
    s_cbranch_scc1 L_gb13_d
    s_waitcnt lgkmcnt(0)
    v_readfirstlane_b32 s17, v187
    s_nop 0
    s_cmp_ge_u32 s17, s16
    s_cbranch_scc0 L_gb13_l
L_gb13_d:
    ds_read_b128 a[48:51], v168 offset:32768
    ds_read_b128 a[52:55], v169 offset:32768
    ds_read_b128 a[56:59], v168 offset:33792
    ds_read_b128 a[60:63], v169 offset:33792
    s_waitcnt lgkmcnt(3)
    v_mfma_f32_16x16x32_bf16 v[128:131], a[48:51], a[0:3], 0
    v_mfma_f32_16x16x32_bf16 v[132:135], a[48:51], a[16:19], 0
    v_mfma_f32_16x16x32_bf16 v[136:139], a[48:51], a[32:35], 0
    s_waitcnt lgkmcnt(2)
    v_mfma_f32_16x16x32_bf16 v[128:131], a[52:55], a[4:7], v[128:131]
    v_mfma_f32_16x16x32_bf16 v[132:135], a[52:55], a[20:23], v[132:135]
    v_mfma_f32_16x16x32_bf16 v[136:139], a[52:55], a[36:39], v[136:139]
    s_waitcnt lgkmcnt(1)
    v_mfma_f32_16x16x32_bf16 v[128:131], a[56:59], a[8:11], v[128:131]
    v_mfma_f32_16x16x32_bf16 v[132:135], a[56:59], a[24:27], v[132:135]
    v_mfma_f32_16x16x32_bf16 v[136:139], a[56:59], a[40:43], v[136:139]
    s_waitcnt lgkmcnt(0)
    v_mfma_f32_16x16x32_bf16 v[128:131], a[60:63], a[12:15], v[128:131]
    v_mfma_f32_16x16x32_bf16 v[132:135], a[60:63], a[28:31], v[132:135]
    v_mfma_f32_16x16x32_bf16 v[136:139], a[60:63], a[44:47], v[136:139]
    s_mov_b32 s50, 0
.p2align 3
L_concat_heads__mha_block_cached__gqa_block_cached__near_ridge_kernel_m_loop:
    ds_read_b128 a[48:51], v168 offset:36864
    ds_read_b128 a[52:55], v169 offset:36864
    ds_read_b128 a[56:59], v168 offset:37888
    s_waitcnt vmcnt(6)
    s_add_u32 s16, s16, 4
    v_mov_b32 v187, 1
    s_mov_b64 exec, 1
    ds_add_rtn_u32 v187, v186, v187
    s_mov_b64 exec, -1
    s_waitcnt lgkmcnt(0)
    v_readfirstlane_b32 s17, v187
    s_nop 0
    s_add_u32 s17, s17, 1
    s_cmp_ge_u32 s17, s16
    s_cbranch_scc1 L_gb14_d
    s_mov_b32 s18, 0
L_gb14_l:
    ds_read_b32 v187, v186
    s_add_u32 s18, s18, 1
    s_cmp_ge_u32 s18, 0x200000
    s_cbranch_scc1 L_gb14_d
    s_waitcnt lgkmcnt(0)
    v_readfirstlane_b32 s17, v187
    s_nop 0
    s_cmp_ge_u32 s17, s16
    s_cbranch_scc0 L_gb14_l
L_gb14_d:
    v_mfma_f32_16x16x32_bf16 v[140:143], a[48:51], a[0:3], 0
    ds_read_b128 a[60:63], v169 offset:37888
    v_max3_f32 v176, v176, v128, v129
    v_max3_f32 v176, v176, v130, v131
    v_mfma_f32_16x16x32_bf16 v[144:147], a[48:51], a[16:19], 0
    ds_read_b128 a[64:67], v168 offset:40960
    v_max3_f32 v177, v177, v132, v133
    v_max3_f32 v177, v177, v134, v135
    v_mfma_f32_16x16x32_bf16 v[148:151], a[48:51], a[32:35], 0
    ds_read_b128 a[48:51], v169 offset:40960
    v_max3_f32 v178, v178, v136, v137
    v_max3_f32 v178, v178, v138, v139
    v_mfma_f32_16x16x32_bf16 v[140:143], a[52:55], a[4:7], v[140:143]
    s_add_u32 m0, s53, 57344
    s_nop 0
    buffer_load_dwordx4 v174, s[36:39], s49 offen nt lds
    s_add_u32 m0, s53, 58240
    v_mfma_f32_16x16x32_bf16 v[144:147], a[52:55], a[20:23], v[144:147]
    buffer_load_dwordx4 v174, s[36:39], s49 offen offset:128 nt lds
    s_add_u32 m0, s52, 24576
    s_nop 0
    buffer_load_dwordx4 v175, s[40:43], s49 offen nt lds
    v_mfma_f32_16x16x32_bf16 v[148:151], a[52:55], a[36:39], v[148:151]
    ds_read_b128 a[52:55], v168 offset:41984
    s_add_u32 m0, s52, 25472
    s_nop 0
    buffer_load_dwordx4 v175, s[40:43], s49 offen offset:128 nt lds
    v_mfma_f32_16x16x32_bf16 v[140:143], a[56:59], a[8:11], v[140:143]
    s_add_u32 s49, s49, 8192
    v_mfma_f32_16x16x32_bf16 v[144:147], a[56:59], a[24:27], v[144:147]
    v_mfma_f32_16x16x32_bf16 v[148:151], a[56:59], a[40:43], v[148:151]
    ds_read_b128 a[56:59], v169 offset:41984
    s_waitcnt lgkmcnt(3)
    v_mfma_f32_16x16x32_bf16 v[140:143], a[60:63], a[12:15], v[140:143]
    v_mfma_f32_16x16x32_bf16 v[144:147], a[60:63], a[28:31], v[144:147]
    v_mfma_f32_16x16x32_bf16 v[148:151], a[60:63], a[44:47], v[148:151]
    v_mfma_f32_16x16x32_bf16 v[128:131], a[64:67], a[0:3], 0
    v_mfma_f32_16x16x32_bf16 v[132:135], a[64:67], a[16:19], 0
    v_mfma_f32_16x16x32_bf16 v[136:139], a[64:67], a[32:35], 0
    s_waitcnt lgkmcnt(1)
    s_nop 1
    v_max3_f32 v176, v176, v140, v141
    v_max3_f32 v176, v176, v142, v143
    v_mfma_f32_16x16x32_bf16 v[128:131], a[48:51], a[4:7], v[128:131]
    v_max3_f32 v177, v177, v144, v145
    v_max3_f32 v177, v177, v146, v147
    v_mfma_f32_16x16x32_bf16 v[132:135], a[48:51], a[20:23], v[132:135]
    v_max3_f32 v178, v178, v148, v149
    v_max3_f32 v178, v178, v150, v151
    v_mfma_f32_16x16x32_bf16 v[136:139], a[48:51], a[36:39], v[136:139]
    v_mfma_f32_16x16x32_bf16 v[128:131], a[52:55], a[8:11], v[128:131]
    v_mfma_f32_16x16x32_bf16 v[132:135], a[52:55], a[24:27], v[132:135]
    v_mfma_f32_16x16x32_bf16 v[136:139], a[52:55], a[40:43], v[136:139]
    s_waitcnt lgkmcnt(0)
    v_mfma_f32_16x16x32_bf16 v[128:131], a[56:59], a[12:15], v[128:131]
    v_mfma_f32_16x16x32_bf16 v[132:135], a[56:59], a[28:31], v[132:135]
    v_mfma_f32_16x16x32_bf16 v[136:139], a[56:59], a[44:47], v[136:139]
    s_cmp_lg_u32 s3, 0
    s_cbranch_scc1 L_concat_heads__mha_block_cached__gqa_block_cached__near_ridge_kernel_m_x0
    ds_read_b128 a[48:51], v185 offset:0
    ds_read_b128 a[52:55], v168 offset:32768
    ds_read_b128 a[56:59], v168 offset:36864
    s_waitcnt lgkmcnt(1)
    v_mfma_f32_16x16x32_bf16 v[140:143], a[52:55], a[48:51], 0
    s_waitcnt lgkmcnt(0)
    v_mfma_f32_16x16x32_bf16 v[144:147], a[56:59], a[48:51], 0
    s_nop 7
    ds_read_b128 a[48:51], v185 offset:1024
    ds_read_b128 a[52:55], v169 offset:32768
    ds_read_b128 a[56:59], v169 offset:36864
    s_waitcnt lgkmcnt(1)
    v_mfma_f32_16x16x32_bf16 v[140:143], a[52:55], a[48:51], v[140:143]
    s_waitcnt lgkmcnt(0)
    v_mfma_f32_16x16x32_bf16 v[144:147], a[56:59], a[48:51], v[144:147]
    s_nop 7
    ds_read_b128 a[48:51], v185 offset:2048
    ds_read_b128 a[52:55], v168 offset:33792
    ds_read_b128 a[56:59], v168 offset:37888
    s_waitcnt lgkmcnt(1)
    v_mfma_f32_16x16x32_bf16 v[140:143], a[52:55], a[48:51], v[140:143]
    s_waitcnt lgkmcnt(0)
    v_mfma_f32_16x16x32_bf16 v[144:147], a[56:59], a[48:51], v[144:147]
    s_nop 7
    ds_read_b128 a[48:51], v185 offset:3072
    ds_read_b128 a[52:55], v169 offset:33792
    ds_read_b128 a[56:59], v169 offset:37888
    s_waitcnt lgkmcnt(1)
    v_mfma_f32_16x16x32_bf16 v[140:143], a[52:55], a[48:51], v[140:143]
    s_waitcnt lgkmcnt(0)
    v_mfma_f32_16x16x32_bf16 v[144:147], a[56:59], a[48:51], v[144:147]
    s_nop 7
    v_max3_f32 v179, v179, v140, v141
    v_max3_f32 v179, v179, v142, v143
    v_max3_f32 v179, v179, v144, v145
    v_max3_f32 v179, v179, v146, v147
    s_nop 7
L_concat_heads__mha_block_cached__gqa_block_cached__near_ridge_kernel_m_x0:
    s_nop 1
    ds_read_b128 a[48:51], v168 offset:45056
    ds_read_b128 a[52:55], v169 offset:45056
    ds_read_b128 a[56:59], v168 offset:46080
    s_waitcnt vmcnt(6)
    s_add_u32 s16, s16, 4
    v_mov_b32 v187, 1
    s_mov_b64 exec, 1
    ds_add_rtn_u32 v187, v186, v187
    s_mov_b64 exec, -1
    s_waitcnt lgkmcnt(0)
    v_readfirstlane_b32 s17, v187
    s_nop 0
    s_add_u32 s17, s17, 1
    s_cmp_ge_u32 s17, s16
    s_cbranch_scc1 L_gb15_d
    s_mov_b32 s18, 0
L_gb15_l:
    ds_read_b32 v187, v186
    s_add_u32 s18, s18, 1
    s_cmp_ge_u32 s18, 0x200000
    s_cbranch_scc1 L_gb15_d
    s_waitcnt lgkmcnt(0)
    v_readfirstlane_b32 s17, v187
    s_nop 0
    s_cmp_ge_u32 s17, s16
    s_cbranch_scc0 L_gb15_l
L_gb15_d:
    v_mfma_f32_16x16x32_bf16 v[140:143], a[48:51], a[0:3], 0
    ds_read_b128 a[60:63], v169 offset:46080
    v_max3_f32 v176, v176, v128, v129
    v_max3_f32 v176, v176, v130, v131
    v_mfma_f32_16x16x32_bf16 v[144:147], a[48:51], a[16:19], 0
    ds_read_b128 a[64:67], v168 offset:49152
    v_max3_f32 v177, v177, v132, v133
    v_max3_f32 v177, v177, v134, v135
    v_mfma_f32_16x16x32_bf16 v[148:151], a[48:51], a[32:35], 0
    ds_read_b128 a[48:51], v169 offset:49152
    v_max3_f32 v178, v178, v136, v137
    v_max3_f32 v178, v178, v138, v139
    v_mfma_f32_16x16x32_bf16 v[140:143], a[52:55], a[4:7], v[140:143]
    s_add_u32 m0, s53, 32768
    s_nop 0
    buffer_load_dwordx4 v174, s[36:39], s49 offen nt lds
    s_add_u32 m0, s53, 33664
    v_mfma_f32_16x16x32_bf16 v[144:147], a[52:55], a[20:23], v[144:147]
    buffer_load_dwordx4 v174, s[36:39], s49 offen offset:128 nt lds
    s_add_u32 m0, s52, 0
    s_nop 0
    buffer_load_dwordx4 v175, s[40:43], s49 offen nt lds
    v_mfma_f32_16x16x32_bf16 v[148:151], a[52:55], a[36:39], v[148:151]
    ds_read_b128 a[52:55], v168 offset:50176
    s_add_u32 m0, s52, 896
    s_nop 0
    buffer_load_dwordx4 v175, s[40:43], s49 offen offset:128 nt lds
    v_mfma_f32_16x16x32_bf16 v[140:143], a[56:59], a[8:11], v[140:143]
    s_add_u32 s49, s49, 8192
    v_mfma_f32_16x16x32_bf16 v[144:147], a[56:59], a[24:27], v[144:147]
    v_mfma_f32_16x16x32_bf16 v[148:151], a[56:59], a[40:43], v[148:151]
    ds_read_b128 a[56:59], v169 offset:50176
    s_waitcnt lgkmcnt(3)
    v_mfma_f32_16x16x32_bf16 v[140:143], a[60:63], a[12:15], v[140:143]
    v_mfma_f32_16x16x32_bf16 v[144:147], a[60:63], a[28:31], v[144:147]
    v_mfma_f32_16x16x32_bf16 v[148:151], a[60:63], a[44:47], v[148:151]
    v_mfma_f32_16x16x32_bf16 v[128:131], a[64:67], a[0:3], 0
    v_mfma_f32_16x16x32_bf16 v[132:135], a[64:67], a[16:19], 0
    v_mfma_f32_16x16x32_bf16 v[136:139], a[64:67], a[32:35], 0
    s_waitcnt lgkmcnt(1)
    s_nop 1
    v_max3_f32 v176, v176, v140, v141
    v_max3_f32 v176, v176, v142, v143
    v_mfma_f32_16x16x32_bf16 v[128:131], a[48:51], a[4:7], v[128:131]
    v_max3_f32 v177, v177, v144, v145
    v_max3_f32 v177, v177, v146, v147
    v_mfma_f32_16x16x32_bf16 v[132:135], a[48:51], a[20:23], v[132:135]
    v_max3_f32 v178, v178, v148, v149
    v_max3_f32 v178, v178, v150, v151
    v_mfma_f32_16x16x32_bf16 v[136:139], a[48:51], a[36:39], v[136:139]
    v_mfma_f32_16x16x32_bf16 v[128:131], a[52:55], a[8:11], v[128:131]
    v_mfma_f32_16x16x32_bf16 v[132:135], a[52:55], a[24:27], v[132:135]
    v_mfma_f32_16x16x32_bf16 v[136:139], a[52:55], a[40:43], v[136:139]
    s_waitcnt lgkmcnt(0)
    v_mfma_f32_16x16x32_bf16 v[128:131], a[56:59], a[12:15], v[128:131]
    v_mfma_f32_16x16x32_bf16 v[132:135], a[56:59], a[28:31], v[132:135]
    v_mfma_f32_16x16x32_bf16 v[136:139], a[56:59], a[44:47], v[136:139]
    s_cmp_lg_u32 s3, 1
    s_cbranch_scc1 L_concat_heads__mha_block_cached__gqa_block_cached__near_ridge_kernel_m_x1
    ds_read_b128 a[48:51], v185 offset:0
    ds_read_b128 a[52:55], v168 offset:40960
    ds_read_b128 a[56:59], v168 offset:45056
    s_waitcnt lgkmcnt(1)
    v_mfma_f32_16x16x32_bf16 v[140:143], a[52:55], a[48:51], 0
    s_waitcnt lgkmcnt(0)
    v_mfma_f32_16x16x32_bf16 v[144:147], a[56:59], a[48:51], 0
    s_nop 7
    ds_read_b128 a[48:51], v185 offset:1024
    ds_read_b128 a[52:55], v169 offset:40960
    ds_read_b128 a[56:59], v169 offset:45056
    s_waitcnt lgkmcnt(1)
    v_mfma_f32_16x16x32_bf16 v[140:143], a[52:55], a[48:51], v[140:143]
    s_waitcnt lgkmcnt(0)
    v_mfma_f32_16x16x32_bf16 v[144:147], a[56:59], a[48:51], v[144:147]
    s_nop 7
    ds_read_b128 a[48:51], v185 offset:2048
    ds_read_b128 a[52:55], v168 offset:41984
    ds_read_b128 a[56:59], v168 offset:46080
    s_waitcnt lgkmcnt(1)
    v_mfma_f32_16x16x32_bf16 v[140:143], a[52:55], a[48:51], v[140:143]
    s_waitcnt lgkmcnt(0)
    v_mfma_f32_16x16x32_bf16 v[144:147], a[56:59], a[48:51], v[144:147]
    s_nop 7
    ds_read_b128 a[48:51], v185 offset:3072
    ds_read_b128 a[52:55], v169 offset:41984
    ds_read_b128 a[56:59], v169 offset:46080
    s_waitcnt lgkmcnt(1)
    v_mfma_f32_16x16x32_bf16 v[140:143], a[52:55], a[48:51], v[140:143]
    s_waitcnt lgkmcnt(0)
    v_mfma_f32_16x16x32_bf16 v[144:147], a[56:59], a[48:51], v[144:147]
    s_nop 7
    v_max3_f32 v179, v179, v140, v141
    v_max3_f32 v179, v179, v142, v143
    v_max3_f32 v179, v179, v144, v145
    v_max3_f32 v179, v179, v146, v147
    s_nop 7
L_concat_heads__mha_block_cached__gqa_block_cached__near_ridge_kernel_m_x1:
    s_nop 1
    ds_read_b128 a[48:51], v168 offset:53248
    ds_read_b128 a[52:55], v169 offset:53248
    ds_read_b128 a[56:59], v168 offset:54272
    s_waitcnt vmcnt(6)
    s_add_u32 s16, s16, 4
    v_mov_b32 v187, 1
    s_mov_b64 exec, 1
    ds_add_rtn_u32 v187, v186, v187
    s_mov_b64 exec, -1
    s_waitcnt lgkmcnt(0)
    v_readfirstlane_b32 s17, v187
    s_nop 0
    s_add_u32 s17, s17, 1
    s_cmp_ge_u32 s17, s16
    s_cbranch_scc1 L_gb16_d
    s_mov_b32 s18, 0
L_gb16_l:
    ds_read_b32 v187, v186
    s_add_u32 s18, s18, 1
    s_cmp_ge_u32 s18, 0x200000
    s_cbranch_scc1 L_gb16_d
    s_waitcnt lgkmcnt(0)
    v_readfirstlane_b32 s17, v187
    s_nop 0
    s_cmp_ge_u32 s17, s16
    s_cbranch_scc0 L_gb16_l
L_gb16_d:
    v_mfma_f32_16x16x32_bf16 v[140:143], a[48:51], a[0:3], 0
    ds_read_b128 a[60:63], v169 offset:54272
    v_max3_f32 v176, v176, v128, v129
    v_max3_f32 v176, v176, v130, v131
    v_mfma_f32_16x16x32_bf16 v[144:147], a[48:51], a[16:19], 0
    ds_read_b128 a[64:67], v168 offset:57344
    v_max3_f32 v177, v177, v132, v133
    v_max3_f32 v177, v177, v134, v135
    v_mfma_f32_16x16x32_bf16 v[148:151], a[48:51], a[32:35], 0
    ds_read_b128 a[48:51], v169 offset:57344
    v_max3_f32 v178, v178, v136, v137
    v_max3_f32 v178, v178, v138, v139
    v_mfma_f32_16x16x32_bf16 v[140:143], a[52:55], a[4:7], v[140:143]
    s_add_u32 m0, s53, 40960
    s_nop 0
    buffer_load_dwordx4 v174, s[36:39], s49 offen nt lds
    s_add_u32 m0, s53, 41856
    v_mfma_f32_16x16x32_bf16 v[144:147], a[52:55], a[20:23], v[144:147]
    buffer_load_dwordx4 v174, s[36:39], s49 offen offset:128 nt lds
    s_add_u32 m0, s52, 8192
    s_nop 0
    buffer_load_dwordx4 v175, s[40:43], s49 offen nt lds
    v_mfma_f32_16x16x32_bf16 v[148:151], a[52:55], a[36:39], v[148:151]
    ds_read_b128 a[52:55], v168 offset:58368
    s_add_u32 m0, s52, 9088
    s_nop 0
    buffer_load_dwordx4 v175, s[40:43], s49 offen offset:128 nt lds
    v_mfma_f32_16x16x32_bf16 v[140:143], a[56:59], a[8:11], v[140:143]
    s_add_u32 s49, s49, 8192
    v_mfma_f32_16x16x32_bf16 v[144:147], a[56:59], a[24:27], v[144:147]
    v_mfma_f32_16x16x32_bf16 v[148:151], a[56:59], a[40:43], v[148:151]
    ds_read_b128 a[56:59], v169 offset:58368
    s_waitcnt lgkmcnt(3)
    v_mfma_f32_16x16x32_bf16 v[140:143], a[60:63], a[12:15], v[140:143]
    v_mfma_f32_16x16x32_bf16 v[144:147], a[60:63], a[28:31], v[144:147]
    v_mfma_f32_16x16x32_bf16 v[148:151], a[60:63], a[44:47], v[148:151]
    v_mfma_f32_16x16x32_bf16 v[128:131], a[64:67], a[0:3], 0
    v_mfma_f32_16x16x32_bf16 v[132:135], a[64:67], a[16:19], 0
    v_mfma_f32_16x16x32_bf16 v[136:139], a[64:67], a[32:35], 0
    s_waitcnt lgkmcnt(1)
    s_nop 1
    v_max3_f32 v176, v176, v140, v141
    v_max3_f32 v176, v176, v142, v143
    v_mfma_f32_16x16x32_bf16 v[128:131], a[48:51], a[4:7], v[128:131]
    v_max3_f32 v177, v177, v144, v145
    v_max3_f32 v177, v177, v146, v147
    v_mfma_f32_16x16x32_bf16 v[132:135], a[48:51], a[20:23], v[132:135]
    v_max3_f32 v178, v178, v148, v149
    v_max3_f32 v178, v178, v150, v151
    v_mfma_f32_16x16x32_bf16 v[136:139], a[48:51], a[36:39], v[136:139]
    v_mfma_f32_16x16x32_bf16 v[128:131], a[52:55], a[8:11], v[128:131]
    v_mfma_f32_16x16x32_bf16 v[132:135], a[52:55], a[24:27], v[132:135]
    v_mfma_f32_16x16x32_bf16 v[136:139], a[52:55], a[40:43], v[136:139]
    s_waitcnt lgkmcnt(0)
    v_mfma_f32_16x16x32_bf16 v[128:131], a[56:59], a[12:15], v[128:131]
    v_mfma_f32_16x16x32_bf16 v[132:135], a[56:59], a[28:31], v[132:135]
    v_mfma_f32_16x16x32_bf16 v[136:139], a[56:59], a[44:47], v[136:139]
    s_cmp_lg_u32 s3, 2
    s_cbranch_scc1 L_concat_heads__mha_block_cached__gqa_block_cached__near_ridge_kernel_m_x2
    ds_read_b128 a[48:51], v185 offset:0
    ds_read_b128 a[52:55], v168 offset:49152
    ds_read_b128 a[56:59], v168 offset:53248
    s_waitcnt lgkmcnt(1)
    v_mfma_f32_16x16x32_bf16 v[140:143], a[52:55], a[48:51], 0
    s_waitcnt lgkmcnt(0)
    v_mfma_f32_16x16x32_bf16 v[144:147], a[56:59], a[48:51], 0
    s_nop 7
    ds_read_b128 a[48:51], v185 offset:1024
    ds_read_b128 a[52:55], v169 offset:49152
    ds_read_b128 a[56:59], v169 offset:53248
    s_waitcnt lgkmcnt(1)
    v_mfma_f32_16x16x32_bf16 v[140:143], a[52:55], a[48:51], v[140:143]
    s_waitcnt lgkmcnt(0)
    v_mfma_f32_16x16x32_bf16 v[144:147], a[56:59], a[48:51], v[144:147]
    s_nop 7
    ds_read_b128 a[48:51], v185 offset:2048
    ds_read_b128 a[52:55], v168 offset:50176
    ds_read_b128 a[56:59], v168 offset:54272
    s_waitcnt lgkmcnt(1)
    v_mfma_f32_16x16x32_bf16 v[140:143], a[52:55], a[48:51], v[140:143]
    s_waitcnt lgkmcnt(0)
    v_mfma_f32_16x16x32_bf16 v[144:147], a[56:59], a[48:51], v[144:147]
    s_nop 7
    ds_read_b128 a[48:51], v185 offset:3072
    ds_read_b128 a[52:55], v169 offset:50176
    ds_read_b128 a[56:59], v169 offset:54272
    s_waitcnt lgkmcnt(1)
    v_mfma_f32_16x16x32_bf16 v[140:143], a[52:55], a[48:51], v[140:143]
    s_waitcnt lgkmcnt(0)
    v_mfma_f32_16x16x32_bf16 v[144:147], a[56:59], a[48:51], v[144:147]
    s_nop 7
    v_max3_f32 v179, v179, v140, v141
    v_max3_f32 v179, v179, v142, v143
    v_max3_f32 v179, v179, v144, v145
    v_max3_f32 v179, v179, v146, v147
    s_nop 7
L_concat_heads__mha_block_cached__gqa_block_cached__near_ridge_kernel_m_x2:
    s_nop 1
    ds_read_b128 a[48:51], v168 offset:61440
    ds_read_b128 a[52:55], v169 offset:61440
    ds_read_b128 a[56:59], v168 offset:62464
    s_waitcnt vmcnt(6)
    s_add_u32 s16, s16, 4
    v_mov_b32 v187, 1
    s_mov_b64 exec, 1
    ds_add_rtn_u32 v187, v186, v187
    s_mov_b64 exec, -1
    s_waitcnt lgkmcnt(0)
    v_readfirstlane_b32 s17, v187
    s_nop 0
    s_add_u32 s17, s17, 1
    s_cmp_ge_u32 s17, s16
    s_cbranch_scc1 L_gb17_d
    s_mov_b32 s18, 0
L_gb17_l:
    ds_read_b32 v187, v186
    s_add_u32 s18, s18, 1
    s_cmp_ge_u32 s18, 0x200000
    s_cbranch_scc1 L_gb17_d
    s_waitcnt lgkmcnt(0)
    v_readfirstlane_b32 s17, v187
    s_nop 0
    s_cmp_ge_u32 s17, s16
    s_cbranch_scc0 L_gb17_l
L_gb17_d:
    v_mfma_f32_16x16x32_bf16 v[140:143], a[48:51], a[0:3], 0
    ds_read_b128 a[60:63], v169 offset:62464
    v_max3_f32 v176, v176, v128, v129
    v_max3_f32 v176, v176, v130, v131
    v_mfma_f32_16x16x32_bf16 v[144:147], a[48:51], a[16:19], 0
    ds_read_b128 a[64:67], v168 offset:32768
    v_max3_f32 v177, v177, v132, v133
    v_max3_f32 v177, v177, v134, v135
    v_mfma_f32_16x16x32_bf16 v[148:151], a[48:51], a[32:35], 0
    ds_read_b128 a[48:51], v169 offset:32768
    v_max3_f32 v178, v178, v136, v137
    v_max3_f32 v178, v178, v138, v139
    v_mfma_f32_16x16x32_bf16 v[140:143], a[52:55], a[4:7], v[140:143]
    s_add_u32 m0, s53, 49152
    s_nop 0
    buffer_load_dwordx4 v174, s[36:39], s49 offen nt lds
    s_add_u32 m0, s53, 50048
    v_mfma_f32_16x16x32_bf16 v[144:147], a[52:55], a[20:23], v[144:147]
    buffer_load_dwordx4 v174, s[36:39], s49 offen offset:128 nt lds
    s_add_u32 m0, s52, 16384
    s_nop 0
    buffer_load_dwordx4 v175, s[40:43], s49 offen nt lds
    v_mfma_f32_16x16x32_bf16 v[148:151], a[52:55], a[36:39], v[148:151]
    ds_read_b128 a[52:55], v168 offset:33792
    s_add_u32 m0, s52, 17280
    s_nop 0
    buffer_load_dwordx4 v175, s[40:43], s49 offen offset:128 nt lds
    v_mfma_f32_16x16x32_bf16 v[140:143], a[56:59], a[8:11], v[140:143]
    s_add_u32 s49, s49, 8192
    v_mfma_f32_16x16x32_bf16 v[144:147], a[56:59], a[24:27], v[144:147]
    v_mfma_f32_16x16x32_bf16 v[148:151], a[56:59], a[40:43], v[148:151]
    ds_read_b128 a[56:59], v169 offset:33792
    s_waitcnt lgkmcnt(3)
    v_mfma_f32_16x16x32_bf16 v[140:143], a[60:63], a[12:15], v[140:143]
    v_mfma_f32_16x16x32_bf16 v[144:147], a[60:63], a[28:31], v[144:147]
    v_mfma_f32_16x16x32_bf16 v[148:151], a[60:63], a[44:47], v[148:151]
    v_mfma_f32_16x16x32_bf16 v[128:131], a[64:67], a[0:3], 0
    v_mfma_f32_16x16x32_bf16 v[132:135], a[64:67], a[16:19], 0
    v_mfma_f32_16x16x32_bf16 v[136:139], a[64:67], a[32:35], 0
    s_waitcnt lgkmcnt(1)
    s_nop 1
    v_max3_f32 v176, v176, v140, v141
    v_max3_f32 v176, v176, v142, v143
    v_mfma_f32_16x16x32_bf16 v[128:131], a[48:51], a[4:7], v[128:131]
    v_max3_f32 v177, v177, v144, v145
    v_max3_f32 v177, v177, v146, v147
    v_mfma_f32_16x16x32_bf16 v[132:135], a[48:51], a[20:23], v[132:135]
    v_max3_f32 v178, v178, v148, v149
    v_max3_f32 v178, v178, v150, v151
    v_mfma_f32_16x16x32_bf16 v[136:139], a[48:51], a[36:39], v[136:139]
    v_mfma_f32_16x16x32_bf16 v[128:131], a[52:55], a[8:11], v[128:131]
    v_mfma_f32_16x16x32_bf16 v[132:135], a[52:55], a[24:27], v[132:135]
    v_mfma_f32_16x16x32_bf16 v[136:139], a[52:55], a[40:43], v[136:139]
    s_waitcnt lgkmcnt(0)
    v_mfma_f32_16x16x32_bf16 v[128:131], a[56:59], a[12:15], v[128:131]
    v_mfma_f32_16x16x32_bf16 v[132:135], a[56:59], a[28:31], v[132:135]
    v_mfma_f32_16x16x32_bf16 v[136:139], a[56:59], a[44:47], v[136:139]
    s_cmp_lg_u32 s3, 3
    s_cbranch_scc1 L_concat_heads__mha_block_cached__gqa_block_cached__near_ridge_kernel_m_x3
    ds_read_b128 a[48:51], v185 offset:0
    ds_read_b128 a[52:55], v168 offset:57344
    ds_read_b128 a[56:59], v168 offset:61440
    s_waitcnt lgkmcnt(1)
    v_mfma_f32_16x16x32_bf16 v[140:143], a[52:55], a[48:51], 0
    s_waitcnt lgkmcnt(0)
    v_mfma_f32_16x16x32_bf16 v[144:147], a[56:59], a[48:51], 0
    s_nop 7
    ds_read_b128 a[48:51], v185 offset:1024
    ds_read_b128 a[52:55], v169 offset:57344
    ds_read_b128 a[56:59], v169 offset:61440
    s_waitcnt lgkmcnt(1)
    v_mfma_f32_16x16x32_bf16 v[140:143], a[52:55], a[48:51], v[140:143]
    s_waitcnt lgkmcnt(0)
    v_mfma_f32_16x16x32_bf16 v[144:147], a[56:59], a[48:51], v[144:147]
    s_nop 7
    ds_read_b128 a[48:51], v185 offset:2048
    ds_read_b128 a[52:55], v168 offset:58368
    ds_read_b128 a[56:59], v168 offset:62464
    s_waitcnt lgkmcnt(1)
    v_mfma_f32_16x16x32_bf16 v[140:143], a[52:55], a[48:51], v[140:143]
    s_waitcnt lgkmcnt(0)
    v_mfma_f32_16x16x32_bf16 v[144:147], a[56:59], a[48:51], v[144:147]
    s_nop 7
    ds_read_b128 a[48:51], v185 offset:3072
    ds_read_b128 a[52:55], v169 offset:58368
    ds_read_b128 a[56:59], v169 offset:62464
    s_waitcnt lgkmcnt(1)
    v_mfma_f32_16x16x32_bf16 v[140:143], a[52:55], a[48:51], v[140:143]
    s_waitcnt lgkmcnt(0)
    v_mfma_f32_16x16x32_bf16 v[144:147], a[56:59], a[48:51], v[144:147]
    s_nop 7
    v_max3_f32 v179, v179, v140, v141
    v_max3_f32 v179, v179, v142, v143
    v_max3_f32 v179, v179, v144, v145
    v_max3_f32 v179, v179, v146, v147
    s_nop 7
L_concat_heads__mha_block_cached__gqa_block_cached__near_ridge_kernel_m_x3:
    s_nop 1
    s_add_u32 s50, s50, 1
    s_cmp_lt_u32 s50, 4
    s_cbranch_scc1 L_concat_heads__mha_block_cached__gqa_block_cached__near_ridge_kernel_m_loop
    s_waitcnt vmcnt(0) lgkmcnt(0)
    s_add_u32 s16, s16, 4
    v_mov_b32 v187, 1
    s_mov_b64 exec, 1
    ds_add_rtn_u32 v187, v186, v187
    s_mov_b64 exec, -1
    s_waitcnt lgkmcnt(0)
    v_readfirstlane_b32 s17, v187
    s_nop 0
    s_add_u32 s17, s17, 1
    s_cmp_ge_u32 s17, s16
    s_cbranch_scc1 L_gb18_d
    s_mov_b32 s18, 0
L_gb18_l:
    ds_read_b32 v187, v186
    s_add_u32 s18, s18, 1
    s_cmp_ge_u32 s18, 0x200000
    s_cbranch_scc1 L_gb18_d
    s_waitcnt lgkmcnt(0)
    v_readfirstlane_b32 s17, v187
    s_nop 0
    s_cmp_ge_u32 s17, s16
    s_cbranch_scc0 L_gb18_l
L_gb18_d:
    v_mov_b32 v180, v176
    s_nop 1
    v_permlane32_swap_b32 v176, v180
    v_max_f32 v176, v176, v180
    v_mov_b32 v180, v176
    s_nop 1
    v_permlane16_swap_b32 v176, v180
    v_max_f32 v176, v176, v180
    v_mov_b32 v180, v177
    s_nop 1
    v_permlane32_swap_b32 v177, v180
    v_max_f32 v177, v177, v180
    v_mov_b32 v180, v177
    s_nop 1
    v_permlane16_swap_b32 v177, v180
    v_max_f32 v177, v177, v180
    v_mov_b32 v180, v178
    s_nop 1
    v_permlane32_swap_b32 v178, v180
    v_max_f32 v178, v178, v180
    v_mov_b32 v180, v178
    s_nop 1
    v_permlane16_swap_b32 v178, v180
    v_max_f32 v178, v178, v180
    v_mov_b32 v180, v179
    s_nop 1
    v_permlane32_swap_b32 v179, v180
    v_max_f32 v179, v179, v180
    v_mov_b32 v180, v179
    s_nop 1
    v_permlane16_swap_b32 v179, v180
    v_max_f32 v179, v179, v180
    v_lshrrev_b32 v180, 2, v184
    v_add_u32 v180, s100, v180
    v_mov_b32 v181, s3
    v_lshl_add_u32 v182, v181, 8, v180
    ds_write_b32 v182, v179 offset:8192
    s_add_u32 s16, s16, 4
    v_mov_b32 v187, 1
    s_mov_b64 exec, 1
    ds_add_rtn_u32 v187, v186, v187
    s_mov_b64 exec, -1
    s_waitcnt lgkmcnt(0)
    v_readfirstlane_b32 s17, v187
    s_nop 0
    s_add_u32 s17, s17, 1
    s_cmp_ge_u32 s17, s16
    s_cbranch_scc1 L_gb19_d
    s_mov_b32 s18, 0
L_gb19_l:
    ds_read_b32 v187, v186
    s_add_u32 s18, s18, 1
    s_cmp_ge_u32 s18, 0x200000
    s_cbranch_scc1 L_gb19_d
    s_waitcnt lgkmcnt(0)
    v_readfirstlane_b32 s17, v187
    s_nop 0
    s_cmp_ge_u32 s17, s16
    s_cbranch_scc0 L_gb19_l
L_gb19_d:
    ds_read_b32 v128, v180 offset:8192
    ds_read_b32 v129, v180 offset:8448
    ds_read_b32 v130, v180 offset:8704
    ds_read_b32 v131, v180 offset:8960
    s_waitcnt lgkmcnt(2)
    v_max_f32 v128, v128, v129
    s_waitcnt lgkmcnt(0)
    v_max3_f32 v179, v128, v130, v131
    s_mov_b32 s49, 0
    s_add_u32 m0, s53, 32768
    s_nop 0
    buffer_load_dwordx4 v174, s[36:39], s49 offen nt lds
    s_add_u32 m0, s53, 33664
    s_nop 0
    buffer_load_dwordx4 v174, s[36:39], s49 offen offset:128 nt lds
    s_mov_b32 s49, 0
    s_add_u32 m0, s52, 0
    s_nop 0
    buffer_load_dwordx4 v175, s[40:43], s49 offen nt lds
    s_add_u32 m0, s52, 896
    s_nop 0
    buffer_load_dwordx4 v175, s[40:43], s49 offen offset:128 nt lds
    s_mov_b32 s49, 8192
    s_add_u32 m0, s53, 40960
    s_nop 0
    buffer_load_dwordx4 v174, s[36:39], s49 offen nt lds
    s_add_u32 m0, s53, 41856
    s_nop 0
    buffer_load_dwordx4 v174, s[36:39], s49 offen offset:128 nt lds
    s_mov_b32 s49, 8192
    s_add_u32 m0, s52, 8192
    s_nop 0
    buffer_load_dwordx4 v175, s[40:43], s49 offen nt lds
    s_add_u32 m0, s52, 9088
    s_nop 0
    buffer_load_dwordx4 v175, s[40:43], s49 offen offset:128 nt lds
    s_mov_b32 s49, 16384
    s_add_u32 m0, s53, 49152
    s_nop 0
    buffer_load_dwordx4 v174, s[36:39], s49 offen nt lds
    s_add_u32 m0, s53, 50048
    s_nop 0
    buffer_load_dwordx4 v174, s[36:39], s49 offen offset:128 nt lds
    s_mov_b32 s49, 16384
    s_add_u32 m0, s52, 16384
    s_nop 0
    buffer_load_dwordx4 v175, s[40:43], s49 offen nt lds
    s_add_u32 m0, s52, 17280
    s_nop 0
    buffer_load_dwordx4 v175, s[40:43], s49 offen offset:128 nt lds
    s_mov_b32 s49, 24576
    v_mov_b32 v0, 0
    v_mov_b32 v1, 0
    v_mov_b32 v2, 0
    v_mov_b32 v3, 0
    v_mov_b32 v4, 0
    v_mov_b32 v5, 0
    v_mov_b32 v6, 0
    v_mov_b32 v7, 0
    v_mov_b32 v8, 0
    v_mov_b32 v9, 0
    v_mov_b32 v10, 0
    v_mov_b32 v11, 0
    v_mov_b32 v12, 0
    v_mov_b32 v13, 0
    v_mov_b32 v14, 0
    v_mov_b32 v15, 0
    v_mov_b32 v16, 0
    v_mov_b32 v17, 0
    v_mov_b32 v18, 0
    v_mov_b32 v19, 0
    v_mov_b32 v20, 0
    v_mov_b32 v21, 0
    v_mov_b32 v22, 0
    v_mov_b32 v23, 0
    v_mov_b32 v24, 0
    v_mov_b32 v25, 0
    v_mov_b32 v26, 0
    v_mov_b32 v27, 0
    v_mov_b32 v28, 0
    v_mov_b32 v29, 0
    v_mov_b32 v30, 0
    v_mov_b32 v31, 0
    v_mov_b32 v32, 0
    v_mov_b32 v33, 0
    v_mov_b32 v34, 0
    v_mov_b32 v35, 0
    v_mov_b32 v36, 0
    v_mov_b32 v37, 0
    v_mov_b32 v38, 0
    v_mov_b32 v39, 0
    v_mov_b32 v40, 0
    v_mov_b32 v41, 0
    v_mov_b32 v42, 0
    v_mov_b32 v43, 0
    v_mov_b32 v44, 0
    v_mov_b32 v45, 0
    v_mov_b32 v46, 0
    v_mov_b32 v47, 0
    v_mov_b32 v48, 0
    v_mov_b32 v49, 0
    v_mov_b32 v50, 0
    v_mov_b32 v51, 0
    v_mov_b32 v52, 0
    v_mov_b32 v53, 0
    v_mov_b32 v54, 0
    v_mov_b32 v55, 0
    v_mov_b32 v56, 0
    v_mov_b32 v57, 0
    v_mov_b32 v58, 0
    v_mov_b32 v59, 0
    v_mov_b32 v60, 0
    v_mov_b32 v61, 0
    v_mov_b32 v62, 0
    v_mov_b32 v63, 0
    v_mov_b32 v64, 0
    v_mov_b32 v65, 0
    v_mov_b32 v66, 0
    v_mov_b32 v67, 0
    v_mov_b32 v68, 0
    v_mov_b32 v69, 0
    v_mov_b32 v70, 0
    v_mov_b32 v71, 0
    v_mov_b32 v72, 0
    v_mov_b32 v73, 0
    v_mov_b32 v74, 0
    v_mov_b32 v75, 0
    v_mov_b32 v76, 0
    v_mov_b32 v77, 0
    v_mov_b32 v78, 0
    v_mov_b32 v79, 0
    v_mov_b32 v80, 0
    v_mov_b32 v81, 0
    v_mov_b32 v82, 0
    v_mov_b32 v83, 0
    v_mov_b32 v84, 0
    v_mov_b32 v85, 0
    v_mov_b32 v86, 0
    v_mov_b32 v87, 0
    v_mov_b32 v88, 0
    v_mov_b32 v89, 0
    v_mov_b32 v90, 0
    v_mov_b32 v91, 0
    v_mov_b32 v92, 0
    v_mov_b32 v93, 0
    v_mov_b32 v94, 0
    v_mov_b32 v95, 0
    v_mov_b32 v96, 0
    v_mov_b32 v97, 0
    v_mov_b32 v98, 0
    v_mov_b32 v99, 0
    v_mov_b32 v100, 0
    v_mov_b32 v101, 0
    v_mov_b32 v102, 0
    v_mov_b32 v103, 0
    v_mov_b32 v104, 0
    v_mov_b32 v105, 0
    v_mov_b32 v106, 0
    v_mov_b32 v107, 0
    v_mov_b32 v108, 0
    v_mov_b32 v109, 0
    v_mov_b32 v110, 0
    v_mov_b32 v111, 0
    v_mov_b32 v112, 0
    v_mov_b32 v113, 0
    v_mov_b32 v114, 0
    v_mov_b32 v115, 0
    v_mov_b32 v116, 0
    v_mov_b32 v117, 0
    v_mov_b32 v118, 0
    v_mov_b32 v119, 0
    v_mov_b32 v120, 0
    v_mov_b32 v121, 0
    v_mov_b32 v122, 0
    v_mov_b32 v123, 0
    v_mov_b32 v124, 0
    v_mov_b32 v125, 0
    v_mov_b32 v126, 0
    v_mov_b32 v127, 0
    v_mov_b32 v164, 0
    v_mov_b32 v165, 0
    v_mov_b32 v166, 0
    v_mov_b32 v167, 0
    s_lshl_b32 s55, s56, 1
    s_add_u32 s55, s55, s3
    s_and_b32 s55, s55, 3
    s_waitcnt vmcnt(8) lgkmcnt(0)
    s_add_u32 s16, s16, 4
    v_mov_b32 v187, 1
    s_mov_b64 exec, 1
    ds_add_rtn_u32 v187, v186, v187
    s_mov_b64 exec, -1
    s_waitcnt lgkmcnt(0)
    v_readfirstlane_b32 s17, v187
    s_nop 0
    s_add_u32 s17, s17, 1
    s_cmp_ge_u32 s17, s16
    s_cbranch_scc1 L_gb20_d
    s_mov_b32 s18, 0
L_gb20_l:
    ds_read_b32 v187, v186
    s_add_u32 s18, s18, 1
    s_cmp_ge_u32 s18, 0x200000
    s_cbranch_scc1 L_gb20_d
    s_waitcnt lgkmcnt(0)
    v_readfirstlane_b32 s17, v187
    s_nop 0
    s_cmp_ge_u32 s17, s16
    s_cbranch_scc0 L_gb20_l
L_gb20_d:
    ds_read_b128 a[48:51], v168 offset:32768
    ds_read_b128 a[52:55], v169 offset:32768
    ds_read_b128 a[56:59], v168 offset:33792
    ds_read_b128 a[60:63], v169 offset:33792
    s_waitcnt lgkmcnt(3)
    v_mfma_f32_16x16x32_bf16 v[128:131], a[48:51], a[0:3], 0
    v_mfma_f32_16x16x32_bf16 v[132:135], a[48:51], a[16:19], 0
    v_mfma_f32_16x16x32_bf16 v[136:139], a[48:51], a[32:35], 0
    s_waitcnt lgkmcnt(2)
    v_mfma_f32_16x16x32_bf16 v[128:131], a[52:55], a[4:7], v[128:131]
    v_mfma_f32_16x16x32_bf16 v[132:135], a[52:55], a[20:23], v[132:135]
    v_mfma_f32_16x16x32_bf16 v[136:139], a[52:55], a[36:39], v[136:139]
    s_waitcnt lgkmcnt(1)
    v_mfma_f32_16x16x32_bf16 v[128:131], a[56:59], a[8:11], v[128:131]
    v_mfma_f32_16x16x32_bf16 v[132:135], a[56:59], a[24:27], v[132:135]
    v_mfma_f32_16x16x32_bf16 v[136:139], a[56:59], a[40:43], v[136:139]
    s_waitcnt lgkmcnt(0)
    v_mfma_f32_16x16x32_bf16 v[128:131], a[60:63], a[12:15], v[128:131]
    v_mfma_f32_16x16x32_bf16 v[132:135], a[60:63], a[28:31], v[132:135]
    v_mfma_f32_16x16x32_bf16 v[136:139], a[60:63], a[44:47], v[136:139]
    s_nop 5
    v_sub_f32 v128, v128, v176
    v_exp_f32 v128, v128
    v_sub_f32 v129, v129, v176
    v_exp_f32 v129, v129
    v_sub_f32 v130, v130, v176
    v_exp_f32 v130, v130
    v_sub_f32 v131, v131, v176
    v_exp_f32 v131, v131
    v_sub_f32 v132, v132, v177
    v_exp_f32 v132, v132
    v_sub_f32 v133, v133, v177
    v_exp_f32 v133, v133
    v_sub_f32 v134, v134, v177
    v_exp_f32 v134, v134
    v_sub_f32 v135, v135, v177
    v_exp_f32 v135, v135
    v_sub_f32 v136, v136, v178
    v_exp_f32 v136, v136
    v_sub_f32 v137, v137, v178
    v_exp_f32 v137, v137
    v_sub_f32 v138, v138, v178
    v_exp_f32 v138, v138
    v_sub_f32 v139, v139, v178
    v_exp_f32 v139, v139
    s_mov_b32 s50, 0
.p2align 3
L_concat_heads__mha_block_cached__gqa_block_cached__near_ridge_kernel_s_loop:
    ds_read_b128 a[48:51], v168 offset:36864
    ds_read_b128 a[52:55], v169 offset:36864
    ds_read_b128 a[56:59], v168 offset:37888
    s_waitcnt vmcnt(6)
    s_add_u32 s16, s16, 4
    v_mov_b32 v187, 1
    s_mov_b64 exec, 1
    ds_add_rtn_u32 v187, v186, v187
    s_mov_b64 exec, -1
    s_waitcnt lgkmcnt(0)
    v_readfirstlane_b32 s17, v187
    s_nop 0
    s_add_u32 s17, s17, 1
    s_cmp_ge_u32 s17, s16
    s_cbranch_scc1 L_gb21_d
    s_mov_b32 s18, 0
L_gb21_l:
    ds_read_b32 v187, v186
    s_add_u32 s18, s18, 1
    s_cmp_ge_u32 s18, 0x200000
    s_cbranch_scc1 L_gb21_d
    s_waitcnt lgkmcnt(0)
    v_readfirstlane_b32 s17, v187
    s_nop 0
    s_cmp_ge_u32 s17, s16
    s_cbranch_scc0 L_gb21_l
L_gb21_d:
    v_mfma_f32_16x16x32_bf16 v[140:143], a[48:51], a[0:3], 0
    ds_read_b128 a[60:63], v169 offset:37888
    v_cvt_pk_bf16_f32 v152, v128, v129
    v_cvt_pk_bf16_f32 v153, v130, v131
    v_mfma_f32_16x16x32_bf16 v[144:147], a[48:51], a[16:19], 0
    ds_read_b128 a[64:67], v168 offset:40960
    v_add_f32 v164, v164, v128
    v_add_f32 v164, v164, v129
    v_mfma_f32_16x16x32_bf16 v[148:151], a[48:51], a[32:35], 0
    ds_read_b128 a[48:51], v169 offset:40960
    v_add_f32 v164, v164, v130
    v_add_f32 v164, v164, v131
    v_mfma_f32_16x16x32_bf16 v[140:143], a[52:55], a[4:7], v[140:143]
    s_add_u32 m0, s53, 57344
    v_cvt_pk_bf16_f32 v156, v132, v133
    v_cvt_pk_bf16_f32 v157, v134, v135
    v_mfma_f32_16x16x32_bf16 v[144:147], a[52:55], a[20:23], v[144:147]
    buffer_load_dwordx4 v174, s[36:39], s49 offen nt lds
    s_add_u32 m0, s53, 58240
    v_add_f32 v165, v165, v132
    v_add_f32 v165, v165, v133
    v_mfma_f32_16x16x32_bf16 v[148:151], a[52:55], a[36:39], v[148:151]
    ds_read_b128 a[52:55], v168 offset:41984
    buffer_load_dwordx4 v174, s[36:39], s49 offen offset:128 nt lds
    v_add_f32 v165, v165, v134
    v_add_f32 v165, v165, v135
    v_mfma_f32_16x16x32_bf16 v[140:143], a[56:59], a[8:11], v[140:143]
    s_add_u32 m0, s52, 24576
    s_nop 0
    buffer_load_dwordx4 v175, s[40:43], s49 offen nt lds
    v_cvt_pk_bf16_f32 v160, v136, v137
    v_cvt_pk_bf16_f32 v161, v138, v139
    v_mfma_f32_16x16x32_bf16 v[144:147], a[56:59], a[24:27], v[144:147]
    s_add_u32 m0, s52, 25472
    s_nop 0
    buffer_load_dwordx4 v175, s[40:43], s49 offen offset:128 nt lds
    v_add_f32 v166, v166, v136
    v_add_f32 v166, v166, v137
    v_mfma_f32_16x16x32_bf16 v[148:151], a[56:59], a[40:43], v[148:151]
    ds_read_b128 a[56:59], v169 offset:41984
    s_add_u32 s49, s49, 8192
    s_waitcnt lgkmcnt(3)
    v_add_f32 v166, v166, v138
    v_add_f32 v166, v166, v139
    v_mfma_f32_16x16x32_bf16 v[140:143], a[60:63], a[12:15], v[140:143]
    v_mfma_f32_16x16x32_bf16 v[144:147], a[60:63], a[28:31], v[144:147]
    v_mfma_f32_16x16x32_bf16 v[148:151], a[60:63], a[44:47], v[148:151]
    ds_read_b64_tr_b16 a[60:61], v170 offset:0
    ds_read_b64_tr_b16 a[62:63], v170 offset:4096
    v_mfma_f32_16x16x32_bf16 v[128:131], a[64:67], a[0:3], 0
    s_nop 2
    v_sub_f32 v140, v140, v176
    v_mfma_f32_16x16x32_bf16 v[132:135], a[64:67], a[16:19], 0
    v_exp_f32 v140, v140
    v_mfma_f32_16x16x32_bf16 v[136:139], a[64:67], a[32:35], 0
    ds_read_b64_tr_b16 a[64:65], v171 offset:0
    s_waitcnt lgkmcnt(4)
    v_sub_f32 v141, v141, v176
    v_mfma_f32_16x16x32_bf16 v[128:131], a[48:51], a[4:7], v[128:131]
    ds_read_b64_tr_b16 a[66:67], v171 offset:4096
    v_exp_f32 v141, v141
    v_mfma_f32_16x16x32_bf16 v[132:135], a[48:51], a[20:23], v[132:135]
    v_sub_f32 v142, v142, v176
    v_mfma_f32_16x16x32_bf16 v[136:139], a[48:51], a[36:39], v[136:139]
    ds_read_b64_tr_b16 a[48:49], v172 offset:0
    v_exp_f32 v142, v142
    v_mfma_f32_16x16x32_bf16 v[128:131], a[52:55], a[8:11], v[128:131]
    ds_read_b64_tr_b16 a[50:51], v172 offset:4096
    v_sub_f32 v143, v143, v176
    v_mfma_f32_16x16x32_bf16 v[132:135], a[52:55], a[24:27], v[132:135]
    v_exp_f32 v143, v143
    v_mfma_f32_16x16x32_bf16 v[136:139], a[52:55], a[40:43], v[136:139]
    ds_read_b64_tr_b16 a[52:53], v173 offset:0
    s_waitcnt lgkmcnt(6)
    v_cvt_pk_bf16_f32 v154, v140, v141
    v_cvt_pk_bf16_f32 v155, v142, v143
    v_mfma_f32_16x16x32_bf16 v[128:131], a[56:59], a[12:15], v[128:131]
    ds_read_b64_tr_b16 a[54:55], v173 offset:4096
    v_sub_f32 v144, v144, v177
    v_mfma_f32_16x16x32_bf16 v[132:135], a[56:59], a[28:31], v[132:135]
    v_exp_f32 v144, v144
    v_mfma_f32_16x16x32_bf16 v[136:139], a[56:59], a[44:47], v[136:139]
    ds_read_b64_tr_b16 a[56:57], v170 offset:1024
    s_waitcnt lgkmcnt(6)
    v_sub_f32 v145, v145, v177
    v_mfma_f32_16x16x32_bf16 v[0:3], a[60:63], v[152:155], v[0:3]
    ds_read_b64_tr_b16 a[58:59], v170 offset:5120
    v_exp_f32 v145, v145
    v_sub_f32 v146, v146, v177
    v_exp_f32 v146, v146
    v_sub_f32 v147, v147, v177
    v_exp_f32 v147, v147
    v_cvt_pk_bf16_f32 v158, v144, v145
    v_cvt_pk_bf16_f32 v159, v146, v147
    s_nop 1
    v_mfma_f32_16x16x32_bf16 v[32:35], a[60:63], v[156:159], v[32:35]
    v_sub_f32 v148, v148, v178
    v_exp_f32 v148, v148
    v_sub_f32 v149, v149, v178
    v_exp_f32 v149, v149
    v_sub_f32 v150, v150, v178
    v_exp_f32 v150, v150
    v_sub_f32 v151, v151, v178
    v_exp_f32 v151, v151
    v_cvt_pk_bf16_f32 v162, v148, v149
    v_cvt_pk_bf16_f32 v163, v150, v151
    s_nop 1
    v_mfma_f32_16x16x32_bf16 v[64:67], a[60:63], v[160:163], v[64:67]
    ds_read_b64_tr_b16 a[60:61], v171 offset:1024
    s_waitcnt lgkmcnt(6)
    v_add_f32 v164, v164, v140
    v_add_f32 v164, v164, v141
    v_mfma_f32_16x16x32_bf16 v[4:7], a[64:67], v[152:155], v[4:7]
    ds_read_b64_tr_b16 a[62:63], v171 offset:5120
    v_add_f32 v164, v164, v142
    v_add_f32 v164, v164, v143
    v_mfma_f32_16x16x32_bf16 v[36:39], a[64:67], v[156:159], v[36:39]
    v_add_f32 v165, v165, v144
    v_add_f32 v165, v165, v145
    v_mfma_f32_16x16x32_bf16 v[68:71], a[64:67], v[160:163], v[68:71]
    ds_read_b64_tr_b16 a[64:65], v172 offset:1024
    s_waitcnt lgkmcnt(6)
    v_add_f32 v165, v165, v146
    v_add_f32 v165, v165, v147
    v_mfma_f32_16x16x32_bf16 v[8:11], a[48:51], v[152:155], v[8:11]
    ds_read_b64_tr_b16 a[66:67], v172 offset:5120
    v_add_f32 v166, v166, v148
    v_add_f32 v166, v166, v149
    v_mfma_f32_16x16x32_bf16 v[40:43], a[48:51], v[156:159], v[40:43]
    v_add_f32 v166, v166, v150
    v_add_f32 v166, v166, v151
    v_mfma_f32_16x16x32_bf16 v[72:75], a[48:51], v[160:163], v[72:75]
    ds_read_b64_tr_b16 a[48:49], v173 offset:1024
    s_waitcnt lgkmcnt(6)
    v_sub_f32 v128, v128, v176
    v_mfma_f32_16x16x32_bf16 v[12:15], a[52:55], v[152:155], v[12:15]
    ds_read_b64_tr_b16 a[50:51], v173 offset:5120
    v_exp_f32 v128, v128
    v_mfma_f32_16x16x32_bf16 v[44:47], a[52:55], v[156:159], v[44:47]
    v_sub_f32 v129, v129, v176
    v_mfma_f32_16x16x32_bf16 v[76:79], a[52:55], v[160:163], v[76:79]
    s_waitcnt lgkmcnt(5)
    v_exp_f32 v129, v129
    v_mfma_f32_16x16x32_bf16 v[16:19], a[56:59], v[152:155], v[16:19]
    v_sub_f32 v130, v130, v176
    v_mfma_f32_16x16x32_bf16 v[48:51], a[56:59], v[156:159], v[48:51]
    v_exp_f32 v130, v130
    v_mfma_f32_16x16x32_bf16 v[80:83], a[56:59], v[160:163], v[80:83]
    s_waitcnt lgkmcnt(3)
    v_sub_f32 v131, v131, v176
    v_mfma_f32_16x16x32_bf16 v[20:23], a[60:63], v[152:155], v[20:23]
    v_exp_f32 v131, v131
    v_mfma_f32_16x16x32_bf16 v[52:55], a[60:63], v[156:159], v[52:55]
    v_sub_f32 v132, v132, v177
    v_mfma_f32_16x16x32_bf16 v[84:87], a[60:63], v[160:163], v[84:87]
    s_waitcnt lgkmcnt(1)
    v_exp_f32 v132, v132
    v_mfma_f32_16x16x32_bf16 v[24:27], a[64:67], v[152:155], v[24:27]
    v_sub_f32 v133, v133, v177
    v_mfma_f32_16x16x32_bf16 v[56:59], a[64:67], v[156:159], v[56:59]
    v_exp_f32 v133, v133
    v_mfma_f32_16x16x32_bf16 v[88:91], a[64:67], v[160:163], v[88:91]
    s_waitcnt lgkmcnt(0)
    v_sub_f32 v134, v134, v177
    v_mfma_f32_16x16x32_bf16 v[28:31], a[48:51], v[152:155], v[28:31]
    v_exp_f32 v134, v134
    v_mfma_f32_16x16x32_bf16 v[60:63], a[48:51], v[156:159], v[60:63]
    v_sub_f32 v135, v135, v177
    v_mfma_f32_16x16x32_bf16 v[92:95], a[48:51], v[160:163], v[92:95]
    v_exp_f32 v135, v135
    v_sub_f32 v136, v136, v178
    v_exp_f32 v136, v136
    v_sub_f32 v137, v137, v178
    v_exp_f32 v137, v137
    v_sub_f32 v138, v138, v178
    v_exp_f32 v138, v138
    v_sub_f32 v139, v139, v178
    v_exp_f32 v139, v139
    s_cmp_lg_u32 s3, 0
    s_cbranch_scc1 L_concat_heads__mha_block_cached__gqa_block_cached__near_ridge_kernel_s_x0
    ds_read_b128 a[48:51], v185 offset:0
    ds_read_b128 a[52:55], v168 offset:32768
    ds_read_b128 a[56:59], v168 offset:36864
    s_waitcnt lgkmcnt(1)
    v_mfma_f32_16x16x32_bf16 v[140:143], a[52:55], a[48:51], 0
    s_waitcnt lgkmcnt(0)
    v_mfma_f32_16x16x32_bf16 v[144:147], a[56:59], a[48:51], 0
    s_nop 7
    ds_read_b128 a[48:51], v185 offset:1024
    ds_read_b128 a[52:55], v169 offset:32768
    ds_read_b128 a[56:59], v169 offset:36864
    s_waitcnt lgkmcnt(1)
    v_mfma_f32_16x16x32_bf16 v[140:143], a[52:55], a[48:51], v[140:143]
    s_waitcnt lgkmcnt(0)
    v_mfma_f32_16x16x32_bf16 v[144:147], a[56:59], a[48:51], v[144:147]
    s_nop 7
    ds_read_b128 a[48:51], v185 offset:2048
    ds_read_b128 a[52:55], v168 offset:33792
    ds_read_b128 a[56:59], v168 offset:37888
    s_waitcnt lgkmcnt(1)
    v_mfma_f32_16x16x32_bf16 v[140:143], a[52:55], a[48:51], v[140:143]
    s_waitcnt lgkmcnt(0)
    v_mfma_f32_16x16x32_bf16 v[144:147], a[56:59], a[48:51], v[144:147]
    s_nop 7
    ds_read_b128 a[48:51], v185 offset:3072
    ds_read_b128 a[52:55], v169 offset:33792
    ds_read_b128 a[56:59], v169 offset:37888
    s_waitcnt lgkmcnt(1)
    v_mfma_f32_16x16x32_bf16 v[140:143], a[52:55], a[48:51], v[140:143]
    s_waitcnt lgkmcnt(0)
    v_mfma_f32_16x16x32_bf16 v[144:147], a[56:59], a[48:51], v[144:147]
    s_nop 7
    v_sub_f32 v140, v140, v179
    v_exp_f32 v140, v140
    v_sub_f32 v141, v141, v179
    v_exp_f32 v141, v141
    v_sub_f32 v142, v142, v179
    v_exp_f32 v142, v142
    v_sub_f32 v143, v143, v179
    v_exp_f32 v143, v143
    v_sub_f32 v144, v144, v179
    v_exp_f32 v144, v144
    v_sub_f32 v145, v145, v179
    v_exp_f32 v145, v145
    v_sub_f32 v146, v146, v179
    v_exp_f32 v146, v146
    v_sub_f32 v147, v147, v179
    v_exp_f32 v147, v147
    v_cvt_pk_bf16_f32 v152, v140, v141
    v_cvt_pk_bf16_f32 v153, v142, v143
    v_add_f32 v167, v167, v140
    v_add_f32 v167, v167, v141
    v_add_f32 v167, v167, v142
    v_add_f32 v167, v167, v143
    v_cvt_pk_bf16_f32 v154, v144, v145
    v_cvt_pk_bf16_f32 v155, v146, v147
    v_add_f32 v167, v167, v144
    v_add_f32 v167, v167, v145
    v_add_f32 v167, v167, v146
    v_add_f32 v167, v167, v147
    ds_read_b64_tr_b16 a[48:49], v170 offset:0
    ds_read_b64_tr_b16 a[50:51], v170 offset:4096
    s_waitcnt lgkmcnt(0)
    v_mfma_f32_16x16x32_bf16 v[96:99], a[48:51], v[152:155], v[96:99]
    ds_read_b64_tr_b16 a[52:53], v171 offset:0
    ds_read_b64_tr_b16 a[54:55], v171 offset:4096
    s_waitcnt lgkmcnt(0)
    v_mfma_f32_16x16x32_bf16 v[100:103], a[52:55], v[152:155], v[100:103]
    ds_read_b64_tr_b16 a[56:57], v172 offset:0
    ds_read_b64_tr_b16 a[58:59], v172 offset:4096
    s_waitcnt lgkmcnt(0)
    v_mfma_f32_16x16x32_bf16 v[104:107], a[56:59], v[152:155], v[104:107]
    ds_read_b64_tr_b16 a[60:61], v173 offset:0
    ds_read_b64_tr_b16 a[62:63], v173 offset:4096
    s_waitcnt lgkmcnt(0)
    v_mfma_f32_16x16x32_bf16 v[108:111], a[60:63], v[152:155], v[108:111]
    ds_read_b64_tr_b16 a[64:65], v170 offset:1024
    ds_read_b64_tr_b16 a[66:67], v170 offset:5120
    s_waitcnt lgkmcnt(0)
    v_mfma_f32_16x16x32_bf16 v[112:115], a[64:67], v[152:155], v[112:115]
    ds_read_b64_tr_b16 a[48:49], v171 offset:1024
    ds_read_b64_tr_b16 a[50:51], v171 offset:5120
    s_waitcnt lgkmcnt(0)
    v_mfma_f32_16x16x32_bf16 v[116:119], a[48:51], v[152:155], v[116:119]
    ds_read_b64_tr_b16 a[52:53], v172 offset:1024
    ds_read_b64_tr_b16 a[54:55], v172 offset:5120
    s_waitcnt lgkmcnt(0)
    v_mfma_f32_16x16x32_bf16 v[120:123], a[52:55], v[152:155], v[120:123]
    ds_read_b64_tr_b16 a[56:57], v173 offset:1024
    ds_read_b64_tr_b16 a[58:59], v173 offset:5120
    s_waitcnt lgkmcnt(0)
    v_mfma_f32_16x16x32_bf16 v[124:127], a[56:59], v[152:155], v[124:127]
    s_nop 7
L_concat_heads__mha_block_cached__gqa_block_cached__near_ridge_kernel_s_x0:
    s_nop 1
    ds_read_b128 a[48:51], v168 offset:45056
    ds_read_b128 a[52:55], v169 offset:45056
    ds_read_b128 a[56:59], v168 offset:46080
    s_waitcnt vmcnt(6)
    s_add_u32 s16, s16, 4
    v_mov_b32 v187, 1
    s_mov_b64 exec, 1
    ds_add_rtn_u32 v187, v186, v187
    s_mov_b64 exec, -1
    s_waitcnt lgkmcnt(0)
    v_readfirstlane_b32 s17, v187
    s_nop 0
    s_add_u32 s17, s17, 1
    s_cmp_ge_u32 s17, s16
    s_cbranch_scc1 L_gb22_d
    s_mov_b32 s18, 0
L_gb22_l:
    ds_read_b32 v187, v186
    s_add_u32 s18, s18, 1
    s_cmp_ge_u32 s18, 0x200000
    s_cbranch_scc1 L_gb22_d
    s_waitcnt lgkmcnt(0)
    v_readfirstlane_b32 s17, v187
    s_nop 0
    s_cmp_ge_u32 s17, s16
    s_cbranch_scc0 L_gb22_l
L_gb22_d:
    v_mfma_f32_16x16x32_bf16 v[140:143], a[48:51], a[0:3], 0
    ds_read_b128 a[60:63], v169 offset:46080
    v_cvt_pk_bf16_f32 v152, v128, v129
    v_cvt_pk_bf16_f32 v153, v130, v131
    v_mfma_f32_16x16x32_bf16 v[144:147], a[48:51], a[16:19], 0
    ds_read_b128 a[64:67], v168 offset:49152
    v_add_f32 v164, v164, v128
    v_add_f32 v164, v164, v129
    v_mfma_f32_16x16x32_bf16 v[148:151], a[48:51], a[32:35], 0
    ds_read_b128 a[48:51], v169 offset:49152
    v_add_f32 v164, v164, v130
    v_add_f32 v164, v164, v131
    v_mfma_f32_16x16x32_bf16 v[140:143], a[52:55], a[4:7], v[140:143]
    s_add_u32 m0, s53, 32768
    v_cvt_pk_bf16_f32 v156, v132, v133
    v_cvt_pk_bf16_f32 v157, v134, v135
    v_mfma_f32_16x16x32_bf16 v[144:147], a[52:55], a[20:23], v[144:147]
    buffer_load_dwordx4 v174, s[36:39], s49 offen nt lds
    s_add_u32 m0, s53, 33664
    v_add_f32 v165, v165, v132
    v_add_f32 v165, v165, v133
    v_mfma_f32_16x16x32_bf16 v[148:151], a[52:55], a[36:39], v[148:151]
    ds_read_b128 a[52:55], v168 offset:50176
    buffer_load_dwordx4 v174, s[36:39], s49 offen offset:128 nt lds
    v_add_f32 v165, v165, v134
    v_add_f32 v165, v165, v135
    v_mfma_f32_16x16x32_bf16 v[140:143], a[56:59], a[8:11], v[140:143]
    s_add_u32 m0, s52, 0
    s_nop 0
    buffer_load_dwordx4 v175, s[40:43], s49 offen nt lds
    v_cvt_pk_bf16_f32 v160, v136, v137
    v_cvt_pk_bf16_f32 v161, v138, v139
    v_mfma_f32_16x16x32_bf16 v[144:147], a[56:59], a[24:27], v[144:147]
    s_add_u32 m0, s52, 896
    s_nop 0
    buffer_load_dwordx4 v175, s[40:43], s49 offen offset:128 nt lds
    v_add_f32 v166, v166, v136
    v_add_f32 v166, v166, v137
    v_mfma_f32_16x16x32_bf16 v[148:151], a[56:59], a[40:43], v[148:151]
    ds_read_b128 a[56:59], v169 offset:50176
    s_add_u32 s49, s49, 8192
    s_waitcnt lgkmcnt(3)
    v_add_f32 v166, v166, v138
    v_add_f32 v166, v166, v139
    v_mfma_f32_16x16x32_bf16 v[140:143], a[60:63], a[12:15], v[140:143]
    v_mfma_f32_16x16x32_bf16 v[144:147], a[60:63], a[28:31], v[144:147]
    v_mfma_f32_16x16x32_bf16 v[148:151], a[60:63], a[44:47], v[148:151]
    ds_read_b64_tr_b16 a[60:61], v170 offset:8192
    ds_read_b64_tr_b16 a[62:63], v170 offset:12288
    v_mfma_f32_16x16x32_bf16 v[128:131], a[64:67], a[0:3], 0
    s_nop 2
    v_sub_f32 v140, v140, v176
    v_mfma_f32_16x16x32_bf16 v[132:135], a[64:67], a[16:19], 0
    v_exp_f32 v140, v140
    v_mfma_f32_16x16x32_bf16 v[136:139], a[64:67], a[32:35], 0
    ds_read_b64_tr_b16 a[64:65], v171 offset:8192
    s_waitcnt lgkmcnt(4)
    v_sub_f32 v141, v141, v176
    v_mfma_f32_16x16x32_bf16 v[128:131], a[48:51], a[4:7], v[128:131]
    ds_read_b64_tr_b16 a[66:67], v171 offset:12288
    v_exp_f32 v141, v141
    v_mfma_f32_16x16x32_bf16 v[132:135], a[48:51], a[20:23], v[132:135]
    v_sub_f32 v142, v142, v176
    v_mfma_f32_16x16x32_bf16 v[136:139], a[48:51], a[36:39], v[136:139]
    ds_read_b64_tr_b16 a[48:49], v172 offset:8192
    v_exp_f32 v142, v142
    v_mfma_f32_16x16x32_bf16 v[128:131], a[52:55], a[8:11], v[128:131]
    ds_read_b64_tr_b16 a[50:51], v172 offset:12288
    v_sub_f32 v143, v143, v176
    v_mfma_f32_16x16x32_bf16 v[132:135], a[52:55], a[24:27], v[132:135]
    v_exp_f32 v143, v143
    v_mfma_f32_16x16x32_bf16 v[136:139], a[52:55], a[40:43], v[136:139]
    ds_read_b64_tr_b16 a[52:53], v173 offset:8192
    s_waitcnt lgkmcnt(6)
    v_cvt_pk_bf16_f32 v154, v140, v141
    v_cvt_pk_bf16_f32 v155, v142, v143
    v_mfma_f32_16x16x32_bf16 v[128:131], a[56:59], a[12:15], v[128:131]
    ds_read_b64_tr_b16 a[54:55], v173 offset:12288
    v_sub_f32 v144, v144, v177
    v_mfma_f32_16x16x32_bf16 v[132:135], a[56:59], a[28:31], v[132:135]
    v_exp_f32 v144, v144
    v_mfma_f32_16x16x32_bf16 v[136:139], a[56:59], a[44:47], v[136:139]
    ds_read_b64_tr_b16 a[56:57], v170 offset:9216
    s_waitcnt lgkmcnt(6)
    v_sub_f32 v145, v145, v177
    v_mfma_f32_16x16x32_bf16 v[0:3], a[60:63], v[152:155], v[0:3]
    ds_read_b64_tr_b16 a[58:59], v170 offset:13312
    v_exp_f32 v145, v145
    v_sub_f32 v146, v146, v177
    v_exp_f32 v146, v146
    v_sub_f32 v147, v147, v177
    v_exp_f32 v147, v147
    v_cvt_pk_bf16_f32 v158, v144, v145
    v_cvt_pk_bf16_f32 v159, v146, v147
    s_nop 1
    v_mfma_f32_16x16x32_bf16 v[32:35], a[60:63], v[156:159], v[32:35]
    v_sub_f32 v148, v148, v178
    v_exp_f32 v148, v148
    v_sub_f32 v149, v149, v178
    v_exp_f32 v149, v149
    v_sub_f32 v150, v150, v178
    v_exp_f32 v150, v150
    v_sub_f32 v151, v151, v178
    v_exp_f32 v151, v151
    v_cvt_pk_bf16_f32 v162, v148, v149
    v_cvt_pk_bf16_f32 v163, v150, v151
    s_nop 1
    v_mfma_f32_16x16x32_bf16 v[64:67], a[60:63], v[160:163], v[64:67]
    ds_read_b64_tr_b16 a[60:61], v171 offset:9216
    s_waitcnt lgkmcnt(6)
    v_add_f32 v164, v164, v140
    v_add_f32 v164, v164, v141
    v_mfma_f32_16x16x32_bf16 v[4:7], a[64:67], v[152:155], v[4:7]
    ds_read_b64_tr_b16 a[62:63], v171 offset:13312
    v_add_f32 v164, v164, v142
    v_add_f32 v164, v164, v143
    v_mfma_f32_16x16x32_bf16 v[36:39], a[64:67], v[156:159], v[36:39]
    v_add_f32 v165, v165, v144
    v_add_f32 v165, v165, v145
    v_mfma_f32_16x16x32_bf16 v[68:71], a[64:67], v[160:163], v[68:71]
    ds_read_b64_tr_b16 a[64:65], v172 offset:9216
    s_waitcnt lgkmcnt(6)
    v_add_f32 v165, v165, v146
    v_add_f32 v165, v165, v147
    v_mfma_f32_16x16x32_bf16 v[8:11], a[48:51], v[152:155], v[8:11]
    ds_read_b64_tr_b16 a[66:67], v172 offset:13312
    v_add_f32 v166, v166, v148
    v_add_f32 v166, v166, v149
    v_mfma_f32_16x16x32_bf16 v[40:43], a[48:51], v[156:159], v[40:43]
    v_add_f32 v166, v166, v150
    v_add_f32 v166, v166, v151
    v_mfma_f32_16x16x32_bf16 v[72:75], a[48:51], v[160:163], v[72:75]
    ds_read_b64_tr_b16 a[48:49], v173 offset:9216
    s_waitcnt lgkmcnt(6)
    v_sub_f32 v128, v128, v176
    v_mfma_f32_16x16x32_bf16 v[12:15], a[52:55], v[152:155], v[12:15]
    ds_read_b64_tr_b16 a[50:51], v173 offset:13312
    v_exp_f32 v128, v128
    v_mfma_f32_16x16x32_bf16 v[44:47], a[52:55], v[156:159], v[44:47]
    v_sub_f32 v129, v129, v176
    v_mfma_f32_16x16x32_bf16 v[76:79], a[52:55], v[160:163], v[76:79]
    s_waitcnt lgkmcnt(5)
    v_exp_f32 v129, v129
    v_mfma_f32_16x16x32_bf16 v[16:19], a[56:59], v[152:155], v[16:19]
    v_sub_f32 v130, v130, v176
    v_mfma_f32_16x16x32_bf16 v[48:51], a[56:59], v[156:159], v[48:51]
    v_exp_f32 v130, v130
    v_mfma_f32_16x16x32_bf16 v[80:83], a[56:59], v[160:163], v[80:83]
    s_waitcnt lgkmcnt(3)
    v_sub_f32 v131, v131, v176
    v_mfma_f32_16x16x32_bf16 v[20:23], a[60:63], v[152:155], v[20:23]
    v_exp_f32 v131, v131
    v_mfma_f32_16x16x32_bf16 v[52:55], a[60:63], v[156:159], v[52:55]
    v_sub_f32 v132, v132, v177
    v_mfma_f32_16x16x32_bf16 v[84:87], a[60:63], v[160:163], v[84:87]
    s_waitcnt lgkmcnt(1)
    v_exp_f32 v132, v132
    v_mfma_f32_16x16x32_bf16 v[24:27], a[64:67], v[152:155], v[24:27]
    v_sub_f32 v133, v133, v177
    v_mfma_f32_16x16x32_bf16 v[56:59], a[64:67], v[156:159], v[56:59]
    v_exp_f32 v133, v133
    v_mfma_f32_16x16x32_bf16 v[88:91], a[64:67], v[160:163], v[88:91]
    s_waitcnt lgkmcnt(0)
    v_sub_f32 v134, v134, v177
    v_mfma_f32_16x16x32_bf16 v[28:31], a[48:51], v[152:155], v[28:31]
    v_exp_f32 v134, v134
    v_mfma_f32_16x16x32_bf16 v[60:63], a[48:51], v[156:159], v[60:63]
    v_sub_f32 v135, v135, v177
    v_mfma_f32_16x16x32_bf16 v[92:95], a[48:51], v[160:163], v[92:95]
    v_exp_f32 v135, v135
    v_sub_f32 v136, v136, v178
    v_exp_f32 v136, v136
    v_sub_f32 v137, v137, v178
    v_exp_f32 v137, v137
    v_sub_f32 v138, v138, v178
    v_exp_f32 v138, v138
    v_sub_f32 v139, v139, v178
    v_exp_f32 v139, v139
    s_cmp_lg_u32 s3, 1
    s_cbranch_scc1 L_concat_heads__mha_block_cached__gqa_block_cached__near_ridge_kernel_s_x1
    ds_read_b128 a[48:51], v185 offset:0
    ds_read_b128 a[52:55], v168 offset:40960
    ds_read_b128 a[56:59], v168 offset:45056
    s_waitcnt lgkmcnt(1)
    v_mfma_f32_16x16x32_bf16 v[140:143], a[52:55], a[48:51], 0
    s_waitcnt lgkmcnt(0)
    v_mfma_f32_16x16x32_bf16 v[144:147], a[56:59], a[48:51], 0
    s_nop 7
    ds_read_b128 a[48:51], v185 offset:1024
    ds_read_b128 a[52:55], v169 offset:40960
    ds_read_b128 a[56:59], v169 offset:45056
    s_waitcnt lgkmcnt(1)
    v_mfma_f32_16x16x32_bf16 v[140:143], a[52:55], a[48:51], v[140:143]
    s_waitcnt lgkmcnt(0)
    v_mfma_f32_16x16x32_bf16 v[144:147], a[56:59], a[48:51], v[144:147]
    s_nop 7
    ds_read_b128 a[48:51], v185 offset:2048
    ds_read_b128 a[52:55], v168 offset:41984
    ds_read_b128 a[56:59], v168 offset:46080
    s_waitcnt lgkmcnt(1)
    v_mfma_f32_16x16x32_bf16 v[140:143], a[52:55], a[48:51], v[140:143]
    s_waitcnt lgkmcnt(0)
    v_mfma_f32_16x16x32_bf16 v[144:147], a[56:59], a[48:51], v[144:147]
    s_nop 7
    ds_read_b128 a[48:51], v185 offset:3072
    ds_read_b128 a[52:55], v169 offset:41984
    ds_read_b128 a[56:59], v169 offset:46080
    s_waitcnt lgkmcnt(1)
    v_mfma_f32_16x16x32_bf16 v[140:143], a[52:55], a[48:51], v[140:143]
    s_waitcnt lgkmcnt(0)
    v_mfma_f32_16x16x32_bf16 v[144:147], a[56:59], a[48:51], v[144:147]
    s_nop 7
    v_sub_f32 v140, v140, v179
    v_exp_f32 v140, v140
    v_sub_f32 v141, v141, v179
    v_exp_f32 v141, v141
    v_sub_f32 v142, v142, v179
    v_exp_f32 v142, v142
    v_sub_f32 v143, v143, v179
    v_exp_f32 v143, v143
    v_sub_f32 v144, v144, v179
    v_exp_f32 v144, v144
    v_sub_f32 v145, v145, v179
    v_exp_f32 v145, v145
    v_sub_f32 v146, v146, v179
    v_exp_f32 v146, v146
    v_sub_f32 v147, v147, v179
    v_exp_f32 v147, v147
    v_cvt_pk_bf16_f32 v152, v140, v141
    v_cvt_pk_bf16_f32 v153, v142, v143
    v_add_f32 v167, v167, v140
    v_add_f32 v167, v167, v141
    v_add_f32 v167, v167, v142
    v_add_f32 v167, v167, v143
    v_cvt_pk_bf16_f32 v154, v144, v145
    v_cvt_pk_bf16_f32 v155, v146, v147
    v_add_f32 v167, v167, v144
    v_add_f32 v167, v167, v145
    v_add_f32 v167, v167, v146
    v_add_f32 v167, v167, v147
    ds_read_b64_tr_b16 a[48:49], v170 offset:8192
    ds_read_b64_tr_b16 a[50:51], v170 offset:12288
    s_waitcnt lgkmcnt(0)
    v_mfma_f32_16x16x32_bf16 v[96:99], a[48:51], v[152:155], v[96:99]
    ds_read_b64_tr_b16 a[52:53], v171 offset:8192
    ds_read_b64_tr_b16 a[54:55], v171 offset:12288
    s_waitcnt lgkmcnt(0)
    v_mfma_f32_16x16x32_bf16 v[100:103], a[52:55], v[152:155], v[100:103]
    ds_read_b64_tr_b16 a[56:57], v172 offset:8192
    ds_read_b64_tr_b16 a[58:59], v172 offset:12288
    s_waitcnt lgkmcnt(0)
    v_mfma_f32_16x16x32_bf16 v[104:107], a[56:59], v[152:155], v[104:107]
    ds_read_b64_tr_b16 a[60:61], v173 offset:8192
    ds_read_b64_tr_b16 a[62:63], v173 offset:12288
    s_waitcnt lgkmcnt(0)
    v_mfma_f32_16x16x32_bf16 v[108:111], a[60:63], v[152:155], v[108:111]
    ds_read_b64_tr_b16 a[64:65], v170 offset:9216
    ds_read_b64_tr_b16 a[66:67], v170 offset:13312
    s_waitcnt lgkmcnt(0)
    v_mfma_f32_16x16x32_bf16 v[112:115], a[64:67], v[152:155], v[112:115]
    ds_read_b64_tr_b16 a[48:49], v171 offset:9216
    ds_read_b64_tr_b16 a[50:51], v171 offset:13312
    s_waitcnt lgkmcnt(0)
    v_mfma_f32_16x16x32_bf16 v[116:119], a[48:51], v[152:155], v[116:119]
    ds_read_b64_tr_b16 a[52:53], v172 offset:9216
    ds_read_b64_tr_b16 a[54:55], v172 offset:13312
    s_waitcnt lgkmcnt(0)
    v_mfma_f32_16x16x32_bf16 v[120:123], a[52:55], v[152:155], v[120:123]
    ds_read_b64_tr_b16 a[56:57], v173 offset:9216
    ds_read_b64_tr_b16 a[58:59], v173 offset:13312
    s_waitcnt lgkmcnt(0)
    v_mfma_f32_16x16x32_bf16 v[124:127], a[56:59], v[152:155], v[124:127]
    s_nop 7
L_concat_heads__mha_block_cached__gqa_block_cached__near_ridge_kernel_s_x1:
    s_nop 1
    ds_read_b128 a[48:51], v168 offset:53248
    ds_read_b128 a[52:55], v169 offset:53248
    ds_read_b128 a[56:59], v168 offset:54272
    s_waitcnt vmcnt(6)
    s_add_u32 s16, s16, 4
    v_mov_b32 v187, 1
    s_mov_b64 exec, 1
    ds_add_rtn_u32 v187, v186, v187
    s_mov_b64 exec, -1
    s_waitcnt lgkmcnt(0)
    v_readfirstlane_b32 s17, v187
    s_nop 0
    s_add_u32 s17, s17, 1
    s_cmp_ge_u32 s17, s16
    s_cbranch_scc1 L_gb23_d
    s_mov_b32 s18, 0
L_gb23_l:
    ds_read_b32 v187, v186
    s_add_u32 s18, s18, 1
    s_cmp_ge_u32 s18, 0x200000
    s_cbranch_scc1 L_gb23_d
    s_waitcnt lgkmcnt(0)
    v_readfirstlane_b32 s17, v187
    s_nop 0
    s_cmp_ge_u32 s17, s16
    s_cbranch_scc0 L_gb23_l
L_gb23_d:
    v_mfma_f32_16x16x32_bf16 v[140:143], a[48:51], a[0:3], 0
    ds_read_b128 a[60:63], v169 offset:54272
    v_cvt_pk_bf16_f32 v152, v128, v129
    v_cvt_pk_bf16_f32 v153, v130, v131
    v_mfma_f32_16x16x32_bf16 v[144:147], a[48:51], a[16:19], 0
    ds_read_b128 a[64:67], v168 offset:57344
    v_add_f32 v164, v164, v128
    v_add_f32 v164, v164, v129
    v_mfma_f32_16x16x32_bf16 v[148:151], a[48:51], a[32:35], 0
    ds_read_b128 a[48:51], v169 offset:57344
    v_add_f32 v164, v164, v130
    v_add_f32 v164, v164, v131
    v_mfma_f32_16x16x32_bf16 v[140:143], a[52:55], a[4:7], v[140:143]
    s_add_u32 m0, s53, 40960
    v_cvt_pk_bf16_f32 v156, v132, v133
    v_cvt_pk_bf16_f32 v157, v134, v135
    v_mfma_f32_16x16x32_bf16 v[144:147], a[52:55], a[20:23], v[144:147]
    buffer_load_dwordx4 v174, s[36:39], s49 offen nt lds
    s_add_u32 m0, s53, 41856
    v_add_f32 v165, v165, v132
    v_add_f32 v165, v165, v133
    v_mfma_f32_16x16x32_bf16 v[148:151], a[52:55], a[36:39], v[148:151]
    ds_read_b128 a[52:55], v168 offset:58368
    buffer_load_dwordx4 v174, s[36:39], s49 offen offset:128 nt lds
    v_add_f32 v165, v165, v134
    v_add_f32 v165, v165, v135
    v_mfma_f32_16x16x32_bf16 v[140:143], a[56:59], a[8:11], v[140:143]
    s_add_u32 m0, s52, 8192
    s_nop 0
    buffer_load_dwordx4 v175, s[40:43], s49 offen nt lds
    v_cvt_pk_bf16_f32 v160, v136, v137
    v_cvt_pk_bf16_f32 v161, v138, v139
    v_mfma_f32_16x16x32_bf16 v[144:147], a[56:59], a[24:27], v[144:147]
    s_add_u32 m0, s52, 9088
    s_nop 0
    buffer_load_dwordx4 v175, s[40:43], s49 offen offset:128 nt lds
    v_add_f32 v166, v166, v136
    v_add_f32 v166, v166, v137
    v_mfma_f32_16x16x32_bf16 v[148:151], a[56:59], a[40:43], v[148:151]
    ds_read_b128 a[56:59], v169 offset:58368
    s_add_u32 s49, s49, 8192
    s_waitcnt lgkmcnt(3)
    v_add_f32 v166, v166, v138
    v_add_f32 v166, v166, v139
    v_mfma_f32_16x16x32_bf16 v[140:143], a[60:63], a[12:15], v[140:143]
    v_mfma_f32_16x16x32_bf16 v[144:147], a[60:63], a[28:31], v[144:147]
    v_mfma_f32_16x16x32_bf16 v[148:151], a[60:63], a[44:47], v[148:151]
    ds_read_b64_tr_b16 a[60:61], v170 offset:16384
    ds_read_b64_tr_b16 a[62:63], v170 offset:20480
    v_mfma_f32_16x16x32_bf16 v[128:131], a[64:67], a[0:3], 0
    s_nop 2
    v_sub_f32 v140, v140, v176
    v_mfma_f32_16x16x32_bf16 v[132:135], a[64:67], a[16:19], 0
    v_exp_f32 v140, v140
    v_mfma_f32_16x16x32_bf16 v[136:139], a[64:67], a[32:35], 0
    ds_read_b64_tr_b16 a[64:65], v171 offset:16384
    s_waitcnt lgkmcnt(4)
    v_sub_f32 v141, v141, v176
    v_mfma_f32_16x16x32_bf16 v[128:131], a[48:51], a[4:7], v[128:131]
    ds_read_b64_tr_b16 a[66:67], v171 offset:20480
    v_exp_f32 v141, v141
    v_mfma_f32_16x16x32_bf16 v[132:135], a[48:51], a[20:23], v[132:135]
    v_sub_f32 v142, v142, v176
    v_mfma_f32_16x16x32_bf16 v[136:139], a[48:51], a[36:39], v[136:139]
    ds_read_b64_tr_b16 a[48:49], v172 offset:16384
    v_exp_f32 v142, v142
    v_mfma_f32_16x16x32_bf16 v[128:131], a[52:55], a[8:11], v[128:131]
    ds_read_b64_tr_b16 a[50:51], v172 offset:20480
    v_sub_f32 v143, v143, v176
    v_mfma_f32_16x16x32_bf16 v[132:135], a[52:55], a[24:27], v[132:135]
    v_exp_f32 v143, v143
    v_mfma_f32_16x16x32_bf16 v[136:139], a[52:55], a[40:43], v[136:139]
    ds_read_b64_tr_b16 a[52:53], v173 offset:16384
    s_waitcnt lgkmcnt(6)
    v_cvt_pk_bf16_f32 v154, v140, v141
    v_cvt_pk_bf16_f32 v155, v142, v143
    v_mfma_f32_16x16x32_bf16 v[128:131], a[56:59], a[12:15], v[128:131]
    ds_read_b64_tr_b16 a[54:55], v173 offset:20480
    v_sub_f32 v144, v144, v177
    v_mfma_f32_16x16x32_bf16 v[132:135], a[56:59], a[28:31], v[132:135]
    v_exp_f32 v144, v144
    v_mfma_f32_16x16x32_bf16 v[136:139], a[56:59], a[44:47], v[136:139]
    ds_read_b64_tr_b16 a[56:57], v170 offset:17408
    s_waitcnt lgkmcnt(6)
    v_sub_f32 v145, v145, v177
    v_mfma_f32_16x16x32_bf16 v[0:3], a[60:63], v[152:155], v[0:3]
    ds_read_b64_tr_b16 a[58:59], v170 offset:21504
    v_exp_f32 v145, v145
    v_sub_f32 v146, v146, v177
    v_exp_f32 v146, v146
    v_sub_f32 v147, v147, v177
    v_exp_f32 v147, v147
    v_cvt_pk_bf16_f32 v158, v144, v145
    v_cvt_pk_bf16_f32 v159, v146, v147
    s_nop 1
    v_mfma_f32_16x16x32_bf16 v[32:35], a[60:63], v[156:159], v[32:35]
    v_sub_f32 v148, v148, v178
    v_exp_f32 v148, v148
    v_sub_f32 v149, v149, v178
    v_exp_f32 v149, v149
    v_sub_f32 v150, v150, v178
    v_exp_f32 v150, v150
    v_sub_f32 v151, v151, v178
    v_exp_f32 v151, v151
    v_cvt_pk_bf16_f32 v162, v148, v149
    v_cvt_pk_bf16_f32 v163, v150, v151
    s_nop 1
    v_mfma_f32_16x16x32_bf16 v[64:67], a[60:63], v[160:163], v[64:67]
    ds_read_b64_tr_b16 a[60:61], v171 offset:17408
    s_waitcnt lgkmcnt(6)
    v_add_f32 v164, v164, v140
    v_add_f32 v164, v164, v141
    v_mfma_f32_16x16x32_bf16 v[4:7], a[64:67], v[152:155], v[4:7]
    ds_read_b64_tr_b16 a[62:63], v171 offset:21504
    v_add_f32 v164, v164, v142
    v_add_f32 v164, v164, v143
    v_mfma_f32_16x16x32_bf16 v[36:39], a[64:67], v[156:159], v[36:39]
    v_add_f32 v165, v165, v144
    v_add_f32 v165, v165, v145
    v_mfma_f32_16x16x32_bf16 v[68:71], a[64:67], v[160:163], v[68:71]
    ds_read_b64_tr_b16 a[64:65], v172 offset:17408
    s_waitcnt lgkmcnt(6)
    v_add_f32 v165, v165, v146
    v_add_f32 v165, v165, v147
    v_mfma_f32_16x16x32_bf16 v[8:11], a[48:51], v[152:155], v[8:11]
    ds_read_b64_tr_b16 a[66:67], v172 offset:21504
    v_add_f32 v166, v166, v148
    v_add_f32 v166, v166, v149
    v_mfma_f32_16x16x32_bf16 v[40:43], a[48:51], v[156:159], v[40:43]
    v_add_f32 v166, v166, v150
    v_add_f32 v166, v166, v151
    v_mfma_f32_16x16x32_bf16 v[72:75], a[48:51], v[160:163], v[72:75]
    ds_read_b64_tr_b16 a[48:49], v173 offset:17408
    s_waitcnt lgkmcnt(6)
    v_sub_f32 v128, v128, v176
    v_mfma_f32_16x16x32_bf16 v[12:15], a[52:55], v[152:155], v[12:15]
    ds_read_b64_tr_b16 a[50:51], v173 offset:21504
    v_exp_f32 v128, v128
    v_mfma_f32_16x16x32_bf16 v[44:47], a[52:55], v[156:159], v[44:47]
    v_sub_f32 v129, v129, v176
    v_mfma_f32_16x16x32_bf16 v[76:79], a[52:55], v[160:163], v[76:79]
    s_waitcnt lgkmcnt(5)
    v_exp_f32 v129, v129
    v_mfma_f32_16x16x32_bf16 v[16:19], a[56:59], v[152:155], v[16:19]
    v_sub_f32 v130, v130, v176
    v_mfma_f32_16x16x32_bf16 v[48:51], a[56:59], v[156:159], v[48:51]
    v_exp_f32 v130, v130
    v_mfma_f32_16x16x32_bf16 v[80:83], a[56:59], v[160:163], v[80:83]
    s_waitcnt lgkmcnt(3)
    v_sub_f32 v131, v131, v176
    v_mfma_f32_16x16x32_bf16 v[20:23], a[60:63], v[152:155], v[20:23]
    v_exp_f32 v131, v131
    v_mfma_f32_16x16x32_bf16 v[52:55], a[60:63], v[156:159], v[52:55]
    v_sub_f32 v132, v132, v177
    v_mfma_f32_16x16x32_bf16 v[84:87], a[60:63], v[160:163], v[84:87]
    s_waitcnt lgkmcnt(1)
    v_exp_f32 v132, v132
    v_mfma_f32_16x16x32_bf16 v[24:27], a[64:67], v[152:155], v[24:27]
    v_sub_f32 v133, v133, v177
    v_mfma_f32_16x16x32_bf16 v[56:59], a[64:67], v[156:159], v[56:59]
    v_exp_f32 v133, v133
    v_mfma_f32_16x16x32_bf16 v[88:91], a[64:67], v[160:163], v[88:91]
    s_waitcnt lgkmcnt(0)
    v_sub_f32 v134, v134, v177
    v_mfma_f32_16x16x32_bf16 v[28:31], a[48:51], v[152:155], v[28:31]
    v_exp_f32 v134, v134
    v_mfma_f32_16x16x32_bf16 v[60:63], a[48:51], v[156:159], v[60:63]
    v_sub_f32 v135, v135, v177
    v_mfma_f32_16x16x32_bf16 v[92:95], a[48:51], v[160:163], v[92:95]
    v_exp_f32 v135, v135
    v_sub_f32 v136, v136, v178
    v_exp_f32 v136, v136
    v_sub_f32 v137, v137, v178
    v_exp_f32 v137, v137
    v_sub_f32 v138, v138, v178
    v_exp_f32 v138, v138
    v_sub_f32 v139, v139, v178
    v_exp_f32 v139, v139
    s_cmp_lg_u32 s3, 2
    s_cbranch_scc1 L_concat_heads__mha_block_cached__gqa_block_cached__near_ridge_kernel_s_x2
    ds_read_b128 a[48:51], v185 offset:0
    ds_read_b128 a[52:55], v168 offset:49152
    ds_read_b128 a[56:59], v168 offset:53248
    s_waitcnt lgkmcnt(1)
    v_mfma_f32_16x16x32_bf16 v[140:143], a[52:55], a[48:51], 0
    s_waitcnt lgkmcnt(0)
    v_mfma_f32_16x16x32_bf16 v[144:147], a[56:59], a[48:51], 0
    s_nop 7
    ds_read_b128 a[48:51], v185 offset:1024
    ds_read_b128 a[52:55], v169 offset:49152
    ds_read_b128 a[56:59], v169 offset:53248
    s_waitcnt lgkmcnt(1)
    v_mfma_f32_16x16x32_bf16 v[140:143], a[52:55], a[48:51], v[140:143]
    s_waitcnt lgkmcnt(0)
    v_mfma_f32_16x16x32_bf16 v[144:147], a[56:59], a[48:51], v[144:147]
    s_nop 7
    ds_read_b128 a[48:51], v185 offset:2048
    ds_read_b128 a[52:55], v168 offset:50176
    ds_read_b128 a[56:59], v168 offset:54272
    s_waitcnt lgkmcnt(1)
    v_mfma_f32_16x16x32_bf16 v[140:143], a[52:55], a[48:51], v[140:143]
    s_waitcnt lgkmcnt(0)
    v_mfma_f32_16x16x32_bf16 v[144:147], a[56:59], a[48:51], v[144:147]
    s_nop 7
    ds_read_b128 a[48:51], v185 offset:3072
    ds_read_b128 a[52:55], v169 offset:50176
    ds_read_b128 a[56:59], v169 offset:54272
    s_waitcnt lgkmcnt(1)
    v_mfma_f32_16x16x32_bf16 v[140:143], a[52:55], a[48:51], v[140:143]
    s_waitcnt lgkmcnt(0)
    v_mfma_f32_16x16x32_bf16 v[144:147], a[56:59], a[48:51], v[144:147]
    s_nop 7
    v_sub_f32 v140, v140, v179
    v_exp_f32 v140, v140
    v_sub_f32 v141, v141, v179
    v_exp_f32 v141, v141
    v_sub_f32 v142, v142, v179
    v_exp_f32 v142, v142
    v_sub_f32 v143, v143, v179
    v_exp_f32 v143, v143
    v_sub_f32 v144, v144, v179
    v_exp_f32 v144, v144
    v_sub_f32 v145, v145, v179
    v_exp_f32 v145, v145
    v_sub_f32 v146, v146, v179
    v_exp_f32 v146, v146
    v_sub_f32 v147, v147, v179
    v_exp_f32 v147, v147
    v_cvt_pk_bf16_f32 v152, v140, v141
    v_cvt_pk_bf16_f32 v153, v142, v143
    v_add_f32 v167, v167, v140
    v_add_f32 v167, v167, v141
    v_add_f32 v167, v167, v142
    v_add_f32 v167, v167, v143
    v_cvt_pk_bf16_f32 v154, v144, v145
    v_cvt_pk_bf16_f32 v155, v146, v147
    v_add_f32 v167, v167, v144
    v_add_f32 v167, v167, v145
    v_add_f32 v167, v167, v146
    v_add_f32 v167, v167, v147
    ds_read_b64_tr_b16 a[48:49], v170 offset:16384
    ds_read_b64_tr_b16 a[50:51], v170 offset:20480
    s_waitcnt lgkmcnt(0)
    v_mfma_f32_16x16x32_bf16 v[96:99], a[48:51], v[152:155], v[96:99]
    ds_read_b64_tr_b16 a[52:53], v171 offset:16384
    ds_read_b64_tr_b16 a[54:55], v171 offset:20480
    s_waitcnt lgkmcnt(0)
    v_mfma_f32_16x16x32_bf16 v[100:103], a[52:55], v[152:155], v[100:103]
    ds_read_b64_tr_b16 a[56:57], v172 offset:16384
    ds_read_b64_tr_b16 a[58:59], v172 offset:20480
    s_waitcnt lgkmcnt(0)
    v_mfma_f32_16x16x32_bf16 v[104:107], a[56:59], v[152:155], v[104:107]
    ds_read_b64_tr_b16 a[60:61], v173 offset:16384
    ds_read_b64_tr_b16 a[62:63], v173 offset:20480
    s_waitcnt lgkmcnt(0)
    v_mfma_f32_16x16x32_bf16 v[108:111], a[60:63], v[152:155], v[108:111]
    ds_read_b64_tr_b16 a[64:65], v170 offset:17408
    ds_read_b64_tr_b16 a[66:67], v170 offset:21504
    s_waitcnt lgkmcnt(0)
    v_mfma_f32_16x16x32_bf16 v[112:115], a[64:67], v[152:155], v[112:115]
    ds_read_b64_tr_b16 a[48:49], v171 offset:17408
    ds_read_b64_tr_b16 a[50:51], v171 offset:21504
    s_waitcnt lgkmcnt(0)
    v_mfma_f32_16x16x32_bf16 v[116:119], a[48:51], v[152:155], v[116:119]
    ds_read_b64_tr_b16 a[52:53], v172 offset:17408
    ds_read_b64_tr_b16 a[54:55], v172 offset:21504
    s_waitcnt lgkmcnt(0)
    v_mfma_f32_16x16x32_bf16 v[120:123], a[52:55], v[152:155], v[120:123]
    ds_read_b64_tr_b16 a[56:57], v173 offset:17408
    ds_read_b64_tr_b16 a[58:59], v173 offset:21504
    s_waitcnt lgkmcnt(0)
    v_mfma_f32_16x16x32_bf16 v[124:127], a[56:59], v[152:155], v[124:127]
    s_nop 7
L_concat_heads__mha_block_cached__gqa_block_cached__near_ridge_kernel_s_x2:
    s_nop 1
    ds_read_b128 a[48:51], v168 offset:61440
    ds_read_b128 a[52:55], v169 offset:61440
    ds_read_b128 a[56:59], v168 offset:62464
    s_waitcnt vmcnt(6)
    s_add_u32 s16, s16, 4
    v_mov_b32 v187, 1
    s_mov_b64 exec, 1
    ds_add_rtn_u32 v187, v186, v187
    s_mov_b64 exec, -1
    s_waitcnt lgkmcnt(0)
    v_readfirstlane_b32 s17, v187
    s_nop 0
    s_add_u32 s17, s17, 1
    s_cmp_ge_u32 s17, s16
    s_cbranch_scc1 L_gb24_d
    s_mov_b32 s18, 0
L_gb24_l:
    ds_read_b32 v187, v186
    s_add_u32 s18, s18, 1
    s_cmp_ge_u32 s18, 0x200000
    s_cbranch_scc1 L_gb24_d
    s_waitcnt lgkmcnt(0)
    v_readfirstlane_b32 s17, v187
    s_nop 0
    s_cmp_ge_u32 s17, s16
    s_cbranch_scc0 L_gb24_l
L_gb24_d:
    v_mfma_f32_16x16x32_bf16 v[140:143], a[48:51], a[0:3], 0
    ds_read_b128 a[60:63], v169 offset:62464
    v_cvt_pk_bf16_f32 v152, v128, v129
    v_cvt_pk_bf16_f32 v153, v130, v131
    v_mfma_f32_16x16x32_bf16 v[144:147], a[48:51], a[16:19], 0
    ds_read_b128 a[64:67], v168 offset:32768
    v_add_f32 v164, v164, v128
    v_add_f32 v164, v164, v129
    v_mfma_f32_16x16x32_bf16 v[148:151], a[48:51], a[32:35], 0
    ds_read_b128 a[48:51], v169 offset:32768
    v_add_f32 v164, v164, v130
    v_add_f32 v164, v164, v131
    v_mfma_f32_16x16x32_bf16 v[140:143], a[52:55], a[4:7], v[140:143]
    s_add_u32 m0, s53, 49152
    v_cvt_pk_bf16_f32 v156, v132, v133
    v_cvt_pk_bf16_f32 v157, v134, v135
    v_mfma_f32_16x16x32_bf16 v[144:147], a[52:55], a[20:23], v[144:147]
    buffer_load_dwordx4 v174, s[36:39], s49 offen nt lds
    s_add_u32 m0, s53, 50048
    v_add_f32 v165, v165, v132
    v_add_f32 v165, v165, v133
    v_mfma_f32_16x16x32_bf16 v[148:151], a[52:55], a[36:39], v[148:151]
    ds_read_b128 a[52:55], v168 offset:33792
    buffer_load_dwordx4 v174, s[36:39], s49 offen offset:128 nt lds
    v_add_f32 v165, v165, v134
    v_add_f32 v165, v165, v135
    v_mfma_f32_16x16x32_bf16 v[140:143], a[56:59], a[8:11], v[140:143]
    s_add_u32 m0, s52, 16384
    s_nop 0
    buffer_load_dwordx4 v175, s[40:43], s49 offen nt lds
    v_cvt_pk_bf16_f32 v160, v136, v137
    v_cvt_pk_bf16_f32 v161, v138, v139
    v_mfma_f32_16x16x32_bf16 v[144:147], a[56:59], a[24:27], v[144:147]
    s_add_u32 m0, s52, 17280
    s_nop 0
    buffer_load_dwordx4 v175, s[40:43], s49 offen offset:128 nt lds
    v_add_f32 v166, v166, v136
    v_add_f32 v166, v166, v137
    v_mfma_f32_16x16x32_bf16 v[148:151], a[56:59], a[40:43], v[148:151]
    ds_read_b128 a[56:59], v169 offset:33792
    s_add_u32 s49, s49, 8192
    s_waitcnt lgkmcnt(3)
    v_add_f32 v166, v166, v138
    v_add_f32 v166, v166, v139
    v_mfma_f32_16x16x32_bf16 v[140:143], a[60:63], a[12:15], v[140:143]
    v_mfma_f32_16x16x32_bf16 v[144:147], a[60:63], a[28:31], v[144:147]
    v_mfma_f32_16x16x32_bf16 v[148:151], a[60:63], a[44:47], v[148:151]
    ds_read_b64_tr_b16 a[60:61], v170 offset:24576
    ds_read_b64_tr_b16 a[62:63], v170 offset:28672
    v_mfma_f32_16x16x32_bf16 v[128:131], a[64:67], a[0:3], 0
    s_nop 2
    v_sub_f32 v140, v140, v176
    v_mfma_f32_16x16x32_bf16 v[132:135], a[64:67], a[16:19], 0
    v_exp_f32 v140, v140
    v_mfma_f32_16x16x32_bf16 v[136:139], a[64:67], a[32:35], 0
    ds_read_b64_tr_b16 a[64:65], v171 offset:24576
    s_waitcnt lgkmcnt(4)
    v_sub_f32 v141, v141, v176
    v_mfma_f32_16x16x32_bf16 v[128:131], a[48:51], a[4:7], v[128:131]
    ds_read_b64_tr_b16 a[66:67], v171 offset:28672
    v_exp_f32 v141, v141
    v_mfma_f32_16x16x32_bf16 v[132:135], a[48:51], a[20:23], v[132:135]
    v_sub_f32 v142, v142, v176
    v_mfma_f32_16x16x32_bf16 v[136:139], a[48:51], a[36:39], v[136:139]
    ds_read_b64_tr_b16 a[48:49], v172 offset:24576
    v_exp_f32 v142, v142
    v_mfma_f32_16x16x32_bf16 v[128:131], a[52:55], a[8:11], v[128:131]
    ds_read_b64_tr_b16 a[50:51], v172 offset:28672
    v_sub_f32 v143, v143, v176
    v_mfma_f32_16x16x32_bf16 v[132:135], a[52:55], a[24:27], v[132:135]
    v_exp_f32 v143, v143
    v_mfma_f32_16x16x32_bf16 v[136:139], a[52:55], a[40:43], v[136:139]
    ds_read_b64_tr_b16 a[52:53], v173 offset:24576
    s_waitcnt lgkmcnt(6)
    v_cvt_pk_bf16_f32 v154, v140, v141
    v_cvt_pk_bf16_f32 v155, v142, v143
    v_mfma_f32_16x16x32_bf16 v[128:131], a[56:59], a[12:15], v[128:131]
    ds_read_b64_tr_b16 a[54:55], v173 offset:28672
    v_sub_f32 v144, v144, v177
    v_mfma_f32_16x16x32_bf16 v[132:135], a[56:59], a[28:31], v[132:135]
    v_exp_f32 v144, v144
    v_mfma_f32_16x16x32_bf16 v[136:139], a[56:59], a[44:47], v[136:139]
    ds_read_b64_tr_b16 a[56:57], v170 offset:25600
    s_waitcnt lgkmcnt(6)
    v_sub_f32 v145, v145, v177
    v_mfma_f32_16x16x32_bf16 v[0:3], a[60:63], v[152:155], v[0:3]
    ds_read_b64_tr_b16 a[58:59], v170 offset:29696
    v_exp_f32 v145, v145
    v_sub_f32 v146, v146, v177
    v_exp_f32 v146, v146
    v_sub_f32 v147, v147, v177
    v_exp_f32 v147, v147
    v_cvt_pk_bf16_f32 v158, v144, v145
    v_cvt_pk_bf16_f32 v159, v146, v147
    s_nop 1
    v_mfma_f32_16x16x32_bf16 v[32:35], a[60:63], v[156:159], v[32:35]
    v_sub_f32 v148, v148, v178
    v_exp_f32 v148, v148
    v_sub_f32 v149, v149, v178
    v_exp_f32 v149, v149
    v_sub_f32 v150, v150, v178
    v_exp_f32 v150, v150
    v_sub_f32 v151, v151, v178
    v_exp_f32 v151, v151
    v_cvt_pk_bf16_f32 v162, v148, v149
    v_cvt_pk_bf16_f32 v163, v150, v151
    s_nop 1
    v_mfma_f32_16x16x32_bf16 v[64:67], a[60:63], v[160:163], v[64:67]
    ds_read_b64_tr_b16 a[60:61], v171 offset:25600
    s_waitcnt lgkmcnt(6)
    v_add_f32 v164, v164, v140
    v_add_f32 v164, v164, v141
    v_mfma_f32_16x16x32_bf16 v[4:7], a[64:67], v[152:155], v[4:7]
    ds_read_b64_tr_b16 a[62:63], v171 offset:29696
    v_add_f32 v164, v164, v142
    v_add_f32 v164, v164, v143
    v_mfma_f32_16x16x32_bf16 v[36:39], a[64:67], v[156:159], v[36:39]
    v_add_f32 v165, v165, v144
    v_add_f32 v165, v165, v145
    v_mfma_f32_16x16x32_bf16 v[68:71], a[64:67], v[160:163], v[68:71]
    ds_read_b64_tr_b16 a[64:65], v172 offset:25600
    s_waitcnt lgkmcnt(6)
    v_add_f32 v165, v165, v146
    v_add_f32 v165, v165, v147
    v_mfma_f32_16x16x32_bf16 v[8:11], a[48:51], v[152:155], v[8:11]
    ds_read_b64_tr_b16 a[66:67], v172 offset:29696
    v_add_f32 v166, v166, v148
    v_add_f32 v166, v166, v149
    v_mfma_f32_16x16x32_bf16 v[40:43], a[48:51], v[156:159], v[40:43]
    v_add_f32 v166, v166, v150
    v_add_f32 v166, v166, v151
    v_mfma_f32_16x16x32_bf16 v[72:75], a[48:51], v[160:163], v[72:75]
    ds_read_b64_tr_b16 a[48:49], v173 offset:25600
    s_waitcnt lgkmcnt(6)
    v_sub_f32 v128, v128, v176
    v_mfma_f32_16x16x32_bf16 v[12:15], a[52:55], v[152:155], v[12:15]
    ds_read_b64_tr_b16 a[50:51], v173 offset:29696
    v_exp_f32 v128, v128
    v_mfma_f32_16x16x32_bf16 v[44:47], a[52:55], v[156:159], v[44:47]
    v_sub_f32 v129, v129, v176
    v_mfma_f32_16x16x32_bf16 v[76:79], a[52:55], v[160:163], v[76:79]
    s_waitcnt lgkmcnt(5)
    v_exp_f32 v129, v129
    v_mfma_f32_16x16x32_bf16 v[16:19], a[56:59], v[152:155], v[16:19]
    v_sub_f32 v130, v130, v176
    v_mfma_f32_16x16x32_bf16 v[48:51], a[56:59], v[156:159], v[48:51]
    v_exp_f32 v130, v130
    v_mfma_f32_16x16x32_bf16 v[80:83], a[56:59], v[160:163], v[80:83]
    s_waitcnt lgkmcnt(3)
    v_sub_f32 v131, v131, v176
    v_mfma_f32_16x16x32_bf16 v[20:23], a[60:63], v[152:155], v[20:23]
    v_exp_f32 v131, v131
    v_mfma_f32_16x16x32_bf16 v[52:55], a[60:63], v[156:159], v[52:55]
    v_sub_f32 v132, v132, v177
    v_mfma_f32_16x16x32_bf16 v[84:87], a[60:63], v[160:163], v[84:87]
    s_waitcnt lgkmcnt(1)
    v_exp_f32 v132, v132
    v_mfma_f32_16x16x32_bf16 v[24:27], a[64:67], v[152:155], v[24:27]
    v_sub_f32 v133, v133, v177
    v_mfma_f32_16x16x32_bf16 v[56:59], a[64:67], v[156:159], v[56:59]
    v_exp_f32 v133, v133
    v_mfma_f32_16x16x32_bf16 v[88:91], a[64:67], v[160:163], v[88:91]
    s_waitcnt lgkmcnt(0)
    v_sub_f32 v134, v134, v177
    v_mfma_f32_16x16x32_bf16 v[28:31], a[48:51], v[152:155], v[28:31]
    v_exp_f32 v134, v134
    v_mfma_f32_16x16x32_bf16 v[60:63], a[48:51], v[156:159], v[60:63]
    v_sub_f32 v135, v135, v177
    v_mfma_f32_16x16x32_bf16 v[92:95], a[48:51], v[160:163], v[92:95]
    v_exp_f32 v135, v135
    v_sub_f32 v136, v136, v178
    v_exp_f32 v136, v136
    v_sub_f32 v137, v137, v178
    v_exp_f32 v137, v137
    v_sub_f32 v138, v138, v178
    v_exp_f32 v138, v138
    v_sub_f32 v139, v139, v178
    v_exp_f32 v139, v139
    s_cmp_lg_u32 s3, 3
    s_cbranch_scc1 L_concat_heads__mha_block_cached__gqa_block_cached__near_ridge_kernel_s_x3
    ds_read_b128 a[48:51], v185 offset:0
    ds_read_b128 a[52:55], v168 offset:57344
    ds_read_b128 a[56:59], v168 offset:61440
    s_waitcnt lgkmcnt(1)
    v_mfma_f32_16x16x32_bf16 v[140:143], a[52:55], a[48:51], 0
    s_waitcnt lgkmcnt(0)
    v_mfma_f32_16x16x32_bf16 v[144:147], a[56:59], a[48:51], 0
    s_nop 7
    ds_read_b128 a[48:51], v185 offset:1024
    ds_read_b128 a[52:55], v169 offset:57344
    ds_read_b128 a[56:59], v169 offset:61440
    s_waitcnt lgkmcnt(1)
    v_mfma_f32_16x16x32_bf16 v[140:143], a[52:55], a[48:51], v[140:143]
    s_waitcnt lgkmcnt(0)
    v_mfma_f32_16x16x32_bf16 v[144:147], a[56:59], a[48:51], v[144:147]
    s_nop 7
    ds_read_b128 a[48:51], v185 offset:2048
    ds_read_b128 a[52:55], v168 offset:58368
    ds_read_b128 a[56:59], v168 offset:62464
    s_waitcnt lgkmcnt(1)
    v_mfma_f32_16x16x32_bf16 v[140:143], a[52:55], a[48:51], v[140:143]
    s_waitcnt lgkmcnt(0)
    v_mfma_f32_16x16x32_bf16 v[144:147], a[56:59], a[48:51], v[144:147]
    s_nop 7
    ds_read_b128 a[48:51], v185 offset:3072
    ds_read_b128 a[52:55], v169 offset:58368
    ds_read_b128 a[56:59], v169 offset:62464
    s_waitcnt lgkmcnt(1)
    v_mfma_f32_16x16x32_bf16 v[140:143], a[52:55], a[48:51], v[140:143]
    s_waitcnt lgkmcnt(0)
    v_mfma_f32_16x16x32_bf16 v[144:147], a[56:59], a[48:51], v[144:147]
    s_nop 7
    v_sub_f32 v140, v140, v179
    v_exp_f32 v140, v140
    v_sub_f32 v141, v141, v179
    v_exp_f32 v141, v141
    v_sub_f32 v142, v142, v179
    v_exp_f32 v142, v142
    v_sub_f32 v143, v143, v179
    v_exp_f32 v143, v143
    v_sub_f32 v144, v144, v179
    v_exp_f32 v144, v144
    v_sub_f32 v145, v145, v179
    v_exp_f32 v145, v145
    v_sub_f32 v146, v146, v179
    v_exp_f32 v146, v146
    v_sub_f32 v147, v147, v179
    v_exp_f32 v147, v147
    v_cvt_pk_bf16_f32 v152, v140, v141
    v_cvt_pk_bf16_f32 v153, v142, v143
    v_add_f32 v167, v167, v140
    v_add_f32 v167, v167, v141
    v_add_f32 v167, v167, v142
    v_add_f32 v167, v167, v143
    v_cvt_pk_bf16_f32 v154, v144, v145
    v_cvt_pk_bf16_f32 v155, v146, v147
    v_add_f32 v167, v167, v144
    v_add_f32 v167, v167, v145
    v_add_f32 v167, v167, v146
    v_add_f32 v167, v167, v147
    ds_read_b64_tr_b16 a[48:49], v170 offset:24576
    ds_read_b64_tr_b16 a[50:51], v170 offset:28672
    s_waitcnt lgkmcnt(0)
    v_mfma_f32_16x16x32_bf16 v[96:99], a[48:51], v[152:155], v[96:99]
    ds_read_b64_tr_b16 a[52:53], v171 offset:24576
    ds_read_b64_tr_b16 a[54:55], v171 offset:28672
    s_waitcnt lgkmcnt(0)
    v_mfma_f32_16x16x32_bf16 v[100:103], a[52:55], v[152:155], v[100:103]
    ds_read_b64_tr_b16 a[56:57], v172 offset:24576
    ds_read_b64_tr_b16 a[58:59], v172 offset:28672
    s_waitcnt lgkmcnt(0)
    v_mfma_f32_16x16x32_bf16 v[104:107], a[56:59], v[152:155], v[104:107]
    ds_read_b64_tr_b16 a[60:61], v173 offset:24576
    ds_read_b64_tr_b16 a[62:63], v173 offset:28672
    s_waitcnt lgkmcnt(0)
    v_mfma_f32_16x16x32_bf16 v[108:111], a[60:63], v[152:155], v[108:111]
    ds_read_b64_tr_b16 a[64:65], v170 offset:25600
    ds_read_b64_tr_b16 a[66:67], v170 offset:29696
    s_waitcnt lgkmcnt(0)
    v_mfma_f32_16x16x32_bf16 v[112:115], a[64:67], v[152:155], v[112:115]
    ds_read_b64_tr_b16 a[48:49], v171 offset:25600
    ds_read_b64_tr_b16 a[50:51], v171 offset:29696
    s_waitcnt lgkmcnt(0)
    v_mfma_f32_16x16x32_bf16 v[116:119], a[48:51], v[152:155], v[116:119]
    ds_read_b64_tr_b16 a[52:53], v172 offset:25600
    ds_read_b64_tr_b16 a[54:55], v172 offset:29696
    s_waitcnt lgkmcnt(0)
    v_mfma_f32_16x16x32_bf16 v[120:123], a[52:55], v[152:155], v[120:123]
    ds_read_b64_tr_b16 a[56:57], v173 offset:25600
    ds_read_b64_tr_b16 a[58:59], v173 offset:29696
    s_waitcnt lgkmcnt(0)
    v_mfma_f32_16x16x32_bf16 v[124:127], a[56:59], v[152:155], v[124:127]
    s_nop 7
L_concat_heads__mha_block_cached__gqa_block_cached__near_ridge_kernel_s_x3:
    s_nop 1
    s_add_u32 s50, s50, 1
    s_cmp_lt_u32 s50, 4
    s_cbranch_scc1 L_concat_heads__mha_block_cached__gqa_block_cached__near_ridge_kernel_s_loop
    s_waitcnt vmcnt(0) lgkmcnt(0)
    s_add_u32 s16, s16, 4
    v_mov_b32 v187, 1
    s_mov_b64 exec, 1
    ds_add_rtn_u32 v187, v186, v187
    s_mov_b64 exec, -1
    s_waitcnt lgkmcnt(0)
    v_readfirstlane_b32 s17, v187
    s_nop 0
    s_add_u32 s17, s17, 1
    s_cmp_ge_u32 s17, s16
    s_cbranch_scc1 L_gb25_d
    s_mov_b32 s18, 0
L_gb25_l:
    ds_read_b32 v187, v186
    s_add_u32 s18, s18, 1
    s_cmp_ge_u32 s18, 0x200000
    s_cbranch_scc1 L_gb25_d
    s_waitcnt lgkmcnt(0)
    v_readfirstlane_b32 s17, v187
    s_nop 0
    s_cmp_ge_u32 s17, s16
    s_cbranch_scc0 L_gb25_l
L_gb25_d:
    v_mov_b32 v180, v164
    s_nop 1
    v_permlane32_swap_b32 v164, v180
    v_add_f32 v164, v164, v180
    v_mov_b32 v180, v164
    s_nop 1
    v_permlane16_swap_b32 v164, v180
    v_add_f32 v164, v164, v180
    v_mov_b32 v180, v165
    s_nop 1
    v_permlane32_swap_b32 v165, v180
    v_add_f32 v165, v165, v180
    v_mov_b32 v180, v165
    s_nop 1
    v_permlane16_swap_b32 v165, v180
    v_add_f32 v165, v165, v180
    v_mov_b32 v180, v166
    s_nop 1
    v_permlane32_swap_b32 v166, v180
    v_add_f32 v166, v166, v180
    v_mov_b32 v180, v166
    s_nop 1
    v_permlane16_swap_b32 v166, v180
    v_add_f32 v166, v166, v180
    v_mov_b32 v180, v167
    s_nop 1
    v_permlane32_swap_b32 v167, v180
    v_add_f32 v167, v167, v180
    v_mov_b32 v180, v167
    s_nop 1
    v_permlane16_swap_b32 v167, v180
    v_add_f32 v167, v167, v180
    v_mov_b32 v181, s3
    s_mov_b32 s54, s101
    v_lshl_add_u32 v182, v181, 13, v184
    v_add_u32 v182, s54, v182
    ds_write_b128 v182, v[96:99] offset:0
    ds_write_b128 v182, v[100:103] offset:1024
    ds_write_b128 v182, v[104:107] offset:2048
    ds_write_b128 v182, v[108:111] offset:3072
    ds_write_b128 v182, v[112:115] offset:4096
    ds_write_b128 v182, v[116:119] offset:5120
    ds_write_b128 v182, v[120:123] offset:6144
    ds_write_b128 v182, v[124:127] offset:7168
    v_lshrrev_b32 v180, 2, v184
    v_add_u32 v180, s100, v180
    v_lshl_add_u32 v182, v181, 8, v180
    ds_write_b32 v182, v167 offset:8192
    s_add_u32 s16, s16, 4
    v_mov_b32 v187, 1
    s_mov_b64 exec, 1
    ds_add_rtn_u32 v187, v186, v187
    s_mov_b64 exec, -1
    s_waitcnt lgkmcnt(0)
    v_readfirstlane_b32 s17, v187
    s_nop 0
    s_add_u32 s17, s17, 1
    s_cmp_ge_u32 s17, s16
    s_cbranch_scc1 L_gb26_d
    s_mov_b32 s18, 0
L_gb26_l:
    ds_read_b32 v187, v186
    s_add_u32 s18, s18, 1
    s_cmp_ge_u32 s18, 0x200000
    s_cbranch_scc1 L_gb26_d
    s_waitcnt lgkmcnt(0)
    v_readfirstlane_b32 s17, v187
    s_nop 0
    s_cmp_ge_u32 s17, s16
    s_cbranch_scc0 L_gb26_l
L_gb26_d:
    ds_read_b32 v128, v180 offset:8192
    ds_read_b32 v129, v180 offset:8448
    ds_read_b32 v130, v180 offset:8704
    ds_read_b32 v131, v180 offset:8960
    v_lshl_add_u32 v182, v181, 11, v184
    v_add_u32 v182, s54, v182
    ds_read_b128 v[96:99], v182 offset:0
    ds_read_b128 v[100:103], v182 offset:1024
    ds_read_b128 v[104:107], v182 offset:8192
    ds_read_b128 v[108:111], v182 offset:9216
    ds_read_b128 v[112:115], v182 offset:16384
    ds_read_b128 v[116:119], v182 offset:17408
    ds_read_b128 v[120:123], v182 offset:24576
    ds_read_b128 v[124:127], v182 offset:25600
    s_waitcnt lgkmcnt(10)
    v_add_f32 v128, v128, v129
    s_waitcnt lgkmcnt(8)
    v_add_f32 v130, v130, v131
    v_add_f32 v167, v128, v130
    v_rcp_f32 v164, v164
    v_rcp_f32 v165, v165
    v_rcp_f32 v166, v166
    v_rcp_f32 v167, v167
    s_waitcnt lgkmcnt(5)
    v_add_f32 v96, v96, v104
    s_waitcnt lgkmcnt(1)
    v_add_f32 v112, v112, v120
    v_add_f32 v97, v97, v105
    v_add_f32 v113, v113, v121
    v_add_f32 v98, v98, v106
    v_add_f32 v114, v114, v122
    v_add_f32 v99, v99, v107
    v_add_f32 v115, v115, v123
    v_add_f32 v100, v100, v108
    s_waitcnt lgkmcnt(0)
    v_add_f32 v116, v116, v124
    v_add_f32 v101, v101, v109
    v_add_f32 v117, v117, v125
    v_add_f32 v102, v102, v110
    v_add_f32 v118, v118, v126
    v_add_f32 v103, v103, v111
    v_add_f32 v119, v119, v127
    v_add_f32 v96, v96, v112
    v_add_f32 v97, v97, v113
    v_add_f32 v98, v98, v114
    v_add_f32 v99, v99, v115
    v_add_f32 v100, v100, v116
    v_add_f32 v101, v101, v117
    v_add_f32 v102, v102, v118
    v_add_f32 v103, v103, v119
    v_mul_f32 v96, v96, v167
    v_mul_f32 v97, v97, v167
    v_mul_f32 v98, v98, v167
    v_mul_f32 v99, v99, v167
    v_mul_f32 v100, v100, v167
    v_mul_f32 v101, v101, v167
    v_mul_f32 v102, v102, v167
    v_mul_f32 v103, v103, v167
    v_cvt_pk_bf16_f32 v152, v96, v97
    v_cvt_pk_bf16_f32 v153, v98, v99
    v_cvt_pk_bf16_f32 v154, v100, v101
    v_cvt_pk_bf16_f32 v155, v102, v103
    s_lshl_b32 s54, s3, 10
    v_add_u32 v182, s54, v185
    s_add_u32 s54, s54, 1572864
    buffer_store_dwordx4 v[152:155], v184, s[44:47], s54 offen sc1
    ds_write_b128 v182, v[152:155] offset:4096
    s_add_u32 s54, s61, 0
    v_mul_f32 v0, v0, v164
    v_mul_f32 v1, v1, v164
    v_mul_f32 v2, v2, v164
    v_mul_f32 v3, v3, v164
    v_mul_f32 v4, v4, v164
    v_mul_f32 v5, v5, v164
    v_mul_f32 v6, v6, v164
    v_mul_f32 v7, v7, v164
    v_cvt_pk_bf16_f32 v104, v0, v1
    v_cvt_pk_bf16_f32 v105, v2, v3
    v_cvt_pk_bf16_f32 v106, v4, v5
    v_cvt_pk_bf16_f32 v107, v6, v7
    buffer_store_dwordx4 v[104:107], v184, s[44:47], s54 offen offset:0 sc1
    v_mul_f32 v8, v8, v164
    v_mul_f32 v9, v9, v164
    v_mul_f32 v10, v10, v164
    v_mul_f32 v11, v11, v164
    v_mul_f32 v12, v12, v164
    v_mul_f32 v13, v13, v164
    v_mul_f32 v14, v14, v164
    v_mul_f32 v15, v15, v164
    v_cvt_pk_bf16_f32 v108, v8, v9
    v_cvt_pk_bf16_f32 v109, v10, v11
    v_cvt_pk_bf16_f32 v110, v12, v13
    v_cvt_pk_bf16_f32 v111, v14, v15
    buffer_store_dwordx4 v[108:111], v184, s[44:47], s54 offen offset:1024 sc1
    v_mul_f32 v16, v16, v164
    v_mul_f32 v17, v17, v164
    v_mul_f32 v18, v18, v164
    v_mul_f32 v19, v19, v164
    v_mul_f32 v20, v20, v164
    v_mul_f32 v21, v21, v164
    v_mul_f32 v22, v22, v164
    v_mul_f32 v23, v23, v164
    v_cvt_pk_bf16_f32 v112, v16, v17
    v_cvt_pk_bf16_f32 v113, v18, v19
    v_cvt_pk_bf16_f32 v114, v20, v21
    v_cvt_pk_bf16_f32 v115, v22, v23
    buffer_store_dwordx4 v[112:115], v184, s[44:47], s54 offen offset:2048 sc1
    v_mul_f32 v24, v24, v164
    v_mul_f32 v25, v25, v164
    v_mul_f32 v26, v26, v164
    v_mul_f32 v27, v27, v164
    v_mul_f32 v28, v28, v164
    v_mul_f32 v29, v29, v164
    v_mul_f32 v30, v30, v164
    v_mul_f32 v31, v31, v164
    v_cvt_pk_bf16_f32 v116, v24, v25
    v_cvt_pk_bf16_f32 v117, v26, v27
    v_cvt_pk_bf16_f32 v118, v28, v29
    v_cvt_pk_bf16_f32 v119, v30, v31
    buffer_store_dwordx4 v[116:119], v184, s[44:47], s54 offen offset:3072 sc1
    s_add_u32 s54, s61, 131072
    v_mul_f32 v32, v32, v165
    v_mul_f32 v33, v33, v165
    v_mul_f32 v34, v34, v165
    v_mul_f32 v35, v35, v165
    v_mul_f32 v36, v36, v165
    v_mul_f32 v37, v37, v165
    v_mul_f32 v38, v38, v165
    v_mul_f32 v39, v39, v165
    v_cvt_pk_bf16_f32 v120, v32, v33
    v_cvt_pk_bf16_f32 v121, v34, v35
    v_cvt_pk_bf16_f32 v122, v36, v37
    v_cvt_pk_bf16_f32 v123, v38, v39
    buffer_store_dwordx4 v[120:123], v184, s[44:47], s54 offen offset:0 sc1
    v_mul_f32 v40, v40, v165
    v_mul_f32 v41, v41, v165
    v_mul_f32 v42, v42, v165
    v_mul_f32 v43, v43, v165
    v_mul_f32 v44, v44, v165
    v_mul_f32 v45, v45, v165
    v_mul_f32 v46, v46, v165
    v_mul_f32 v47, v47, v165
    v_cvt_pk_bf16_f32 v124, v40, v41
    v_cvt_pk_bf16_f32 v125, v42, v43
    v_cvt_pk_bf16_f32 v126, v44, v45
    v_cvt_pk_bf16_f32 v127, v46, v47
    buffer_store_dwordx4 v[124:127], v184, s[44:47], s54 offen offset:1024 sc1
    v_mul_f32 v48, v48, v165
    v_mul_f32 v49, v49, v165
    v_mul_f32 v50, v50, v165
    v_mul_f32 v51, v51, v165
    v_mul_f32 v52, v52, v165
    v_mul_f32 v53, v53, v165
    v_mul_f32 v54, v54, v165
    v_mul_f32 v55, v55, v165
    v_cvt_pk_bf16_f32 v128, v48, v49
    v_cvt_pk_bf16_f32 v129, v50, v51
    v_cvt_pk_bf16_f32 v130, v52, v53
    v_cvt_pk_bf16_f32 v131, v54, v55
    buffer_store_dwordx4 v[128:131], v184, s[44:47], s54 offen offset:2048 sc1
    v_mul_f32 v56, v56, v165
    v_mul_f32 v57, v57, v165
    v_mul_f32 v58, v58, v165
    v_mul_f32 v59, v59, v165
    v_mul_f32 v60, v60, v165
    v_mul_f32 v61, v61, v165
    v_mul_f32 v62, v62, v165
    v_mul_f32 v63, v63, v165
    v_cvt_pk_bf16_f32 v132, v56, v57
    v_cvt_pk_bf16_f32 v133, v58, v59
    v_cvt_pk_bf16_f32 v134, v60, v61
    v_cvt_pk_bf16_f32 v135, v62, v63
    buffer_store_dwordx4 v[132:135], v184, s[44:47], s54 offen offset:3072 sc1
    s_add_u32 s54, s61, 262144
    v_mul_f32 v64, v64, v166
    v_mul_f32 v65, v65, v166
    v_mul_f32 v66, v66, v166
    v_mul_f32 v67, v67, v166
    v_mul_f32 v68, v68, v166
    v_mul_f32 v69, v69, v166
    v_mul_f32 v70, v70, v166
    v_mul_f32 v71, v71, v166
    v_cvt_pk_bf16_f32 v136, v64, v65
    v_cvt_pk_bf16_f32 v137, v66, v67
    v_cvt_pk_bf16_f32 v138, v68, v69
    v_cvt_pk_bf16_f32 v139, v70, v71
    buffer_store_dwordx4 v[136:139], v184, s[44:47], s54 offen offset:0 sc1
    v_mul_f32 v72, v72, v166
    v_mul_f32 v73, v73, v166
    v_mul_f32 v74, v74, v166
    v_mul_f32 v75, v75, v166
    v_mul_f32 v76, v76, v166
    v_mul_f32 v77, v77, v166
    v_mul_f32 v78, v78, v166
    v_mul_f32 v79, v79, v166
    v_cvt_pk_bf16_f32 v140, v72, v73
    v_cvt_pk_bf16_f32 v141, v74, v75
    v_cvt_pk_bf16_f32 v142, v76, v77
    v_cvt_pk_bf16_f32 v143, v78, v79
    buffer_store_dwordx4 v[140:143], v184, s[44:47], s54 offen offset:1024 sc1
    v_mul_f32 v80, v80, v166
    v_mul_f32 v81, v81, v166
    v_mul_f32 v82, v82, v166
    v_mul_f32 v83, v83, v166
    v_mul_f32 v84, v84, v166
    v_mul_f32 v85, v85, v166
    v_mul_f32 v86, v86, v166
    v_mul_f32 v87, v87, v166
    v_cvt_pk_bf16_f32 v144, v80, v81
    v_cvt_pk_bf16_f32 v145, v82, v83
    v_cvt_pk_bf16_f32 v146, v84, v85
    v_cvt_pk_bf16_f32 v147, v86, v87
    buffer_store_dwordx4 v[144:147], v184, s[44:47], s54 offen offset:2048 sc1
    v_mul_f32 v88, v88, v166
    v_mul_f32 v89, v89, v166
    v_mul_f32 v90, v90, v166
    v_mul_f32 v91, v91, v166
    v_mul_f32 v92, v92, v166
    v_mul_f32 v93, v93, v166
    v_mul_f32 v94, v94, v166
    v_mul_f32 v95, v95, v166
    v_cvt_pk_bf16_f32 v148, v88, v89
    v_cvt_pk_bf16_f32 v149, v90, v91
    v_cvt_pk_bf16_f32 v150, v92, v93
    v_cvt_pk_bf16_f32 v151, v94, v95
    buffer_store_dwordx4 v[148:151], v184, s[44:47], s54 offen offset:3072 sc1
    s_waitcnt lgkmcnt(0)
    s_branch L_concat_heads__mha_block_cached__gqa_block_cached__near_ridge_kernel_oproj
L_concat_heads__mha_block_cached__gqa_block_cached__near_ridge_kernel_oproj:
    s_load_dwordx2 s[8:9], s[0:1], 32
    s_load_dwordx2 s[10:11], s[0:1], 72
    s_load_dwordx4 s[12:15], s[0:1], 80
    s_waitcnt lgkmcnt(0)
    s_add_u32 s16, s16, 4
    v_mov_b32 v187, 1
    s_mov_b64 exec, 1
    ds_add_rtn_u32 v187, v186, v187
    s_mov_b64 exec, -1
    s_waitcnt lgkmcnt(0)
    v_readfirstlane_b32 s17, v187
    s_nop 0
    s_add_u32 s17, s17, 1
    s_cmp_ge_u32 s17, s16
    s_cbranch_scc1 L_gb27_d
    s_mov_b32 s18, 0
L_gb27_l:
    ds_read_b32 v187, v186
    s_add_u32 s18, s18, 1
    s_cmp_ge_u32 s18, 0x200000
    s_cbranch_scc1 L_gb27_d
    s_waitcnt lgkmcnt(0)
    v_readfirstlane_b32 s17, v187
    s_nop 0
    s_cmp_ge_u32 s17, s16
    s_cbranch_scc0 L_gb27_l
L_gb27_d:
    v_lshrrev_b32 v0, 4, v184
    v_mov_b32 v6, s3
    v_lshrrev_b32 v1, 4, v0
    v_bfe_u32 v2, v0, 2, 2
    v_and_b32 v3, 3, v0
    v_lshrrev_b32 v4, 3, v0
    v_lshl_add_u32 v4, v6, 3, v4
    v_and_b32 v5, 7, v0
    v_lshlrev_b32 v180, 1, v1
    v_xor_b32 v180, v180, v5
    v_lshlrev_b32 v180, 4, v180
    v_lshl_add_u32 v180, v4, 10, v180
    s_cmp_eq_u32 s4, 0
    s_waitcnt lgkmcnt(0)
    s_cselect_b64 s[8:9], s[8:9], s[10:11]
    s_lshl_b32 s54, s26, 20
    s_lshl_b32 s55, s56, 17
    s_add_u32 s54, s54, s55
    s_lshl_b32 s55, s62, 8
    s_add_u32 s54, s54, s55
    s_add_u32 s32, s8, s54
    s_addc_u32 s33, s9, 0
    s_sub_u32 s34, 0x400000, s54
    s_mov_b32 s35, 0x20000
    s_mov_b32 s52, s101
    s_lshl_b32 s54, s3, 11
    s_add_u32 s54, s54, s52
    s_mov_b32 s61, s54
    s_add_u32 m0, s61, 0
    s_add_u32 s48, s62, 0
    s_and_b32 s48, s48, 3
    s_lshl_b32 s48, s48, 18
    s_add_u32 s48, s48, 0
    buffer_load_dwordx4 v180, s[32:35], s48 offen lds
    s_add_u32 m0, s61, 896
    s_nop 0
    buffer_load_dwordx4 v180, s[32:35], s48 offen offset:128 lds
    s_add_u32 m0, s61, 8192
    s_add_u32 s48, s62, 0
    s_and_b32 s48, s48, 3
    s_lshl_b32 s48, s48, 18
    s_add_u32 s48, s48, 32768
    buffer_load_dwordx4 v180, s[32:35], s48 offen lds
    s_add_u32 m0, s61, 9088
    s_nop 0
    buffer_load_dwordx4 v180, s[32:35], s48 offen offset:128 lds
    s_add_u32 m0, s61, 16384
    s_add_u32 s48, s62, 0
    s_and_b32 s48, s48, 3
    s_lshl_b32 s48, s48, 18
    s_add_u32 s48, s48, 65536
    buffer_load_dwordx4 v180, s[32:35], s48 offen lds
    s_add_u32 m0, s61, 17280
    s_nop 0
    buffer_load_dwordx4 v180, s[32:35], s48 offen offset:128 lds
    s_add_u32 m0, s61, 24576
    s_add_u32 s48, s62, 0
    s_and_b32 s48, s48, 3
    s_lshl_b32 s48, s48, 18
    s_add_u32 s48, s48, 98304
    buffer_load_dwordx4 v180, s[32:35], s48 offen lds
    s_add_u32 m0, s61, 25472
    s_nop 0
    buffer_load_dwordx4 v180, s[32:35], s48 offen offset:128 lds
    s_add_u32 m0, s61, 32768
    s_add_u32 s48, s62, 1
    s_and_b32 s48, s48, 3
    s_lshl_b32 s48, s48, 18
    s_add_u32 s48, s48, 0
    buffer_load_dwordx4 v180, s[32:35], s48 offen lds
    s_add_u32 m0, s61, 33664
    s_nop 0
    buffer_load_dwordx4 v180, s[32:35], s48 offen offset:128 lds
    s_add_u32 m0, s61, 40960
    s_add_u32 s48, s62, 1
    s_and_b32 s48, s48, 3
    s_lshl_b32 s48, s48, 18
    s_add_u32 s48, s48, 32768
    buffer_load_dwordx4 v180, s[32:35], s48 offen lds
    s_add_u32 m0, s61, 41856
    s_nop 0
    buffer_load_dwordx4 v180, s[32:35], s48 offen offset:128 lds
    s_mul_i32 s54, s27, 1703936
    s_lshl_b32 s55, s26, 3
    s_add_u32 s55, s55, s56
    s_lshl_b32 s55, s55, 12
    s_add_u32 s54, s54, s55
    s_add_u32 s28, s24, s54
    s_addc_u32 s29, s25, 0
    s_sub_u32 s30, 1703936, s55
    s_mov_b32 s31, 0x20000
    s_lshl_b32 s54, s27, 2
    s_add_u32 s54, s54, s62
    s_lshl_b32 s54, s54, 19
    s_add_u32 s54, s54, 33554432
    s_add_u32 s36, s24, s54
    s_addc_u32 s37, s25, 0
    s_mov_b32 s38, 0x80000
    s_mov_b32 s39, 0x20000
    s_mul_i32 s54, s5, 425984
    s_lshl_b32 s55, s4, 10
    s_add_u32 s54, s54, s55
    s_lshl_b32 s55, s62, 8
    s_add_u32 s54, s54, s55
    s_add_u32 s44, s12, s54
    s_addc_u32 s45, s13, 0
    s_sub_u32 s46, 3407872, s54
    s_mov_b32 s47, 0x20000
    s_mul_i32 s54, s3, 393216
    v_add_u32 v176, s54, v184
    v_add_u32 v177, 131072, v176
    v_add_u32 v178, 262144, v176
    v_lshlrev_b32 v179, 2, v0
    v_lshl_add_u32 v179, v6, 8, v179
    v_add_u32 v179, 1572864, v179
    v_lshrrev_b32 v4, 1, v1
    v_lshlrev_b32 v4, 11, v4
    v_and_b32 v5, 1, v1
    v_lshl_add_u32 v4, v5, 9, v4
    v_lshl_add_u32 v4, v2, 7, v4
    v_lshl_add_u32 v4, v3, 3, v4
    v_add_u32 v4, s52, v4
    v_lshrrev_b32 v3, 1, v2
    v_lshl_or_b32 v5, v5, 1, v3
    s_add_u32 s54, s26, 0
    s_and_b32 s54, s54, 3
    v_xor_b32 v3, s54, v5
    v_lshl_add_u32 v168, v3, 5, v4
    s_add_u32 s54, s26, 1
    s_and_b32 s54, s54, 3
    v_xor_b32 v3, s54, v5
    v_lshl_add_u32 v169, v3, 5, v4
    s_add_u32 s54, s26, 2
    s_and_b32 s54, s54, 3
    v_xor_b32 v3, s54, v5
    v_lshl_add_u32 v170, v3, 5, v4
    s_add_u32 s54, s26, 3
    s_and_b32 s54, s54, 3
    v_xor_b32 v3, s54, v5
    v_lshl_add_u32 v171, v3, 5, v4
    v_xor_b32 v3, v6, v5
    v_lshl_add_u32 v172, v3, 5, v4
    v_mov_b32 v182, v0
    v_mov_b32 v183, v1
    s_lshl_b32 s51, s3, 8
    s_add_u32 s51, s51, s100
    s_waitcnt vmcnt(10)
    s_add_u32 s16, s16, 4
    v_mov_b32 v187, 1
    s_mov_b64 exec, 1
    ds_add_rtn_u32 v187, v186, v187
    s_mov_b64 exec, -1
    s_waitcnt lgkmcnt(0)
    v_readfirstlane_b32 s17, v187
    s_nop 0
    s_add_u32 s17, s17, 1
    s_cmp_ge_u32 s17, s16
    s_cbranch_scc1 L_gb28_d
    s_mov_b32 s18, 0
L_gb28_l:
    ds_read_b32 v187, v186
    s_add_u32 s18, s18, 1
    s_cmp_ge_u32 s18, 0x200000
    s_cbranch_scc1 L_gb28_d
    s_waitcnt lgkmcnt(0)
    v_readfirstlane_b32 s17, v187
    s_nop 0
    s_cmp_ge_u32 s17, s16
    s_cbranch_scc0 L_gb28_l
L_gb28_d:
    ds_read_b64_tr_b16 a[0:1], v168 offset:0
    ds_read_b64_tr_b16 a[2:3], v168 offset:4096
    s_waitcnt lgkmcnt(0)
    v_mfma_f32_16x16x32_bf16 v[0:3], a[0:3], v[104:107], 0
    ds_read_b64_tr_b16 a[4:5], v169 offset:0
    ds_read_b64_tr_b16 a[6:7], v169 offset:4096
    ds_read_b64_tr_b16 a[8:9], v170 offset:0
    v_mfma_f32_16x16x32_bf16 v[32:35], a[0:3], v[120:123], 0
    ds_read_b64_tr_b16 a[10:11], v170 offset:4096
    ds_read_b64_tr_b16 a[12:13], v171 offset:0
    ds_read_b64_tr_b16 a[14:15], v171 offset:4096
    v_mfma_f32_16x16x32_bf16 v[64:67], a[0:3], v[136:139], 0
    ds_read_b64_tr_b16 a[16:17], v168 offset:1024
    ds_read_b64_tr_b16 a[18:19], v168 offset:5120
    ds_read_b64_tr_b16 a[20:21], v169 offset:1024
    s_waitcnt lgkmcnt(5)
    v_mfma_f32_16x16x32_bf16 v[4:7], a[4:7], v[104:107], 0
    ds_read_b64_tr_b16 a[22:23], v169 offset:5120
    ds_read_b64_tr_b16 a[24:25], v170 offset:1024
    ds_read_b64_tr_b16 a[26:27], v170 offset:5120
    v_mfma_f32_16x16x32_bf16 v[36:39], a[4:7], v[120:123], 0
    ds_read_b64_tr_b16 a[28:29], v171 offset:1024
    ds_read_b64_tr_b16 a[30:31], v171 offset:5120
    ds_read_b128 a[32:35], v185 offset:4096
    ds_read_b64_tr_b16 a[36:37], v172 offset:0
    v_mfma_f32_16x16x32_bf16 v[68:71], a[4:7], v[136:139], 0
    ds_read_b64_tr_b16 a[38:39], v172 offset:4096
    ds_read_b64_tr_b16 a[0:1], v172 offset:1024
    ds_read_b64_tr_b16 a[2:3], v172 offset:5120
    s_add_u32 m0, s61, 49152
    v_mfma_f32_16x16x32_bf16 v[8:11], a[8:11], v[104:107], 0
    s_add_u32 s48, s62, 1
    s_and_b32 s48, s48, 3
    s_lshl_b32 s48, s48, 18
    s_add_u32 s48, s48, 65536
    v_mfma_f32_16x16x32_bf16 v[40:43], a[8:11], v[120:123], 0
    buffer_load_dwordx4 v180, s[32:35], s48 offen lds
    s_add_u32 m0, s61, 50048
    s_nop 0
    buffer_load_dwordx4 v180, s[32:35], s48 offen offset:128 lds
    v_mfma_f32_16x16x32_bf16 v[72:75], a[8:11], v[136:139], 0
    s_waitcnt lgkmcnt(11)
    v_mfma_f32_16x16x32_bf16 v[12:15], a[12:15], v[104:107], 0
    v_mfma_f32_16x16x32_bf16 v[44:47], a[12:15], v[120:123], 0
    v_mfma_f32_16x16x32_bf16 v[76:79], a[12:15], v[136:139], 0
    v_mfma_f32_16x16x32_bf16 v[16:19], a[16:19], v[104:107], 0
    s_andn2_b32 s54, s2, 24
    s_lshl_b32 s54, s54, 8
    s_lshl_b32 s7, s62, 3
    s_add_u32 s7, s7, s57
    s_lshl_b32 s7, s7, 2
    s_add_u32 s54, s54, s7
    v_lshlrev_b32 v181, 7, v184
    v_mov_b32 v173, 1
    s_mov_b64 exec, 0xf
    buffer_store_dword v173, v181, s[84:87], s54 offen offset:0 sc1
    s_mov_b64 exec, -1
    v_mfma_f32_16x16x32_bf16 v[48:51], a[16:19], v[120:123], 0
    v_mfma_f32_16x16x32_bf16 v[80:83], a[16:19], v[136:139], 0
    s_waitcnt lgkmcnt(7)
    v_mfma_f32_16x16x32_bf16 v[20:23], a[20:23], v[104:107], 0
    v_mfma_f32_16x16x32_bf16 v[52:55], a[20:23], v[120:123], 0
    v_mfma_f32_16x16x32_bf16 v[84:87], a[20:23], v[136:139], 0
    v_mfma_f32_16x16x32_bf16 v[24:27], a[24:27], v[104:107], 0
    v_mfma_f32_16x16x32_bf16 v[56:59], a[24:27], v[120:123], 0
    s_waitcnt vmcnt(11)
    s_add_u32 s16, s16, 4
    v_mov_b32 v187, 1
    s_mov_b64 exec, 1
    ds_add_rtn_u32 v187, v186, v187
    s_mov_b64 exec, -1
    s_waitcnt lgkmcnt(0)
    v_readfirstlane_b32 s17, v187
    s_nop 0
    s_add_u32 s17, s17, 1
    s_cmp_ge_u32 s17, s16
    s_cbranch_scc1 L_gb29_d
    s_mov_b32 s18, 0
L_gb29_l:
    ds_read_b32 v187, v186
    s_add_u32 s18, s18, 1
    s_cmp_ge_u32 s18, 0x200000
    s_cbranch_scc1 L_gb29_d
    s_waitcnt lgkmcnt(0)
    v_readfirstlane_b32 s17, v187
    s_nop 0
    s_cmp_ge_u32 s17, s16
    s_cbranch_scc0 L_gb29_l
L_gb29_d:
    v_mfma_f32_16x16x32_bf16 v[88:91], a[24:27], v[136:139], 0
    ds_read_b64_tr_b16 a[4:5], v168 offset:8192
    ds_read_b64_tr_b16 a[6:7], v168 offset:12288
    ds_read_b64_tr_b16 a[8:9], v169 offset:8192
    v_mfma_f32_16x16x32_bf16 v[28:31], a[28:31], v[104:107], 0
    ds_read_b64_tr_b16 a[10:11], v169 offset:12288
    ds_read_b64_tr_b16 a[12:13], v170 offset:8192
    ds_read_b64_tr_b16 a[14:15], v170 offset:12288
    v_mfma_f32_16x16x32_bf16 v[60:63], a[28:31], v[120:123], 0
    ds_read_b64_tr_b16 a[16:17], v171 offset:8192
    ds_read_b64_tr_b16 a[18:19], v171 offset:12288
    ds_read_b64_tr_b16 a[20:21], v168 offset:9216
    v_mfma_f32_16x16x32_bf16 v[92:95], a[28:31], v[136:139], 0
    ds_read_b64_tr_b16 a[22:23], v168 offset:13312
    ds_read_b64_tr_b16 a[24:25], v169 offset:9216
    ds_read_b64_tr_b16 a[26:27], v169 offset:13312
    v_mfma_f32_16x16x32_bf16 v[96:99], a[36:39], a[32:35], 0
    ds_read_b64_tr_b16 a[28:29], v170 offset:9216
    ds_read_b64_tr_b16 a[30:31], v170 offset:13312
    ds_read_b64_tr_b16 a[36:37], v171 offset:9216
    s_add_u32 m0, s61, 57344
    v_mfma_f32_16x16x32_bf16 v[100:103], a[0:3], a[32:35], 0
    ds_read_b64_tr_b16 a[38:39], v171 offset:13312
    ds_read_b128 a[0:3], v185 offset:5120
    ds_read_b64_tr_b16 a[32:33], v172 offset:8192
    s_add_u32 s48, s62, 1
    s_waitcnt lgkmcnt(14)
    v_mfma_f32_16x16x32_bf16 v[0:3], a[4:7], v[108:111], v[0:3]
    ds_read_b64_tr_b16 a[34:35], v172 offset:12288
    s_and_b32 s48, s48, 3
    s_lshl_b32 s48, s48, 18
    s_add_u32 s48, s48, 98304
    v_mfma_f32_16x16x32_bf16 v[32:35], a[4:7], v[124:127], v[32:35]
    buffer_load_dwordx4 v180, s[32:35], s48 offen lds
    s_add_u32 m0, s61, 58240
    s_nop 0
    buffer_load_dwordx4 v180, s[32:35], s48 offen offset:128 lds
    v_mfma_f32_16x16x32_bf16 v[64:67], a[4:7], v[140:143], v[64:67]
    ds_read_b64_tr_b16 a[4:5], v172 offset:9216
    ds_read_b64_tr_b16 a[6:7], v172 offset:13312
    v_mfma_f32_16x16x32_bf16 v[4:7], a[8:11], v[108:111], v[4:7]
    v_mfma_f32_16x16x32_bf16 v[36:39], a[8:11], v[124:127], v[36:39]
    v_mfma_f32_16x16x32_bf16 v[68:71], a[8:11], v[140:143], v[68:71]
    s_waitcnt lgkmcnt(13)
    v_mfma_f32_16x16x32_bf16 v[8:11], a[12:15], v[108:111], v[8:11]
    v_mfma_f32_16x16x32_bf16 v[40:43], a[12:15], v[124:127], v[40:43]
    v_mfma_f32_16x16x32_bf16 v[72:75], a[12:15], v[140:143], v[72:75]
    v_mfma_f32_16x16x32_bf16 v[12:15], a[16:19], v[108:111], v[12:15]
    v_mfma_f32_16x16x32_bf16 v[44:47], a[16:19], v[124:127], v[44:47]
    v_mfma_f32_16x16x32_bf16 v[76:79], a[16:19], v[140:143], v[76:79]
    s_waitcnt lgkmcnt(9)
    v_mfma_f32_16x16x32_bf16 v[16:19], a[20:23], v[108:111], v[16:19]
    v_mfma_f32_16x16x32_bf16 v[48:51], a[20:23], v[124:127], v[48:51]
    v_mfma_f32_16x16x32_bf16 v[80:83], a[20:23], v[140:143], v[80:83]
    v_mfma_f32_16x16x32_bf16 v[20:23], a[24:27], v[108:111], v[20:23]
    v_mfma_f32_16x16x32_bf16 v[52:55], a[24:27], v[124:127], v[52:55]
    v_mfma_f32_16x16x32_bf16 v[84:87], a[24:27], v[140:143], v[84:87]
    s_waitcnt lgkmcnt(5)
    v_mfma_f32_16x16x32_bf16 v[24:27], a[28:31], v[108:111], v[24:27]
    v_mfma_f32_16x16x32_bf16 v[56:59], a[28:31], v[124:127], v[56:59]
    s_waitcnt vmcnt(11)
    s_add_u32 s16, s16, 4
    v_mov_b32 v187, 1
    s_mov_b64 exec, 1
    ds_add_rtn_u32 v187, v186, v187
    s_mov_b64 exec, -1
    s_waitcnt lgkmcnt(0)
    v_readfirstlane_b32 s17, v187
    s_nop 0
    s_add_u32 s17, s17, 1
    s_cmp_ge_u32 s17, s16
    s_cbranch_scc1 L_gb30_d
    s_mov_b32 s18, 0
L_gb30_l:
    ds_read_b32 v187, v186
    s_add_u32 s18, s18, 1
    s_cmp_ge_u32 s18, 0x200000
    s_cbranch_scc1 L_gb30_d
    s_waitcnt lgkmcnt(0)
    v_readfirstlane_b32 s17, v187
    s_nop 0
    s_cmp_ge_u32 s17, s16
    s_cbranch_scc0 L_gb30_l
L_gb30_d:
    v_mfma_f32_16x16x32_bf16 v[88:91], a[28:31], v[140:143], v[88:91]
    ds_read_b64_tr_b16 a[8:9], v168 offset:16384
    ds_read_b64_tr_b16 a[10:11], v168 offset:20480
    ds_read_b64_tr_b16 a[12:13], v169 offset:16384
    v_mfma_f32_16x16x32_bf16 v[28:31], a[36:39], v[108:111], v[28:31]
    ds_read_b64_tr_b16 a[14:15], v169 offset:20480
    ds_read_b64_tr_b16 a[16:17], v170 offset:16384
    ds_read_b64_tr_b16 a[18:19], v170 offset:20480
    v_mfma_f32_16x16x32_bf16 v[60:63], a[36:39], v[124:127], v[60:63]
    ds_read_b64_tr_b16 a[20:21], v171 offset:16384
    ds_read_b64_tr_b16 a[22:23], v171 offset:20480
    ds_read_b64_tr_b16 a[24:25], v168 offset:17408
    v_mfma_f32_16x16x32_bf16 v[92:95], a[36:39], v[140:143], v[92:95]
    ds_read_b64_tr_b16 a[26:27], v168 offset:21504
    ds_read_b64_tr_b16 a[28:29], v169 offset:17408
    ds_read_b64_tr_b16 a[30:31], v169 offset:21504
    v_mfma_f32_16x16x32_bf16 v[96:99], a[32:35], a[0:3], v[96:99]
    ds_read_b64_tr_b16 a[36:37], v170 offset:17408
    ds_read_b64_tr_b16 a[38:39], v170 offset:21504
    ds_read_b64_tr_b16 a[32:33], v171 offset:17408
    s_add_u32 m0, s61, 0
    v_mfma_f32_16x16x32_bf16 v[100:103], a[4:7], a[0:3], v[100:103]
    ds_read_b64_tr_b16 a[34:35], v171 offset:21504
    ds_read_b128 a[0:3], v185 offset:6144
    ds_read_b64_tr_b16 a[4:5], v172 offset:16384
    s_add_u32 s48, s62, 2
    s_waitcnt lgkmcnt(14)
    v_mfma_f32_16x16x32_bf16 v[0:3], a[8:11], v[112:115], v[0:3]
    ds_read_b64_tr_b16 a[6:7], v172 offset:20480
    s_and_b32 s48, s48, 3
    s_lshl_b32 s48, s48, 18
    s_add_u32 s48, s48, 0
    v_mfma_f32_16x16x32_bf16 v[32:35], a[8:11], v[128:131], v[32:35]
    buffer_load_dwordx4 v180, s[32:35], s48 offen lds
    s_add_u32 m0, s61, 896
    s_nop 0
    buffer_load_dwordx4 v180, s[32:35], s48 offen offset:128 lds
    v_mfma_f32_16x16x32_bf16 v[64:67], a[8:11], v[144:147], v[64:67]
    ds_read_b64_tr_b16 a[8:9], v172 offset:17408
    ds_read_b64_tr_b16 a[10:11], v172 offset:21504
    v_mfma_f32_16x16x32_bf16 v[4:7], a[12:15], v[112:115], v[4:7]
    v_mfma_f32_16x16x32_bf16 v[36:39], a[12:15], v[128:131], v[36:39]
    v_mfma_f32_16x16x32_bf16 v[68:71], a[12:15], v[144:147], v[68:71]
    s_waitcnt lgkmcnt(13)
    v_mfma_f32_16x16x32_bf16 v[8:11], a[16:19], v[112:115], v[8:11]
    v_mfma_f32_16x16x32_bf16 v[40:43], a[16:19], v[128:131], v[40:43]
    v_mfma_f32_16x16x32_bf16 v[72:75], a[16:19], v[144:147], v[72:75]
    v_mfma_f32_16x16x32_bf16 v[12:15], a[20:23], v[112:115], v[12:15]
    v_mfma_f32_16x16x32_bf16 v[44:47], a[20:23], v[128:131], v[44:47]
    v_mfma_f32_16x16x32_bf16 v[76:79], a[20:23], v[144:147], v[76:79]
    s_waitcnt lgkmcnt(9)
    v_mfma_f32_16x16x32_bf16 v[16:19], a[24:27], v[112:115], v[16:19]
    v_mfma_f32_16x16x32_bf16 v[48:51], a[24:27], v[128:131], v[48:51]
    v_mfma_f32_16x16x32_bf16 v[80:83], a[24:27], v[144:147], v[80:83]
    v_mfma_f32_16x16x32_bf16 v[20:23], a[28:31], v[112:115], v[20:23]
    v_mfma_f32_16x16x32_bf16 v[52:55], a[28:31], v[128:131], v[52:55]
    v_mfma_f32_16x16x32_bf16 v[84:87], a[28:31], v[144:147], v[84:87]
    s_waitcnt lgkmcnt(5)
    v_mfma_f32_16x16x32_bf16 v[24:27], a[36:39], v[112:115], v[24:27]
    v_mfma_f32_16x16x32_bf16 v[56:59], a[36:39], v[128:131], v[56:59]
    s_waitcnt vmcnt(11)
    s_add_u32 s16, s16, 4
    v_mov_b32 v187, 1
    s_mov_b64 exec, 1
    ds_add_rtn_u32 v187, v186, v187
    s_mov_b64 exec, -1
    s_waitcnt lgkmcnt(0)
    v_readfirstlane_b32 s17, v187
    s_nop 0
    s_add_u32 s17, s17, 1
    s_cmp_ge_u32 s17, s16
    s_cbranch_scc1 L_gb31_d
    s_mov_b32 s18, 0
L_gb31_l:
    ds_read_b32 v187, v186
    s_add_u32 s18, s18, 1
    s_cmp_ge_u32 s18, 0x200000
    s_cbranch_scc1 L_gb31_d
    s_waitcnt lgkmcnt(0)
    v_readfirstlane_b32 s17, v187
    s_nop 0
    s_cmp_ge_u32 s17, s16
    s_cbranch_scc0 L_gb31_l
L_gb31_d:
    v_mfma_f32_16x16x32_bf16 v[88:91], a[36:39], v[144:147], v[88:91]
    ds_read_b64_tr_b16 a[12:13], v168 offset:24576
    ds_read_b64_tr_b16 a[14:15], v168 offset:28672
    ds_read_b64_tr_b16 a[16:17], v169 offset:24576
    v_mfma_f32_16x16x32_bf16 v[28:31], a[32:35], v[112:115], v[28:31]
    ds_read_b64_tr_b16 a[18:19], v169 offset:28672
    ds_read_b64_tr_b16 a[20:21], v170 offset:24576
    ds_read_b64_tr_b16 a[22:23], v170 offset:28672
    v_mfma_f32_16x16x32_bf16 v[60:63], a[32:35], v[128:131], v[60:63]
    ds_read_b64_tr_b16 a[24:25], v171 offset:24576
    ds_read_b64_tr_b16 a[26:27], v171 offset:28672
    ds_read_b64_tr_b16 a[28:29], v168 offset:25600
    v_mfma_f32_16x16x32_bf16 v[92:95], a[32:35], v[144:147], v[92:95]
    ds_read_b64_tr_b16 a[30:31], v168 offset:29696
    ds_read_b64_tr_b16 a[36:37], v169 offset:25600
    ds_read_b64_tr_b16 a[38:39], v169 offset:29696
    v_mfma_f32_16x16x32_bf16 v[96:99], a[4:7], a[0:3], v[96:99]
    ds_read_b64_tr_b16 a[32:33], v170 offset:25600
    ds_read_b64_tr_b16 a[34:35], v170 offset:29696
    ds_read_b64_tr_b16 a[4:5], v171 offset:25600
    s_add_u32 m0, s61, 8192
    v_mfma_f32_16x16x32_bf16 v[100:103], a[8:11], a[0:3], v[100:103]
    ds_read_b64_tr_b16 a[6:7], v171 offset:29696
    ds_read_b128 a[0:3], v185 offset:7168
    ds_read_b64_tr_b16 a[8:9], v172 offset:24576
    s_add_u32 s48, s62, 2
    s_waitcnt lgkmcnt(14)
    v_mfma_f32_16x16x32_bf16 v[0:3], a[12:15], v[116:119], v[0:3]
    ds_read_b64_tr_b16 a[10:11], v172 offset:28672
    s_and_b32 s48, s48, 3
    s_lshl_b32 s48, s48, 18
    s_add_u32 s48, s48, 32768
    v_mfma_f32_16x16x32_bf16 v[32:35], a[12:15], v[132:135], v[32:35]
    buffer_load_dwordx4 v180, s[32:35], s48 offen lds
    s_add_u32 m0, s61, 9088
    s_nop 0
    buffer_load_dwordx4 v180, s[32:35], s48 offen offset:128 lds
    v_mfma_f32_16x16x32_bf16 v[64:67], a[12:15], v[148:151], v[64:67]
    ds_read_b64_tr_b16 a[12:13], v172 offset:25600
    ds_read_b64_tr_b16 a[14:15], v172 offset:29696
    v_mfma_f32_16x16x32_bf16 v[4:7], a[16:19], v[116:119], v[4:7]
    v_mfma_f32_16x16x32_bf16 v[36:39], a[16:19], v[132:135], v[36:39]
    v_mfma_f32_16x16x32_bf16 v[68:71], a[16:19], v[148:151], v[68:71]
    s_waitcnt lgkmcnt(13)
    v_mfma_f32_16x16x32_bf16 v[8:11], a[20:23], v[116:119], v[8:11]
    v_mfma_f32_16x16x32_bf16 v[40:43], a[20:23], v[132:135], v[40:43]
    v_mfma_f32_16x16x32_bf16 v[72:75], a[20:23], v[148:151], v[72:75]
    v_mfma_f32_16x16x32_bf16 v[12:15], a[24:27], v[116:119], v[12:15]
    v_mfma_f32_16x16x32_bf16 v[44:47], a[24:27], v[132:135], v[44:47]
    v_mfma_f32_16x16x32_bf16 v[76:79], a[24:27], v[148:151], v[76:79]
    s_waitcnt lgkmcnt(9)
    v_mfma_f32_16x16x32_bf16 v[16:19], a[28:31], v[116:119], v[16:19]
    v_mfma_f32_16x16x32_bf16 v[48:51], a[28:31], v[132:135], v[48:51]
    v_mfma_f32_16x16x32_bf16 v[80:83], a[28:31], v[148:151], v[80:83]
    v_mfma_f32_16x16x32_bf16 v[20:23], a[36:39], v[116:119], v[20:23]
    v_mfma_f32_16x16x32_bf16 v[52:55], a[36:39], v[132:135], v[52:55]
    v_mfma_f32_16x16x32_bf16 v[84:87], a[36:39], v[148:151], v[84:87]
    s_waitcnt lgkmcnt(5)
    v_mfma_f32_16x16x32_bf16 v[24:27], a[32:35], v[116:119], v[24:27]
    v_mfma_f32_16x16x32_bf16 v[56:59], a[32:35], v[132:135], v[56:59]
    v_mfma_f32_16x16x32_bf16 v[88:91], a[32:35], v[148:151], v[88:91]
    v_mfma_f32_16x16x32_bf16 v[28:31], a[4:7], v[116:119], v[28:31]
    v_mfma_f32_16x16x32_bf16 v[60:63], a[4:7], v[132:135], v[60:63]
    v_mfma_f32_16x16x32_bf16 v[92:95], a[4:7], v[148:151], v[92:95]
    s_waitcnt lgkmcnt(0)
    v_mfma_f32_16x16x32_bf16 v[96:99], a[8:11], a[0:3], v[96:99]
    v_mfma_f32_16x16x32_bf16 v[100:103], a[12:15], a[0:3], v[100:103]
    s_lshl_b32 s55, s56, 2
    s_lshl_b32 s55, 0x0f0f0f0f, s55
    s_mov_b32 s50, 0
    s_lshl_b32 s7, s2, 8
    v_lshrrev_b32 v181, 2, v184
    v_and_b32 v181, 0x7c, v181
L_concat_heads__mha_block_cached__gqa_block_cached__near_ridge_kernel_w0_poll:
    buffer_load_dword v173, v181, s[84:87], s7 offen offset:0 sc1
    s_waitcnt vmcnt(0)
    v_cmp_eq_u32 vcc, 1, v173
    s_nop 0
    s_and_b32 s54, vcc_lo, s55
    s_cmp_eq_u32 s54, s55
    s_cbranch_scc1 L_concat_heads__mha_block_cached__gqa_block_cached__near_ridge_kernel_w0_polled
    s_sleep 2
    s_add_u32 s50, s50, 1
    s_cmp_lt_u32 s50, 0x100000
    s_cbranch_scc1 L_concat_heads__mha_block_cached__gqa_block_cached__near_ridge_kernel_w0_poll
L_concat_heads__mha_block_cached__gqa_block_cached__near_ridge_kernel_w0_polled:
    s_add_u32 s63, s62, 1
    s_and_b32 s63, s63, 3
    s_lshl_b32 s63, s63, 13
    s_add_u32 s63, s63, 0
    buffer_load_dwordx4 v[152:155], v176, s[28:31], s63 offen sc1
    buffer_load_dwordx4 v[156:159], v177, s[28:31], s63 offen sc1
    buffer_load_dwordx4 v[160:163], v178, s[28:31], s63 offen sc1
    s_add_u32 m0, s51, 12288
    s_add_u32 s49, s62, 1
    s_and_b32 s49, s49, 3
    s_lshl_b32 s49, s49, 13
    s_add_u32 s49, s49, 0
    buffer_load_dword v179, s[28:31], s49 offen sc1 lds
    s_add_u32 s63, s62, 1
    s_and_b32 s63, s63, 3
    s_lshl_b32 s63, s63, 13
    s_add_u32 s63, s63, 1024
    buffer_load_dwordx4 a[40:43], v176, s[28:31], s63 offen sc1
    buffer_load_dwordx4 a[44:47], v177, s[28:31], s63 offen sc1
    buffer_load_dwordx4 a[48:51], v178, s[28:31], s63 offen sc1
    s_add_u32 m0, s51, 13312
    s_add_u32 s49, s62, 1
    s_and_b32 s49, s49, 3
    s_lshl_b32 s49, s49, 13
    s_add_u32 s49, s49, 1024
    buffer_load_dword v179, s[28:31], s49 offen sc1 lds
    s_add_u32 s63, s62, 1
    s_and_b32 s63, s63, 3
    s_lshl_b32 s63, s63, 13
    s_add_u32 s63, s63, 2048
    buffer_load_dwordx4 a[52:55], v176, s[28:31], s63 offen sc1
    buffer_load_dwordx4 a[56:59], v177, s[28:31], s63 offen sc1
    buffer_load_dwordx4 a[60:63], v178, s[28:31], s63 offen sc1
    s_add_u32 m0, s51, 14336
    s_add_u32 s49, s62, 1
    s_and_b32 s49, s49, 3
    s_lshl_b32 s49, s49, 13
    s_add_u32 s49, s49, 2048
    buffer_load_dword v179, s[28:31], s49 offen sc1 lds
    s_add_u32 s63, s62, 1
    s_and_b32 s63, s63, 3
    s_lshl_b32 s63, s63, 13
    s_add_u32 s63, s63, 3072
    buffer_load_dwordx4 v[104:107], v176, s[28:31], s63 offen sc1
    buffer_load_dwordx4 v[108:111], v177, s[28:31], s63 offen sc1
    buffer_load_dwordx4 v[112:115], v178, s[28:31], s63 offen sc1
    s_add_u32 m0, s51, 8192
    s_add_u32 s49, s62, 1
    s_and_b32 s49, s49, 3
    s_lshl_b32 s49, s49, 13
    s_add_u32 s49, s49, 3072
    buffer_load_dword v179, s[28:31], s49 offen sc1 lds
    s_add_u32 s63, s62, 2
    s_and_b32 s63, s63, 3
    s_lshl_b32 s63, s63, 13
    s_add_u32 s63, s63, 0
    buffer_load_dwordx4 v[116:119], v176, s[28:31], s63 offen sc1
    buffer_load_dwordx4 v[120:123], v177, s[28:31], s63 offen sc1
    buffer_load_dwordx4 v[124:127], v178, s[28:31], s63 offen sc1
    s_add_u32 m0, s51, 9216
    s_add_u32 s49, s62, 2
    s_and_b32 s49, s49, 3
    s_lshl_b32 s49, s49, 13
    s_add_u32 s49, s49, 0
    buffer_load_dword v179, s[28:31], s49 offen sc1 lds
    s_add_u32 s63, s62, 2
    s_and_b32 s63, s63, 3
    s_lshl_b32 s63, s63, 13
    s_add_u32 s63, s63, 1024
    buffer_load_dwordx4 v[128:131], v176, s[28:31], s63 offen sc1
    buffer_load_dwordx4 v[132:135], v177, s[28:31], s63 offen sc1
    buffer_load_dwordx4 v[136:139], v178, s[28:31], s63 offen sc1
    s_waitcnt vmcnt(19)
    s_add_u32 s16, s16, 4
    v_mov_b32 v187, 1
    s_mov_b64 exec, 1
    ds_add_rtn_u32 v187, v186, v187
    s_mov_b64 exec, -1
    s_waitcnt lgkmcnt(0)
    v_readfirstlane_b32 s17, v187
    s_nop 0
    s_add_u32 s17, s17, 1
    s_cmp_ge_u32 s17, s16
    s_cbranch_scc1 L_gb32_d
    s_mov_b32 s18, 0
L_gb32_l:
    ds_read_b32 v187, v186
    s_add_u32 s18, s18, 1
    s_cmp_ge_u32 s18, 0x200000
    s_cbranch_scc1 L_gb32_d
    s_waitcnt lgkmcnt(0)
    v_readfirstlane_b32 s17, v187
    s_nop 0
    s_cmp_ge_u32 s17, s16
    s_cbranch_scc0 L_gb32_l
L_gb32_d:
    ds_read_b64_tr_b16 a[0:1], v168 offset:32768
    ds_read_b64_tr_b16 a[2:3], v168 offset:36864
    s_waitcnt lgkmcnt(0)
    v_mfma_f32_16x16x32_bf16 v[0:3], a[0:3], v[152:155], v[0:3]
    ds_read_b64_tr_b16 a[4:5], v169 offset:32768
    ds_read_b64_tr_b16 a[6:7], v169 offset:36864
    ds_read_b64_tr_b16 a[8:9], v170 offset:32768
    v_mfma_f32_16x16x32_bf16 v[32:35], a[0:3], v[156:159], v[32:35]
    ds_read_b64_tr_b16 a[10:11], v170 offset:36864
    ds_read_b64_tr_b16 a[12:13], v171 offset:32768
    ds_read_b64_tr_b16 a[14:15], v171 offset:36864
    v_mfma_f32_16x16x32_bf16 v[64:67], a[0:3], v[160:163], v[64:67]
    ds_read_b64_tr_b16 a[16:17], v168 offset:33792
    ds_read_b64_tr_b16 a[18:19], v168 offset:37888
    ds_read_b64_tr_b16 a[20:21], v169 offset:33792
    s_waitcnt lgkmcnt(5)
    v_mfma_f32_16x16x32_bf16 v[4:7], a[4:7], v[152:155], v[4:7]
    ds_read_b64_tr_b16 a[22:23], v169 offset:37888
    ds_read_b64_tr_b16 a[24:25], v170 offset:33792
    ds_read_b64_tr_b16 a[26:27], v170 offset:37888
    v_mfma_f32_16x16x32_bf16 v[36:39], a[4:7], v[156:159], v[36:39]
    ds_read_b64_tr_b16 a[28:29], v171 offset:33792
    ds_read_b64_tr_b16 a[30:31], v171 offset:37888
    ds_read_b128 a[32:35], v185 offset:12288
    ds_read_b64_tr_b16 a[36:37], v172 offset:32768
    v_mfma_f32_16x16x32_bf16 v[68:71], a[4:7], v[160:163], v[68:71]
    ds_read_b64_tr_b16 a[38:39], v172 offset:36864
    ds_read_b64_tr_b16 a[0:1], v172 offset:33792
    ds_read_b64_tr_b16 a[2:3], v172 offset:37888
    s_add_u32 m0, s61, 16384
    v_mfma_f32_16x16x32_bf16 v[8:11], a[8:11], v[152:155], v[8:11]
    s_add_u32 s48, s62, 2
    s_and_b32 s48, s48, 3
    s_lshl_b32 s48, s48, 18
    s_add_u32 s48, s48, 65536
    v_mfma_f32_16x16x32_bf16 v[40:43], a[8:11], v[156:159], v[40:43]
    buffer_load_dwordx4 v180, s[32:35], s48 offen lds
    s_add_u32 m0, s61, 17280
    s_nop 0
    buffer_load_dwordx4 v180, s[32:35], s48 offen offset:128 lds
    s_add_u32 s63, s62, 2
    v_mfma_f32_16x16x32_bf16 v[72:75], a[8:11], v[160:163], v[72:75]
    s_and_b32 s63, s63, 3
    s_lshl_b32 s63, s63, 13
    s_add_u32 s63, s63, 2048
    buffer_load_dwordx4 v[140:143], v176, s[28:31], s63 offen sc1
    s_waitcnt lgkmcnt(11)
    v_mfma_f32_16x16x32_bf16 v[12:15], a[12:15], v[152:155], v[12:15]
    buffer_load_dwordx4 v[144:147], v177, s[28:31], s63 offen sc1
    buffer_load_dwordx4 v[148:151], v178, s[28:31], s63 offen sc1
    s_add_u32 m0, s51, 10240
    s_add_u32 s49, s62, 2
    v_mfma_f32_16x16x32_bf16 v[44:47], a[12:15], v[156:159], v[44:47]
    s_and_b32 s49, s49, 3
    s_lshl_b32 s49, s49, 13
    s_add_u32 s49, s49, 1024
    buffer_load_dword v179, s[28:31], s49 offen sc1 lds
    v_mfma_f32_16x16x32_bf16 v[76:79], a[12:15], v[160:163], v[76:79]
    v_mfma_f32_16x16x32_bf16 v[16:19], a[16:19], v[152:155], v[16:19]
    v_mfma_f32_16x16x32_bf16 v[48:51], a[16:19], v[156:159], v[48:51]
    v_mfma_f32_16x16x32_bf16 v[80:83], a[16:19], v[160:163], v[80:83]
    s_waitcnt lgkmcnt(7)
    v_mfma_f32_16x16x32_bf16 v[20:23], a[20:23], v[152:155], v[20:23]
    v_mfma_f32_16x16x32_bf16 v[52:55], a[20:23], v[156:159], v[52:55]
    v_mfma_f32_16x16x32_bf16 v[84:87], a[20:23], v[160:163], v[84:87]
    v_mfma_f32_16x16x32_bf16 v[24:27], a[24:27], v[152:155], v[24:27]
    v_mfma_f32_16x16x32_bf16 v[56:59], a[24:27], v[156:159], v[56:59]
    s_waitcnt vmcnt(21)
    s_add_u32 s16, s16, 4
    v_mov_b32 v187, 1
    s_mov_b64 exec, 1
    ds_add_rtn_u32 v187, v186, v187
    s_mov_b64 exec, -1
    s_waitcnt lgkmcnt(0)
    v_readfirstlane_b32 s17, v187
    s_nop 0
    s_add_u32 s17, s17, 1
    s_cmp_ge_u32 s17, s16
    s_cbranch_scc1 L_gb33_d
    s_mov_b32 s18, 0
L_gb33_l:
    ds_read_b32 v187, v186
    s_add_u32 s18, s18, 1
    s_cmp_ge_u32 s18, 0x200000
    s_cbranch_scc1 L_gb33_d
    s_waitcnt lgkmcnt(0)
    v_readfirstlane_b32 s17, v187
    s_nop 0
    s_cmp_ge_u32 s17, s16
    s_cbranch_scc0 L_gb33_l
L_gb33_d:
    v_mfma_f32_16x16x32_bf16 v[88:91], a[24:27], v[160:163], v[88:91]
    ds_read_b64_tr_b16 a[4:5], v168 offset:40960
    ds_read_b64_tr_b16 a[6:7], v168 offset:45056
    ds_read_b64_tr_b16 a[8:9], v169 offset:40960
    v_mfma_f32_16x16x32_bf16 v[28:31], a[28:31], v[152:155], v[28:31]
    ds_read_b64_tr_b16 a[10:11], v169 offset:45056
    ds_read_b64_tr_b16 a[12:13], v170 offset:40960
    ds_read_b64_tr_b16 a[14:15], v170 offset:45056
    v_mfma_f32_16x16x32_bf16 v[60:63], a[28:31], v[156:159], v[60:63]
    ds_read_b64_tr_b16 a[16:17], v171 offset:40960
    ds_read_b64_tr_b16 a[18:19], v171 offset:45056
    ds_read_b64_tr_b16 a[20:21], v168 offset:41984
    v_mfma_f32_16x16x32_bf16 v[92:95], a[28:31], v[160:163], v[92:95]
    ds_read_b64_tr_b16 a[22:23], v168 offset:46080
    ds_read_b64_tr_b16 a[24:25], v169 offset:41984
    ds_read_b64_tr_b16 a[26:27], v169 offset:46080
    v_mfma_f32_16x16x32_bf16 v[96:99], a[36:39], a[32:35], v[96:99]
    ds_read_b64_tr_b16 a[28:29], v170 offset:41984
    ds_read_b64_tr_b16 a[30:31], v170 offset:46080
    ds_read_b64_tr_b16 a[36:37], v171 offset:41984
    s_add_u32 m0, s61, 24576
    v_mfma_f32_16x16x32_bf16 v[100:103], a[0:3], a[32:35], v[100:103]
    ds_read_b64_tr_b16 a[38:39], v171 offset:46080
    ds_read_b128 a[0:3], v185 offset:13312
    ds_read_b64_tr_b16 a[32:33], v172 offset:40960
    s_add_u32 s48, s62, 2
    s_waitcnt lgkmcnt(14)
    v_mfma_f32_16x16x32_bf16 v[0:3], a[4:7], a[40:43], v[0:3]
    ds_read_b64_tr_b16 a[34:35], v172 offset:45056
    s_and_b32 s48, s48, 3
    s_lshl_b32 s48, s48, 18
    s_add_u32 s48, s48, 98304
    v_mfma_f32_16x16x32_bf16 v[32:35], a[4:7], a[44:47], v[32:35]
    buffer_load_dwordx4 v180, s[32:35], s48 offen lds
    s_add_u32 m0, s61, 25472
    s_nop 0
    buffer_load_dwordx4 v180, s[32:35], s48 offen offset:128 lds
    v_mfma_f32_16x16x32_bf16 v[64:67], a[4:7], a[48:51], v[64:67]
    ds_read_b64_tr_b16 a[4:5], v172 offset:41984
    ds_read_b64_tr_b16 a[6:7], v172 offset:46080
    s_add_u32 s63, s62, 2
    v_mfma_f32_16x16x32_bf16 v[4:7], a[8:11], a[40:43], v[4:7]
    s_and_b32 s63, s63, 3
    s_lshl_b32 s63, s63, 13
    s_add_u32 s63, s63, 3072
    v_mfma_f32_16x16x32_bf16 v[36:39], a[8:11], a[44:47], v[36:39]
    buffer_load_dwordx4 v[152:155], v176, s[28:31], s63 offen sc1
    buffer_load_dwordx4 v[156:159], v177, s[28:31], s63 offen sc1
    buffer_load_dwordx4 v[160:163], v178, s[28:31], s63 offen sc1
    v_mfma_f32_16x16x32_bf16 v[68:71], a[8:11], a[48:51], v[68:71]
    s_add_u32 m0, s51, 11264
    s_add_u32 s49, s62, 2
    s_and_b32 s49, s49, 3
    s_lshl_b32 s49, s49, 13
    s_waitcnt lgkmcnt(13)
    v_mfma_f32_16x16x32_bf16 v[8:11], a[12:15], a[40:43], v[8:11]
    s_add_u32 s49, s49, 2048
    buffer_load_dword v179, s[28:31], s49 offen sc1 lds
    v_mfma_f32_16x16x32_bf16 v[40:43], a[12:15], a[44:47], v[40:43]
    v_mfma_f32_16x16x32_bf16 v[72:75], a[12:15], a[48:51], v[72:75]
    v_mfma_f32_16x16x32_bf16 v[12:15], a[16:19], a[40:43], v[12:15]
    v_mfma_f32_16x16x32_bf16 v[44:47], a[16:19], a[44:47], v[44:47]
    v_mfma_f32_16x16x32_bf16 v[76:79], a[16:19], a[48:51], v[76:79]
    s_waitcnt lgkmcnt(9)
    v_mfma_f32_16x16x32_bf16 v[16:19], a[20:23], a[40:43], v[16:19]
    v_mfma_f32_16x16x32_bf16 v[48:51], a[20:23], a[44:47], v[48:51]
    v_mfma_f32_16x16x32_bf16 v[80:83], a[20:23], a[48:51], v[80:83]
    v_mfma_f32_16x16x32_bf16 v[20:23], a[24:27], a[40:43], v[20:23]
    v_mfma_f32_16x16x32_bf16 v[52:55], a[24:27], a[44:47], v[52:55]
    v_mfma_f32_16x16x32_bf16 v[84:87], a[24:27], a[48:51], v[84:87]
    s_waitcnt lgkmcnt(5)
    v_mfma_f32_16x16x32_bf16 v[24:27], a[28:31], a[40:43], v[24:27]
    v_mfma_f32_16x16x32_bf16 v[56:59], a[28:31], a[44:47], v[56:59]
    s_waitcnt vmcnt(23)
    s_add_u32 s16, s16, 4
    v_mov_b32 v187, 1
    s_mov_b64 exec, 1
    ds_add_rtn_u32 v187, v186, v187
    s_mov_b64 exec, -1
    s_waitcnt lgkmcnt(0)
    v_readfirstlane_b32 s17, v187
    s_nop 0
    s_add_u32 s17, s17, 1
    s_cmp_ge_u32 s17, s16
    s_cbranch_scc1 L_gb34_d
    s_mov_b32 s18, 0
L_gb34_l:
    ds_read_b32 v187, v186
    s_add_u32 s18, s18, 1
    s_cmp_ge_u32 s18, 0x200000
    s_cbranch_scc1 L_gb34_d
    s_waitcnt lgkmcnt(0)
    v_readfirstlane_b32 s17, v187
    s_nop 0
    s_cmp_ge_u32 s17, s16
    s_cbranch_scc0 L_gb34_l
L_gb34_d:
    v_mfma_f32_16x16x32_bf16 v[88:91], a[28:31], a[48:51], v[88:91]
    ds_read_b64_tr_b16 a[8:9], v168 offset:49152
    ds_read_b64_tr_b16 a[10:11], v168 offset:53248
    ds_read_b64_tr_b16 a[12:13], v169 offset:49152
    v_mfma_f32_16x16x32_bf16 v[28:31], a[36:39], a[40:43], v[28:31]
    ds_read_b64_tr_b16 a[14:15], v169 offset:53248
    ds_read_b64_tr_b16 a[16:17], v170 offset:49152
    ds_read_b64_tr_b16 a[18:19], v170 offset:53248
    v_mfma_f32_16x16x32_bf16 v[60:63], a[36:39], a[44:47], v[60:63]
    ds_read_b64_tr_b16 a[20:21], v171 offset:49152
    ds_read_b64_tr_b16 a[22:23], v171 offset:53248
    ds_read_b64_tr_b16 a[24:25], v168 offset:50176
    v_mfma_f32_16x16x32_bf16 v[92:95], a[36:39], a[48:51], v[92:95]
    ds_read_b64_tr_b16 a[26:27], v168 offset:54272
    ds_read_b64_tr_b16 a[28:29], v169 offset:50176
    ds_read_b64_tr_b16 a[30:31], v169 offset:54272
    v_mfma_f32_16x16x32_bf16 v[96:99], a[32:35], a[0:3], v[96:99]
    ds_read_b64_tr_b16 a[36:37], v170 offset:50176
    ds_read_b64_tr_b16 a[38:39], v170 offset:54272
    ds_read_b64_tr_b16 a[32:33], v171 offset:50176
    s_add_u32 m0, s61, 32768
    v_mfma_f32_16x16x32_bf16 v[100:103], a[4:7], a[0:3], v[100:103]
    ds_read_b64_tr_b16 a[34:35], v171 offset:54272
    ds_read_b128 a[0:3], v185 offset:14336
    ds_read_b64_tr_b16 a[4:5], v172 offset:49152
    s_add_u32 s48, s62, 3
    s_waitcnt lgkmcnt(14)
    v_mfma_f32_16x16x32_bf16 v[0:3], a[8:11], a[52:55], v[0:3]
    ds_read_b64_tr_b16 a[6:7], v172 offset:53248
    s_and_b32 s48, s48, 3
    s_lshl_b32 s48, s48, 18
    s_add_u32 s48, s48, 0
    v_mfma_f32_16x16x32_bf16 v[32:35], a[8:11], a[56:59], v[32:35]
    buffer_load_dwordx4 v180, s[32:35], s48 offen lds
    s_add_u32 m0, s61, 33664
    s_nop 0
    buffer_load_dwordx4 v180, s[32:35], s48 offen offset:128 lds
    v_mfma_f32_16x16x32_bf16 v[64:67], a[8:11], a[60:63], v[64:67]
    ds_read_b64_tr_b16 a[8:9], v172 offset:50176
    ds_read_b64_tr_b16 a[10:11], v172 offset:54272
    s_add_u32 s63, s62, 3
    v_mfma_f32_16x16x32_bf16 v[4:7], a[12:15], a[52:55], v[4:7]
    s_and_b32 s63, s63, 3
    s_lshl_b32 s63, s63, 13
    s_add_u32 s63, s63, 0
    v_mfma_f32_16x16x32_bf16 v[36:39], a[12:15], a[56:59], v[36:39]
    buffer_load_dwordx4 a[40:43], v176, s[28:31], s63 offen sc1
    buffer_load_dwordx4 a[44:47], v177, s[28:31], s63 offen sc1
    buffer_load_dwordx4 a[48:51], v178, s[28:31], s63 offen sc1
    v_mfma_f32_16x16x32_bf16 v[68:71], a[12:15], a[60:63], v[68:71]
    s_add_u32 m0, s51, 12288
    s_add_u32 s49, s62, 2
    s_and_b32 s49, s49, 3
    s_lshl_b32 s49, s49, 13
    s_waitcnt lgkmcnt(13)
    v_mfma_f32_16x16x32_bf16 v[8:11], a[16:19], a[52:55], v[8:11]
    s_add_u32 s49, s49, 3072
    buffer_load_dword v179, s[28:31], s49 offen sc1 lds
    v_mfma_f32_16x16x32_bf16 v[40:43], a[16:19], a[56:59], v[40:43]
    v_mfma_f32_16x16x32_bf16 v[72:75], a[16:19], a[60:63], v[72:75]
    v_mfma_f32_16x16x32_bf16 v[12:15], a[20:23], a[52:55], v[12:15]
    v_mfma_f32_16x16x32_bf16 v[44:47], a[20:23], a[56:59], v[44:47]
    v_mfma_f32_16x16x32_bf16 v[76:79], a[20:23], a[60:63], v[76:79]
    s_waitcnt lgkmcnt(9)
    v_mfma_f32_16x16x32_bf16 v[16:19], a[24:27], a[52:55], v[16:19]
    v_mfma_f32_16x16x32_bf16 v[48:51], a[24:27], a[56:59], v[48:51]
    v_mfma_f32_16x16x32_bf16 v[80:83], a[24:27], a[60:63], v[80:83]
    v_mfma_f32_16x16x32_bf16 v[20:23], a[28:31], a[52:55], v[20:23]
    v_mfma_f32_16x16x32_bf16 v[52:55], a[28:31], a[56:59], v[52:55]
    v_mfma_f32_16x16x32_bf16 v[84:87], a[28:31], a[60:63], v[84:87]
    s_waitcnt lgkmcnt(5)
    v_mfma_f32_16x16x32_bf16 v[24:27], a[36:39], a[52:55], v[24:27]
    v_mfma_f32_16x16x32_bf16 v[56:59], a[36:39], a[56:59], v[56:59]
    s_waitcnt vmcnt(25)
    s_add_u32 s16, s16, 4
    v_mov_b32 v187, 1
    s_mov_b64 exec, 1
    ds_add_rtn_u32 v187, v186, v187
    s_mov_b64 exec, -1
    s_waitcnt lgkmcnt(0)
    v_readfirstlane_b32 s17, v187
    s_nop 0
    s_add_u32 s17, s17, 1
    s_cmp_ge_u32 s17, s16
    s_cbranch_scc1 L_gb35_d
    s_mov_b32 s18, 0
L_gb35_l:
    ds_read_b32 v187, v186
    s_add_u32 s18, s18, 1
    s_cmp_ge_u32 s18, 0x200000
    s_cbranch_scc1 L_gb35_d
    s_waitcnt lgkmcnt(0)
    v_readfirstlane_b32 s17, v187
    s_nop 0
    s_cmp_ge_u32 s17, s16
    s_cbranch_scc0 L_gb35_l
L_gb35_d:
    v_mfma_f32_16x16x32_bf16 v[88:91], a[36:39], a[60:63], v[88:91]
    ds_read_b64_tr_b16 a[12:13], v168 offset:57344
    ds_read_b64_tr_b16 a[14:15], v168 offset:61440
    ds_read_b64_tr_b16 a[16:17], v169 offset:57344
    v_mfma_f32_16x16x32_bf16 v[28:31], a[32:35], a[52:55], v[28:31]
    ds_read_b64_tr_b16 a[18:19], v169 offset:61440
    ds_read_b64_tr_b16 a[20:21], v170 offset:57344
    ds_read_b64_tr_b16 a[22:23], v170 offset:61440
    v_mfma_f32_16x16x32_bf16 v[60:63], a[32:35], a[56:59], v[60:63]
    ds_read_b64_tr_b16 a[24:25], v171 offset:57344
    ds_read_b64_tr_b16 a[26:27], v171 offset:61440
    ds_read_b64_tr_b16 a[28:29], v168 offset:58368
    v_mfma_f32_16x16x32_bf16 v[92:95], a[32:35], a[60:63], v[92:95]
    ds_read_b64_tr_b16 a[30:31], v168 offset:62464
    ds_read_b64_tr_b16 a[36:37], v169 offset:58368
    ds_read_b64_tr_b16 a[38:39], v169 offset:62464
    v_mfma_f32_16x16x32_bf16 v[96:99], a[4:7], a[0:3], v[96:99]
    ds_read_b64_tr_b16 a[32:33], v170 offset:58368
    ds_read_b64_tr_b16 a[34:35], v170 offset:62464
    ds_read_b64_tr_b16 a[4:5], v171 offset:58368
    s_add_u32 m0, s61, 40960
    v_mfma_f32_16x16x32_bf16 v[100:103], a[8:11], a[0:3], v[100:103]
    ds_read_b64_tr_b16 a[6:7], v171 offset:62464
    ds_read_b128 a[0:3], v185 offset:8192
    ds_read_b64_tr_b16 a[8:9], v172 offset:57344
    s_add_u32 s48, s62, 3
    s_waitcnt lgkmcnt(14)
    v_mfma_f32_16x16x32_bf16 v[0:3], a[12:15], v[104:107], v[0:3]
    ds_read_b64_tr_b16 a[10:11], v172 offset:61440
    s_and_b32 s48, s48, 3
    s_lshl_b32 s48, s48, 18
    s_add_u32 s48, s48, 32768
    v_mfma_f32_16x16x32_bf16 v[32:35], a[12:15], v[108:111], v[32:35]
    buffer_load_dwordx4 v180, s[32:35], s48 offen lds
    s_add_u32 m0, s61, 41856
    s_nop 0
    buffer_load_dwordx4 v180, s[32:35], s48 offen offset:128 lds
    v_mfma_f32_16x16x32_bf16 v[64:67], a[12:15], v[112:115], v[64:67]
    ds_read_b64_tr_b16 a[12:13], v172 offset:58368
    ds_read_b64_tr_b16 a[14:15], v172 offset:62464
    s_add_u32 s63, s62, 3
    v_mfma_f32_16x16x32_bf16 v[4:7], a[16:19], v[104:107], v[4:7]
    s_and_b32 s63, s63, 3
    s_lshl_b32 s63, s63, 13
    s_add_u32 s63, s63, 1024
    v_mfma_f32_16x16x32_bf16 v[36:39], a[16:19], v[108:111], v[36:39]
    buffer_load_dwordx4 a[52:55], v176, s[28:31], s63 offen sc1
    buffer_load_dwordx4 a[56:59], v177, s[28:31], s63 offen sc1
    buffer_load_dwordx4 a[60:63], v178, s[28:31], s63 offen sc1
    v_mfma_f32_16x16x32_bf16 v[68:71], a[16:19], v[112:115], v[68:71]
    s_add_u32 m0, s51, 13312
    s_add_u32 s49, s62, 3
    s_and_b32 s49, s49, 3
    s_lshl_b32 s49, s49, 13
    s_waitcnt lgkmcnt(13)
    v_mfma_f32_16x16x32_bf16 v[8:11], a[20:23], v[104:107], v[8:11]
    s_add_u32 s49, s49, 0
    buffer_load_dword v179, s[28:31], s49 offen sc1 lds
    v_mfma_f32_16x16x32_bf16 v[40:43], a[20:23], v[108:111], v[40:43]
    v_mfma_f32_16x16x32_bf16 v[72:75], a[20:23], v[112:115], v[72:75]
    v_mfma_f32_16x16x32_bf16 v[12:15], a[24:27], v[104:107], v[12:15]
    v_mfma_f32_16x16x32_bf16 v[44:47], a[24:27], v[108:111], v[44:47]
    v_mfma_f32_16x16x32_bf16 v[76:79], a[24:27], v[112:115], v[76:79]
    s_waitcnt lgkmcnt(9)
    v_mfma_f32_16x16x32_bf16 v[16:19], a[28:31], v[104:107], v[16:19]
    v_mfma_f32_16x16x32_bf16 v[48:51], a[28:31], v[108:111], v[48:51]
    v_mfma_f32_16x16x32_bf16 v[80:83], a[28:31], v[112:115], v[80:83]
    v_mfma_f32_16x16x32_bf16 v[20:23], a[36:39], v[104:107], v[20:23]
    v_mfma_f32_16x16x32_bf16 v[52:55], a[36:39], v[108:111], v[52:55]
    v_mfma_f32_16x16x32_bf16 v[84:87], a[36:39], v[112:115], v[84:87]
    s_waitcnt lgkmcnt(5)
    v_mfma_f32_16x16x32_bf16 v[24:27], a[32:35], v[104:107], v[24:27]
    v_mfma_f32_16x16x32_bf16 v[56:59], a[32:35], v[108:111], v[56:59]
    s_waitcnt vmcnt(27)
    s_add_u32 s16, s16, 4
    v_mov_b32 v187, 1
    s_mov_b64 exec, 1
    ds_add_rtn_u32 v187, v186, v187
    s_mov_b64 exec, -1
    s_waitcnt lgkmcnt(0)
    v_readfirstlane_b32 s17, v187
    s_nop 0
    s_add_u32 s17, s17, 1
    s_cmp_ge_u32 s17, s16
    s_cbranch_scc1 L_gb36_d
    s_mov_b32 s18, 0
L_gb36_l:
    ds_read_b32 v187, v186
    s_add_u32 s18, s18, 1
    s_cmp_ge_u32 s18, 0x200000
    s_cbranch_scc1 L_gb36_d
    s_waitcnt lgkmcnt(0)
    v_readfirstlane_b32 s17, v187
    s_nop 0
    s_cmp_ge_u32 s17, s16
    s_cbranch_scc0 L_gb36_l
L_gb36_d:
    v_mfma_f32_16x16x32_bf16 v[88:91], a[32:35], v[112:115], v[88:91]
    ds_read_b64_tr_b16 a[16:17], v168 offset:0
    ds_read_b64_tr_b16 a[18:19], v168 offset:4096
    ds_read_b64_tr_b16 a[20:21], v169 offset:0
    v_mfma_f32_16x16x32_bf16 v[28:31], a[4:7], v[104:107], v[28:31]
    ds_read_b64_tr_b16 a[22:23], v169 offset:4096
    ds_read_b64_tr_b16 a[24:25], v170 offset:0
    ds_read_b64_tr_b16 a[26:27], v170 offset:4096
    v_mfma_f32_16x16x32_bf16 v[60:63], a[4:7], v[108:111], v[60:63]
    ds_read_b64_tr_b16 a[28:29], v171 offset:0
    ds_read_b64_tr_b16 a[30:31], v171 offset:4096
    ds_read_b64_tr_b16 a[36:37], v168 offset:1024
    v_mfma_f32_16x16x32_bf16 v[92:95], a[4:7], v[112:115], v[92:95]
    ds_read_b64_tr_b16 a[38:39], v168 offset:5120
    ds_read_b64_tr_b16 a[32:33], v169 offset:1024
    ds_read_b64_tr_b16 a[34:35], v169 offset:5120
    v_mfma_f32_16x16x32_bf16 v[96:99], a[8:11], a[0:3], v[96:99]
    ds_read_b64_tr_b16 a[4:5], v170 offset:1024
    ds_read_b64_tr_b16 a[6:7], v170 offset:5120
    ds_read_b64_tr_b16 a[8:9], v171 offset:1024
    s_add_u32 m0, s61, 49152
    v_mfma_f32_16x16x32_bf16 v[100:103], a[12:15], a[0:3], v[100:103]
    ds_read_b64_tr_b16 a[10:11], v171 offset:5120
    ds_read_b128 a[0:3], v185 offset:9216
    ds_read_b64_tr_b16 a[12:13], v172 offset:0
    s_add_u32 s48, s62, 3
    s_waitcnt lgkmcnt(14)
    v_mfma_f32_16x16x32_bf16 v[0:3], a[16:19], v[116:119], v[0:3]
    ds_read_b64_tr_b16 a[14:15], v172 offset:4096
    s_and_b32 s48, s48, 3
    s_lshl_b32 s48, s48, 18
    s_add_u32 s48, s48, 65536
    v_mfma_f32_16x16x32_bf16 v[32:35], a[16:19], v[120:123], v[32:35]
    buffer_load_dwordx4 v180, s[32:35], s48 offen lds
    s_add_u32 m0, s61, 50048
    s_nop 0
    buffer_load_dwordx4 v180, s[32:35], s48 offen offset:128 lds
    v_mfma_f32_16x16x32_bf16 v[64:67], a[16:19], v[124:127], v[64:67]
    ds_read_b64_tr_b16 a[16:17], v172 offset:1024
    ds_read_b64_tr_b16 a[18:19], v172 offset:5120
    s_add_u32 s63, s62, 3
    v_mfma_f32_16x16x32_bf16 v[4:7], a[20:23], v[116:119], v[4:7]
    s_and_b32 s63, s63, 3
    s_lshl_b32 s63, s63, 13
    s_add_u32 s63, s63, 2048
    v_mfma_f32_16x16x32_bf16 v[36:39], a[20:23], v[120:123], v[36:39]
    buffer_load_dwordx4 v[104:107], v176, s[28:31], s63 offen sc1
    buffer_load_dwordx4 v[108:111], v177, s[28:31], s63 offen sc1
    buffer_load_dwordx4 v[112:115], v178, s[28:31], s63 offen sc1
    v_mfma_f32_16x16x32_bf16 v[68:71], a[20:23], v[124:127], v[68:71]
    s_add_u32 m0, s51, 14336
    s_add_u32 s49, s62, 3
    s_and_b32 s49, s49, 3
    s_lshl_b32 s49, s49, 13
    s_waitcnt lgkmcnt(13)
    v_mfma_f32_16x16x32_bf16 v[8:11], a[24:27], v[116:119], v[8:11]
    s_add_u32 s49, s49, 1024
    buffer_load_dword v179, s[28:31], s49 offen sc1 lds
    v_mfma_f32_16x16x32_bf16 v[40:43], a[24:27], v[120:123], v[40:43]
    v_mfma_f32_16x16x32_bf16 v[72:75], a[24:27], v[124:127], v[72:75]
    v_mfma_f32_16x16x32_bf16 v[12:15], a[28:31], v[116:119], v[12:15]
    v_mfma_f32_16x16x32_bf16 v[44:47], a[28:31], v[120:123], v[44:47]
    v_mfma_f32_16x16x32_bf16 v[76:79], a[28:31], v[124:127], v[76:79]
    s_waitcnt lgkmcnt(9)
    v_mfma_f32_16x16x32_bf16 v[16:19], a[36:39], v[116:119], v[16:19]
    v_mfma_f32_16x16x32_bf16 v[48:51], a[36:39], v[120:123], v[48:51]
    v_mfma_f32_16x16x32_bf16 v[80:83], a[36:39], v[124:127], v[80:83]
    v_mfma_f32_16x16x32_bf16 v[20:23], a[32:35], v[116:119], v[20:23]
    v_mfma_f32_16x16x32_bf16 v[52:55], a[32:35], v[120:123], v[52:55]
    v_mfma_f32_16x16x32_bf16 v[84:87], a[32:35], v[124:127], v[84:87]
    s_waitcnt lgkmcnt(5)
    v_mfma_f32_16x16x32_bf16 v[24:27], a[4:7], v[116:119], v[24:27]
    v_mfma_f32_16x16x32_bf16 v[56:59], a[4:7], v[120:123], v[56:59]
    s_waitcnt vmcnt(24)
    s_add_u32 s16, s16, 4
    v_mov_b32 v187, 1
    s_mov_b64 exec, 1
    ds_add_rtn_u32 v187, v186, v187
    s_mov_b64 exec, -1
    s_waitcnt lgkmcnt(0)
    v_readfirstlane_b32 s17, v187
    s_nop 0
    s_add_u32 s17, s17, 1
    s_cmp_ge_u32 s17, s16
    s_cbranch_scc1 L_gb37_d
    s_mov_b32 s18, 0
L_gb37_l:
    ds_read_b32 v187, v186
    s_add_u32 s18, s18, 1
    s_cmp_ge_u32 s18, 0x200000
    s_cbranch_scc1 L_gb37_d
    s_waitcnt lgkmcnt(0)
    v_readfirstlane_b32 s17, v187
    s_nop 0
    s_cmp_ge_u32 s17, s16
    s_cbranch_scc0 L_gb37_l
L_gb37_d:
    v_mfma_f32_16x16x32_bf16 v[88:91], a[4:7], v[124:127], v[88:91]
    ds_read_b64_tr_b16 a[20:21], v168 offset:8192
    ds_read_b64_tr_b16 a[22:23], v168 offset:12288
    ds_read_b64_tr_b16 a[24:25], v169 offset:8192
    v_mfma_f32_16x16x32_bf16 v[28:31], a[8:11], v[116:119], v[28:31]
    ds_read_b64_tr_b16 a[26:27], v169 offset:12288
    ds_read_b64_tr_b16 a[28:29], v170 offset:8192
    ds_read_b64_tr_b16 a[30:31], v170 offset:12288
    v_mfma_f32_16x16x32_bf16 v[60:63], a[8:11], v[120:123], v[60:63]
    ds_read_b64_tr_b16 a[36:37], v171 offset:8192
    ds_read_b64_tr_b16 a[38:39], v171 offset:12288
    ds_read_b64_tr_b16 a[32:33], v168 offset:9216
    v_mfma_f32_16x16x32_bf16 v[92:95], a[8:11], v[124:127], v[92:95]
    ds_read_b64_tr_b16 a[34:35], v168 offset:13312
    ds_read_b64_tr_b16 a[4:5], v169 offset:9216
    ds_read_b64_tr_b16 a[6:7], v169 offset:13312
    v_mfma_f32_16x16x32_bf16 v[96:99], a[12:15], a[0:3], v[96:99]
    ds_read_b64_tr_b16 a[8:9], v170 offset:9216
    ds_read_b64_tr_b16 a[10:11], v170 offset:13312
    ds_read_b64_tr_b16 a[12:13], v171 offset:9216
    s_add_u32 m0, s61, 57344
    v_mfma_f32_16x16x32_bf16 v[100:103], a[16:19], a[0:3], v[100:103]
    ds_read_b64_tr_b16 a[14:15], v171 offset:13312
    ds_read_b128 a[0:3], v185 offset:10240
    ds_read_b64_tr_b16 a[16:17], v172 offset:8192
    s_add_u32 s48, s62, 3
    s_waitcnt lgkmcnt(14)
    v_mfma_f32_16x16x32_bf16 v[0:3], a[20:23], v[128:131], v[0:3]
    ds_read_b64_tr_b16 a[18:19], v172 offset:12288
    s_and_b32 s48, s48, 3
    s_lshl_b32 s48, s48, 18
    s_add_u32 s48, s48, 98304
    v_mfma_f32_16x16x32_bf16 v[32:35], a[20:23], v[132:135], v[32:35]
    buffer_load_dwordx4 v180, s[32:35], s48 offen lds
    s_add_u32 m0, s61, 58240
    s_nop 0
    buffer_load_dwordx4 v180, s[32:35], s48 offen offset:128 lds
    v_mfma_f32_16x16x32_bf16 v[64:67], a[20:23], v[136:139], v[64:67]
    ds_read_b64_tr_b16 a[20:21], v172 offset:9216
    ds_read_b64_tr_b16 a[22:23], v172 offset:13312
    s_add_u32 s63, s62, 3
    v_mfma_f32_16x16x32_bf16 v[4:7], a[24:27], v[128:131], v[4:7]
    s_and_b32 s63, s63, 3
    s_lshl_b32 s63, s63, 13
    s_add_u32 s63, s63, 3072
    v_mfma_f32_16x16x32_bf16 v[36:39], a[24:27], v[132:135], v[36:39]
    buffer_load_dwordx4 v[116:119], v176, s[28:31], s63 offen sc1
    buffer_load_dwordx4 v[120:123], v177, s[28:31], s63 offen sc1
    buffer_load_dwordx4 v[124:127], v178, s[28:31], s63 offen sc1
    v_mfma_f32_16x16x32_bf16 v[68:71], a[24:27], v[136:139], v[68:71]
    s_add_u32 m0, s51, 8192
    s_add_u32 s49, s62, 3
    s_and_b32 s49, s49, 3
    s_lshl_b32 s49, s49, 13
    s_waitcnt lgkmcnt(13)
    v_mfma_f32_16x16x32_bf16 v[8:11], a[28:31], v[128:131], v[8:11]
    s_add_u32 s49, s49, 2048
    buffer_load_dword v179, s[28:31], s49 offen sc1 lds
    v_mfma_f32_16x16x32_bf16 v[40:43], a[28:31], v[132:135], v[40:43]
    v_mfma_f32_16x16x32_bf16 v[72:75], a[28:31], v[136:139], v[72:75]
    v_mfma_f32_16x16x32_bf16 v[12:15], a[36:39], v[128:131], v[12:15]
    v_mfma_f32_16x16x32_bf16 v[44:47], a[36:39], v[132:135], v[44:47]
    v_mfma_f32_16x16x32_bf16 v[76:79], a[36:39], v[136:139], v[76:79]
    s_waitcnt lgkmcnt(9)
    v_mfma_f32_16x16x32_bf16 v[16:19], a[32:35], v[128:131], v[16:19]
    v_mfma_f32_16x16x32_bf16 v[48:51], a[32:35], v[132:135], v[48:51]
    v_mfma_f32_16x16x32_bf16 v[80:83], a[32:35], v[136:139], v[80:83]
    v_mfma_f32_16x16x32_bf16 v[20:23], a[4:7], v[128:131], v[20:23]
    v_mfma_f32_16x16x32_bf16 v[52:55], a[4:7], v[132:135], v[52:55]
    v_mfma_f32_16x16x32_bf16 v[84:87], a[4:7], v[136:139], v[84:87]
    s_waitcnt lgkmcnt(5)
    v_mfma_f32_16x16x32_bf16 v[24:27], a[8:11], v[128:131], v[24:27]
    v_mfma_f32_16x16x32_bf16 v[56:59], a[8:11], v[132:135], v[56:59]
    s_waitcnt vmcnt(24)
    s_add_u32 s16, s16, 4
    v_mov_b32 v187, 1
    s_mov_b64 exec, 1
    ds_add_rtn_u32 v187, v186, v187
    s_mov_b64 exec, -1
    s_waitcnt lgkmcnt(0)
    v_readfirstlane_b32 s17, v187
    s_nop 0
    s_add_u32 s17, s17, 1
    s_cmp_ge_u32 s17, s16
    s_cbranch_scc1 L_gb38_d
    s_mov_b32 s18, 0
L_gb38_l:
    ds_read_b32 v187, v186
    s_add_u32 s18, s18, 1
    s_cmp_ge_u32 s18, 0x200000
    s_cbranch_scc1 L_gb38_d
    s_waitcnt lgkmcnt(0)
    v_readfirstlane_b32 s17, v187
    s_nop 0
    s_cmp_ge_u32 s17, s16
    s_cbranch_scc0 L_gb38_l
L_gb38_d:
    v_mfma_f32_16x16x32_bf16 v[88:91], a[8:11], v[136:139], v[88:91]
    ds_read_b64_tr_b16 a[24:25], v168 offset:16384
    ds_read_b64_tr_b16 a[26:27], v168 offset:20480
    ds_read_b64_tr_b16 a[28:29], v169 offset:16384
    v_mfma_f32_16x16x32_bf16 v[28:31], a[12:15], v[128:131], v[28:31]
    ds_read_b64_tr_b16 a[30:31], v169 offset:20480
    ds_read_b64_tr_b16 a[36:37], v170 offset:16384
    ds_read_b64_tr_b16 a[38:39], v170 offset:20480
    v_mfma_f32_16x16x32_bf16 v[60:63], a[12:15], v[132:135], v[60:63]
    ds_read_b64_tr_b16 a[32:33], v171 offset:16384
    ds_read_b64_tr_b16 a[34:35], v171 offset:20480
    ds_read_b64_tr_b16 a[4:5], v168 offset:17408
    v_mfma_f32_16x16x32_bf16 v[92:95], a[12:15], v[136:139], v[92:95]
    ds_read_b64_tr_b16 a[6:7], v168 offset:21504
    ds_read_b64_tr_b16 a[8:9], v169 offset:17408
    ds_read_b64_tr_b16 a[10:11], v169 offset:21504
    v_mfma_f32_16x16x32_bf16 v[96:99], a[16:19], a[0:3], v[96:99]
    ds_read_b64_tr_b16 a[12:13], v170 offset:17408
    ds_read_b64_tr_b16 a[14:15], v170 offset:21504
    ds_read_b64_tr_b16 a[16:17], v171 offset:17408
    v_mfma_f32_16x16x32_bf16 v[100:103], a[20:23], a[0:3], v[100:103]
    ds_read_b64_tr_b16 a[18:19], v171 offset:21504
    ds_read_b128 a[0:3], v185 offset:11264
    ds_read_b64_tr_b16 a[20:21], v172 offset:16384
    s_waitcnt lgkmcnt(14)
    v_mfma_f32_16x16x32_bf16 v[0:3], a[24:27], v[140:143], v[0:3]
    ds_read_b64_tr_b16 a[22:23], v172 offset:20480
    v_mfma_f32_16x16x32_bf16 v[32:35], a[24:27], v[144:147], v[32:35]
    s_add_u32 m0, s51, 9216
    s_add_u32 s49, s62, 3
    s_and_b32 s49, s49, 3
    v_mfma_f32_16x16x32_bf16 v[64:67], a[24:27], v[148:151], v[64:67]
    ds_read_b64_tr_b16 a[24:25], v172 offset:17408
    ds_read_b64_tr_b16 a[26:27], v172 offset:21504
    s_lshl_b32 s49, s49, 13
    v_mfma_f32_16x16x32_bf16 v[4:7], a[28:31], v[140:143], v[4:7]
    s_add_u32 s49, s49, 3072
    buffer_load_dword v179, s[28:31], s49 offen sc1 lds
    v_mfma_f32_16x16x32_bf16 v[36:39], a[28:31], v[144:147], v[36:39]
    v_mfma_f32_16x16x32_bf16 v[68:71], a[28:31], v[148:151], v[68:71]
    s_waitcnt lgkmcnt(13)
    v_mfma_f32_16x16x32_bf16 v[8:11], a[36:39], v[140:143], v[8:11]
    v_mfma_f32_16x16x32_bf16 v[40:43], a[36:39], v[144:147], v[40:43]
    v_mfma_f32_16x16x32_bf16 v[72:75], a[36:39], v[148:151], v[72:75]
    v_mfma_f32_16x16x32_bf16 v[12:15], a[32:35], v[140:143], v[12:15]
    v_mfma_f32_16x16x32_bf16 v[44:47], a[32:35], v[144:147], v[44:47]
    v_mfma_f32_16x16x32_bf16 v[76:79], a[32:35], v[148:151], v[76:79]
    s_waitcnt lgkmcnt(9)
    v_mfma_f32_16x16x32_bf16 v[16:19], a[4:7], v[140:143], v[16:19]
    v_mfma_f32_16x16x32_bf16 v[48:51], a[4:7], v[144:147], v[48:51]
    v_mfma_f32_16x16x32_bf16 v[80:83], a[4:7], v[148:151], v[80:83]
    v_mfma_f32_16x16x32_bf16 v[20:23], a[8:11], v[140:143], v[20:23]
    v_mfma_f32_16x16x32_bf16 v[52:55], a[8:11], v[144:147], v[52:55]
    v_mfma_f32_16x16x32_bf16 v[84:87], a[8:11], v[148:151], v[84:87]
    s_waitcnt lgkmcnt(5)
    v_mfma_f32_16x16x32_bf16 v[24:27], a[12:15], v[140:143], v[24:27]
    v_mfma_f32_16x16x32_bf16 v[56:59], a[12:15], v[144:147], v[56:59]
    s_waitcnt vmcnt(19)
    s_add_u32 s16, s16, 4
    v_mov_b32 v187, 1
    s_mov_b64 exec, 1
    ds_add_rtn_u32 v187, v186, v187
    s_mov_b64 exec, -1
    s_waitcnt lgkmcnt(0)
    v_readfirstlane_b32 s17, v187
    s_nop 0
    s_add_u32 s17, s17, 1
    s_cmp_ge_u32 s17, s16
    s_cbranch_scc1 L_gb39_d
    s_mov_b32 s18, 0
L_gb39_l:
    ds_read_b32 v187, v186
    s_add_u32 s18, s18, 1
    s_cmp_ge_u32 s18, 0x200000
    s_cbranch_scc1 L_gb39_d
    s_waitcnt lgkmcnt(0)
    v_readfirstlane_b32 s17, v187
    s_nop 0
    s_cmp_ge_u32 s17, s16
    s_cbranch_scc0 L_gb39_l
L_gb39_d:
    v_mfma_f32_16x16x32_bf16 v[88:91], a[12:15], v[148:151], v[88:91]
    ds_read_b64_tr_b16 a[28:29], v168 offset:24576
    ds_read_b64_tr_b16 a[30:31], v168 offset:28672
    ds_read_b64_tr_b16 a[36:37], v169 offset:24576
    v_mfma_f32_16x16x32_bf16 v[28:31], a[16:19], v[140:143], v[28:31]
    ds_read_b64_tr_b16 a[38:39], v169 offset:28672
    ds_read_b64_tr_b16 a[32:33], v170 offset:24576
    ds_read_b64_tr_b16 a[34:35], v170 offset:28672
    v_mfma_f32_16x16x32_bf16 v[60:63], a[16:19], v[144:147], v[60:63]
    ds_read_b64_tr_b16 a[4:5], v171 offset:24576
    ds_read_b64_tr_b16 a[6:7], v171 offset:28672
    ds_read_b64_tr_b16 a[8:9], v168 offset:25600
    v_mfma_f32_16x16x32_bf16 v[92:95], a[16:19], v[148:151], v[92:95]
    ds_read_b64_tr_b16 a[10:11], v168 offset:29696
    ds_read_b64_tr_b16 a[12:13], v169 offset:25600
    ds_read_b64_tr_b16 a[14:15], v169 offset:29696
    v_mfma_f32_16x16x32_bf16 v[96:99], a[20:23], a[0:3], v[96:99]
    ds_read_b64_tr_b16 a[16:17], v170 offset:25600
    ds_read_b64_tr_b16 a[18:19], v170 offset:29696
    ds_read_b64_tr_b16 a[20:21], v171 offset:25600
    v_mfma_f32_16x16x32_bf16 v[100:103], a[24:27], a[0:3], v[100:103]
    ds_read_b64_tr_b16 a[22:23], v171 offset:29696
    ds_read_b128 a[0:3], v185 offset:12288
    ds_read_b64_tr_b16 a[24:25], v172 offset:24576
    s_waitcnt lgkmcnt(14)
    v_mfma_f32_16x16x32_bf16 v[0:3], a[28:31], v[152:155], v[0:3]
    ds_read_b64_tr_b16 a[26:27], v172 offset:28672
    v_mfma_f32_16x16x32_bf16 v[32:35], a[28:31], v[156:159], v[32:35]
    v_mfma_f32_16x16x32_bf16 v[64:67], a[28:31], v[160:163], v[64:67]
    ds_read_b64_tr_b16 a[28:29], v172 offset:25600
    ds_read_b64_tr_b16 a[30:31], v172 offset:29696
    v_mfma_f32_16x16x32_bf16 v[4:7], a[36:39], v[152:155], v[4:7]
    v_mfma_f32_16x16x32_bf16 v[36:39], a[36:39], v[156:159], v[36:39]
    v_mfma_f32_16x16x32_bf16 v[68:71], a[36:39], v[160:163], v[68:71]
    s_waitcnt lgkmcnt(13)
    v_mfma_f32_16x16x32_bf16 v[8:11], a[32:35], v[152:155], v[8:11]
    v_mfma_f32_16x16x32_bf16 v[40:43], a[32:35], v[156:159], v[40:43]
    v_mfma_f32_16x16x32_bf16 v[72:75], a[32:35], v[160:163], v[72:75]
    v_mfma_f32_16x16x32_bf16 v[12:15], a[4:7], v[152:155], v[12:15]
    v_mfma_f32_16x16x32_bf16 v[44:47], a[4:7], v[156:159], v[44:47]
    v_mfma_f32_16x16x32_bf16 v[76:79], a[4:7], v[160:163], v[76:79]
    s_waitcnt lgkmcnt(9)
    v_mfma_f32_16x16x32_bf16 v[16:19], a[8:11], v[152:155], v[16:19]
    v_mfma_f32_16x16x32_bf16 v[48:51], a[8:11], v[156:159], v[48:51]
    v_mfma_f32_16x16x32_bf16 v[80:83], a[8:11], v[160:163], v[80:83]
    v_mfma_f32_16x16x32_bf16 v[20:23], a[12:15], v[152:155], v[20:23]
    v_mfma_f32_16x16x32_bf16 v[52:55], a[12:15], v[156:159], v[52:55]
    v_mfma_f32_16x16x32_bf16 v[84:87], a[12:15], v[160:163], v[84:87]
    s_waitcnt lgkmcnt(5)
    v_mfma_f32_16x16x32_bf16 v[24:27], a[16:19], v[152:155], v[24:27]
    v_mfma_f32_16x16x32_bf16 v[56:59], a[16:19], v[156:159], v[56:59]
    s_waitcnt vmcnt(13)
    s_add_u32 s16, s16, 4
    v_mov_b32 v187, 1
    s_mov_b64 exec, 1
    ds_add_rtn_u32 v187, v186, v187
    s_mov_b64 exec, -1
    s_waitcnt lgkmcnt(0)
    v_readfirstlane_b32 s17, v187
    s_nop 0
    s_add_u32 s17, s17, 1
    s_cmp_ge_u32 s17, s16
    s_cbranch_scc1 L_gb40_d
    s_mov_b32 s18, 0
L_gb40_l:
    ds_read_b32 v187, v186
    s_add_u32 s18, s18, 1
    s_cmp_ge_u32 s18, 0x200000
    s_cbranch_scc1 L_gb40_d
    s_waitcnt lgkmcnt(0)
    v_readfirstlane_b32 s17, v187
    s_nop 0
    s_cmp_ge_u32 s17, s16
    s_cbranch_scc0 L_gb40_l
L_gb40_d:
    v_mfma_f32_16x16x32_bf16 v[88:91], a[16:19], v[160:163], v[88:91]
    ds_read_b64_tr_b16 a[36:37], v168 offset:32768
    ds_read_b64_tr_b16 a[38:39], v168 offset:36864
    ds_read_b64_tr_b16 a[32:33], v169 offset:32768
    v_mfma_f32_16x16x32_bf16 v[28:31], a[20:23], v[152:155], v[28:31]
    ds_read_b64_tr_b16 a[34:35], v169 offset:36864
    ds_read_b64_tr_b16 a[4:5], v170 offset:32768
    ds_read_b64_tr_b16 a[6:7], v170 offset:36864
    v_mfma_f32_16x16x32_bf16 v[60:63], a[20:23], v[156:159], v[60:63]
    ds_read_b64_tr_b16 a[8:9], v171 offset:32768
    ds_read_b64_tr_b16 a[10:11], v171 offset:36864
    ds_read_b64_tr_b16 a[12:13], v168 offset:33792
    v_mfma_f32_16x16x32_bf16 v[92:95], a[20:23], v[160:163], v[92:95]
    ds_read_b64_tr_b16 a[14:15], v168 offset:37888
    ds_read_b64_tr_b16 a[16:17], v169 offset:33792
    ds_read_b64_tr_b16 a[18:19], v169 offset:37888
    v_mfma_f32_16x16x32_bf16 v[96:99], a[24:27], a[0:3], v[96:99]
    ds_read_b64_tr_b16 a[20:21], v170 offset:33792
    ds_read_b64_tr_b16 a[22:23], v170 offset:37888
    ds_read_b64_tr_b16 a[24:25], v171 offset:33792
    v_mfma_f32_16x16x32_bf16 v[100:103], a[28:31], a[0:3], v[100:103]
    ds_read_b64_tr_b16 a[26:27], v171 offset:37888
    ds_read_b128 a[0:3], v185 offset:13312
    ds_read_b64_tr_b16 a[28:29], v172 offset:32768
    s_waitcnt lgkmcnt(14)
    v_mfma_f32_16x16x32_bf16 v[0:3], a[36:39], a[40:43], v[0:3]
    ds_read_b64_tr_b16 a[30:31], v172 offset:36864
    v_mfma_f32_16x16x32_bf16 v[32:35], a[36:39], a[44:47], v[32:35]
    v_mfma_f32_16x16x32_bf16 v[64:67], a[36:39], a[48:51], v[64:67]
    ds_read_b64_tr_b16 a[36:37], v172 offset:33792
    ds_read_b64_tr_b16 a[38:39], v172 offset:37888
    v_mfma_f32_16x16x32_bf16 v[4:7], a[32:35], a[40:43], v[4:7]
    v_mfma_f32_16x16x32_bf16 v[36:39], a[32:35], a[44:47], v[36:39]
    v_mfma_f32_16x16x32_bf16 v[68:71], a[32:35], a[48:51], v[68:71]
    s_waitcnt lgkmcnt(13)
    v_mfma_f32_16x16x32_bf16 v[8:11], a[4:7], a[40:43], v[8:11]
    v_mfma_f32_16x16x32_bf16 v[40:43], a[4:7], a[44:47], v[40:43]
    v_mfma_f32_16x16x32_bf16 v[72:75], a[4:7], a[48:51], v[72:75]
    v_mfma_f32_16x16x32_bf16 v[12:15], a[8:11], a[40:43], v[12:15]
    v_mfma_f32_16x16x32_bf16 v[44:47], a[8:11], a[44:47], v[44:47]
    v_mfma_f32_16x16x32_bf16 v[76:79], a[8:11], a[48:51], v[76:79]
    s_waitcnt lgkmcnt(9)
    v_mfma_f32_16x16x32_bf16 v[16:19], a[12:15], a[40:43], v[16:19]
    v_mfma_f32_16x16x32_bf16 v[48:51], a[12:15], a[44:47], v[48:51]
    v_mfma_f32_16x16x32_bf16 v[80:83], a[12:15], a[48:51], v[80:83]
    v_mfma_f32_16x16x32_bf16 v[20:23], a[16:19], a[40:43], v[20:23]
    v_mfma_f32_16x16x32_bf16 v[52:55], a[16:19], a[44:47], v[52:55]
    v_mfma_f32_16x16x32_bf16 v[84:87], a[16:19], a[48:51], v[84:87]
    s_waitcnt lgkmcnt(5)
    v_mfma_f32_16x16x32_bf16 v[24:27], a[20:23], a[40:43], v[24:27]
    v_mfma_f32_16x16x32_bf16 v[56:59], a[20:23], a[44:47], v[56:59]
    s_waitcnt vmcnt(7)
    s_add_u32 s16, s16, 4
    v_mov_b32 v187, 1
    s_mov_b64 exec, 1
    ds_add_rtn_u32 v187, v186, v187
    s_mov_b64 exec, -1
    s_waitcnt lgkmcnt(0)
    v_readfirstlane_b32 s17, v187
    s_nop 0
    s_add_u32 s17, s17, 1
    s_cmp_ge_u32 s17, s16
    s_cbranch_scc1 L_gb41_d
    s_mov_b32 s18, 0
L_gb41_l:
    ds_read_b32 v187, v186
    s_add_u32 s18, s18, 1
    s_cmp_ge_u32 s18, 0x200000
    s_cbranch_scc1 L_gb41_d
    s_waitcnt lgkmcnt(0)
    v_readfirstlane_b32 s17, v187
    s_nop 0
    s_cmp_ge_u32 s17, s16
    s_cbranch_scc0 L_gb41_l
L_gb41_d:
    v_mfma_f32_16x16x32_bf16 v[88:91], a[20:23], a[48:51], v[88:91]
    ds_read_b64_tr_b16 a[32:33], v168 offset:40960
    ds_read_b64_tr_b16 a[34:35], v168 offset:45056
    ds_read_b64_tr_b16 a[4:5], v169 offset:40960
    v_mfma_f32_16x16x32_bf16 v[28:31], a[24:27], a[40:43], v[28:31]
    ds_read_b64_tr_b16 a[6:7], v169 offset:45056
    ds_read_b64_tr_b16 a[8:9], v170 offset:40960
    ds_read_b64_tr_b16 a[10:11], v170 offset:45056
    v_mfma_f32_16x16x32_bf16 v[60:63], a[24:27], a[44:47], v[60:63]
    ds_read_b64_tr_b16 a[12:13], v171 offset:40960
    ds_read_b64_tr_b16 a[14:15], v171 offset:45056
    ds_read_b64_tr_b16 a[16:17], v168 offset:41984
    v_mfma_f32_16x16x32_bf16 v[92:95], a[24:27], a[48:51], v[92:95]
    ds_read_b64_tr_b16 a[18:19], v168 offset:46080
    ds_read_b64_tr_b16 a[20:21], v169 offset:41984
    ds_read_b64_tr_b16 a[22:23], v169 offset:46080
    v_mfma_f32_16x16x32_bf16 v[96:99], a[28:31], a[0:3], v[96:99]
    ds_read_b64_tr_b16 a[24:25], v170 offset:41984
    ds_read_b64_tr_b16 a[26:27], v170 offset:46080
    ds_read_b64_tr_b16 a[28:29], v171 offset:41984
    v_mfma_f32_16x16x32_bf16 v[100:103], a[36:39], a[0:3], v[100:103]
    ds_read_b64_tr_b16 a[30:31], v171 offset:46080
    ds_read_b128 a[0:3], v185 offset:14336
    ds_read_b64_tr_b16 a[36:37], v172 offset:40960
    s_waitcnt lgkmcnt(14)
    v_mfma_f32_16x16x32_bf16 v[0:3], a[32:35], a[52:55], v[0:3]
    ds_read_b64_tr_b16 a[38:39], v172 offset:45056
    v_mfma_f32_16x16x32_bf16 v[32:35], a[32:35], a[56:59], v[32:35]
    v_mfma_f32_16x16x32_bf16 v[64:67], a[32:35], a[60:63], v[64:67]
    ds_read_b64_tr_b16 a[32:33], v172 offset:41984
    ds_read_b64_tr_b16 a[34:35], v172 offset:46080
    v_mfma_f32_16x16x32_bf16 v[4:7], a[4:7], a[52:55], v[4:7]
    v_mfma_f32_16x16x32_bf16 v[36:39], a[4:7], a[56:59], v[36:39]
    v_mfma_f32_16x16x32_bf16 v[68:71], a[4:7], a[60:63], v[68:71]
    s_waitcnt lgkmcnt(13)
    v_mfma_f32_16x16x32_bf16 v[8:11], a[8:11], a[52:55], v[8:11]
    v_mfma_f32_16x16x32_bf16 v[40:43], a[8:11], a[56:59], v[40:43]
    v_mfma_f32_16x16x32_bf16 v[72:75], a[8:11], a[60:63], v[72:75]
    v_mfma_f32_16x16x32_bf16 v[12:15], a[12:15], a[52:55], v[12:15]
    v_mfma_f32_16x16x32_bf16 v[44:47], a[12:15], a[56:59], v[44:47]
    v_mfma_f32_16x16x32_bf16 v[76:79], a[12:15], a[60:63], v[76:79]
    s_waitcnt lgkmcnt(9)
    v_mfma_f32_16x16x32_bf16 v[16:19], a[16:19], a[52:55], v[16:19]
    v_mfma_f32_16x16x32_bf16 v[48:51], a[16:19], a[56:59], v[48:51]
    v_mfma_f32_16x16x32_bf16 v[80:83], a[16:19], a[60:63], v[80:83]
    v_mfma_f32_16x16x32_bf16 v[20:23], a[20:23], a[52:55], v[20:23]
    v_mfma_f32_16x16x32_bf16 v[52:55], a[20:23], a[56:59], v[52:55]
    v_mfma_f32_16x16x32_bf16 v[84:87], a[20:23], a[60:63], v[84:87]
    s_waitcnt lgkmcnt(5)
    v_mfma_f32_16x16x32_bf16 v[24:27], a[24:27], a[52:55], v[24:27]
    v_mfma_f32_16x16x32_bf16 v[56:59], a[24:27], a[56:59], v[56:59]
    s_waitcnt vmcnt(1)
    s_add_u32 s16, s16, 4
    v_mov_b32 v187, 1
    s_mov_b64 exec, 1
    ds_add_rtn_u32 v187, v186, v187
    s_mov_b64 exec, -1
    s_waitcnt lgkmcnt(0)
    v_readfirstlane_b32 s17, v187
    s_nop 0
    s_add_u32 s17, s17, 1
    s_cmp_ge_u32 s17, s16
    s_cbranch_scc1 L_gb42_d
    s_mov_b32 s18, 0
L_gb42_l:
    ds_read_b32 v187, v186
    s_add_u32 s18, s18, 1
    s_cmp_ge_u32 s18, 0x200000
    s_cbranch_scc1 L_gb42_d
    s_waitcnt lgkmcnt(0)
    v_readfirstlane_b32 s17, v187
    s_nop 0
    s_cmp_ge_u32 s17, s16
    s_cbranch_scc0 L_gb42_l
L_gb42_d:
    v_mfma_f32_16x16x32_bf16 v[88:91], a[24:27], a[60:63], v[88:91]
    ds_read_b64_tr_b16 a[4:5], v168 offset:49152
    ds_read_b64_tr_b16 a[6:7], v168 offset:53248
    ds_read_b64_tr_b16 a[8:9], v169 offset:49152
    v_mfma_f32_16x16x32_bf16 v[28:31], a[28:31], a[52:55], v[28:31]
    ds_read_b64_tr_b16 a[10:11], v169 offset:53248
    ds_read_b64_tr_b16 a[12:13], v170 offset:49152
    ds_read_b64_tr_b16 a[14:15], v170 offset:53248
    v_mfma_f32_16x16x32_bf16 v[60:63], a[28:31], a[56:59], v[60:63]
    ds_read_b64_tr_b16 a[16:17], v171 offset:49152
    ds_read_b64_tr_b16 a[18:19], v171 offset:53248
    ds_read_b64_tr_b16 a[20:21], v168 offset:50176
    v_mfma_f32_16x16x32_bf16 v[92:95], a[28:31], a[60:63], v[92:95]
    ds_read_b64_tr_b16 a[22:23], v168 offset:54272
    ds_read_b64_tr_b16 a[24:25], v169 offset:50176
    ds_read_b64_tr_b16 a[26:27], v169 offset:54272
    v_mfma_f32_16x16x32_bf16 v[96:99], a[36:39], a[0:3], v[96:99]
    ds_read_b64_tr_b16 a[28:29], v170 offset:50176
    ds_read_b64_tr_b16 a[30:31], v170 offset:54272
    ds_read_b64_tr_b16 a[36:37], v171 offset:50176
    v_mfma_f32_16x16x32_bf16 v[100:103], a[32:35], a[0:3], v[100:103]
    ds_read_b64_tr_b16 a[38:39], v171 offset:54272
    ds_read_b128 a[0:3], v185 offset:8192
    ds_read_b64_tr_b16 a[32:33], v172 offset:49152
    s_waitcnt lgkmcnt(14)
    v_mfma_f32_16x16x32_bf16 v[0:3], a[4:7], v[104:107], v[0:3]
    ds_read_b64_tr_b16 a[34:35], v172 offset:53248
    v_mfma_f32_16x16x32_bf16 v[32:35], a[4:7], v[108:111], v[32:35]
    v_mfma_f32_16x16x32_bf16 v[64:67], a[4:7], v[112:115], v[64:67]
    ds_read_b64_tr_b16 a[4:5], v172 offset:50176
    ds_read_b64_tr_b16 a[6:7], v172 offset:54272
    v_mfma_f32_16x16x32_bf16 v[4:7], a[8:11], v[104:107], v[4:7]
    v_mfma_f32_16x16x32_bf16 v[36:39], a[8:11], v[108:111], v[36:39]
    v_mfma_f32_16x16x32_bf16 v[68:71], a[8:11], v[112:115], v[68:71]
    s_waitcnt lgkmcnt(13)
    v_mfma_f32_16x16x32_bf16 v[8:11], a[12:15], v[104:107], v[8:11]
    v_mfma_f32_16x16x32_bf16 v[40:43], a[12:15], v[108:111], v[40:43]
    v_mfma_f32_16x16x32_bf16 v[72:75], a[12:15], v[112:115], v[72:75]
    v_mfma_f32_16x16x32_bf16 v[12:15], a[16:19], v[104:107], v[12:15]
    v_mfma_f32_16x16x32_bf16 v[44:47], a[16:19], v[108:111], v[44:47]
    v_mfma_f32_16x16x32_bf16 v[76:79], a[16:19], v[112:115], v[76:79]
    s_waitcnt lgkmcnt(9)
    v_mfma_f32_16x16x32_bf16 v[16:19], a[20:23], v[104:107], v[16:19]
    v_mfma_f32_16x16x32_bf16 v[48:51], a[20:23], v[108:111], v[48:51]
    v_mfma_f32_16x16x32_bf16 v[80:83], a[20:23], v[112:115], v[80:83]
    v_mfma_f32_16x16x32_bf16 v[20:23], a[24:27], v[104:107], v[20:23]
    v_mfma_f32_16x16x32_bf16 v[52:55], a[24:27], v[108:111], v[52:55]
    v_mfma_f32_16x16x32_bf16 v[84:87], a[24:27], v[112:115], v[84:87]
    s_waitcnt lgkmcnt(5)
    v_mfma_f32_16x16x32_bf16 v[24:27], a[28:31], v[104:107], v[24:27]
    v_mfma_f32_16x16x32_bf16 v[56:59], a[28:31], v[108:111], v[56:59]
    s_waitcnt vmcnt(0)
    s_add_u32 s16, s16, 4
    v_mov_b32 v187, 1
    s_mov_b64 exec, 1
    ds_add_rtn_u32 v187, v186, v187
    s_mov_b64 exec, -1
    s_waitcnt lgkmcnt(0)
    v_readfirstlane_b32 s17, v187
    s_nop 0
    s_add_u32 s17, s17, 1
    s_cmp_ge_u32 s17, s16
    s_cbranch_scc1 L_gb43_d
    s_mov_b32 s18, 0
L_gb43_l:
    ds_read_b32 v187, v186
    s_add_u32 s18, s18, 1
    s_cmp_ge_u32 s18, 0x200000
    s_cbranch_scc1 L_gb43_d
    s_waitcnt lgkmcnt(0)
    v_readfirstlane_b32 s17, v187
    s_nop 0
    s_cmp_ge_u32 s17, s16
    s_cbranch_scc0 L_gb43_l
L_gb43_d:
    v_mfma_f32_16x16x32_bf16 v[88:91], a[28:31], v[112:115], v[88:91]
    ds_read_b64_tr_b16 a[8:9], v168 offset:57344
    ds_read_b64_tr_b16 a[10:11], v168 offset:61440
    ds_read_b64_tr_b16 a[12:13], v169 offset:57344
    v_mfma_f32_16x16x32_bf16 v[28:31], a[36:39], v[104:107], v[28:31]
    ds_read_b64_tr_b16 a[14:15], v169 offset:61440
    ds_read_b64_tr_b16 a[16:17], v170 offset:57344
    ds_read_b64_tr_b16 a[18:19], v170 offset:61440
    v_mfma_f32_16x16x32_bf16 v[60:63], a[36:39], v[108:111], v[60:63]
    ds_read_b64_tr_b16 a[20:21], v171 offset:57344
    ds_read_b64_tr_b16 a[22:23], v171 offset:61440
    ds_read_b64_tr_b16 a[24:25], v168 offset:58368
    v_mfma_f32_16x16x32_bf16 v[92:95], a[36:39], v[112:115], v[92:95]
    ds_read_b64_tr_b16 a[26:27], v168 offset:62464
    ds_read_b64_tr_b16 a[28:29], v169 offset:58368
    ds_read_b64_tr_b16 a[30:31], v169 offset:62464
    v_mfma_f32_16x16x32_bf16 v[96:99], a[32:35], a[0:3], v[96:99]
    ds_read_b64_tr_b16 a[36:37], v170 offset:58368
    ds_read_b64_tr_b16 a[38:39], v170 offset:62464
    ds_read_b64_tr_b16 a[32:33], v171 offset:58368
    v_mfma_f32_16x16x32_bf16 v[100:103], a[4:7], a[0:3], v[100:103]
    ds_read_b64_tr_b16 a[34:35], v171 offset:62464
    ds_read_b128 a[0:3], v185 offset:9216
    ds_read_b64_tr_b16 a[4:5], v172 offset:57344
    s_waitcnt lgkmcnt(14)
    v_mfma_f32_16x16x32_bf16 v[0:3], a[8:11], v[116:119], v[0:3]
    ds_read_b64_tr_b16 a[6:7], v172 offset:61440
    v_mfma_f32_16x16x32_bf16 v[32:35], a[8:11], v[120:123], v[32:35]
    v_mfma_f32_16x16x32_bf16 v[64:67], a[8:11], v[124:127], v[64:67]
    ds_read_b64_tr_b16 a[8:9], v172 offset:58368
    ds_read_b64_tr_b16 a[10:11], v172 offset:62464
    v_mfma_f32_16x16x32_bf16 v[4:7], a[12:15], v[116:119], v[4:7]
    v_mfma_f32_16x16x32_bf16 v[36:39], a[12:15], v[120:123], v[36:39]
    v_mfma_f32_16x16x32_bf16 v[68:71], a[12:15], v[124:127], v[68:71]
    s_waitcnt lgkmcnt(13)
    v_mfma_f32_16x16x32_bf16 v[8:11], a[16:19], v[116:119], v[8:11]
    v_mfma_f32_16x16x32_bf16 v[40:43], a[16:19], v[120:123], v[40:43]
    v_mfma_f32_16x16x32_bf16 v[72:75], a[16:19], v[124:127], v[72:75]
    v_mfma_f32_16x16x32_bf16 v[12:15], a[20:23], v[116:119], v[12:15]
    v_mfma_f32_16x16x32_bf16 v[44:47], a[20:23], v[120:123], v[44:47]
    v_mfma_f32_16x16x32_bf16 v[76:79], a[20:23], v[124:127], v[76:79]
    s_waitcnt lgkmcnt(9)
    v_mfma_f32_16x16x32_bf16 v[16:19], a[24:27], v[116:119], v[16:19]
    v_mfma_f32_16x16x32_bf16 v[48:51], a[24:27], v[120:123], v[48:51]
    v_mfma_f32_16x16x32_bf16 v[80:83], a[24:27], v[124:127], v[80:83]
    v_mfma_f32_16x16x32_bf16 v[20:23], a[28:31], v[116:119], v[20:23]
    v_mfma_f32_16x16x32_bf16 v[52:55], a[28:31], v[120:123], v[52:55]
    v_mfma_f32_16x16x32_bf16 v[84:87], a[28:31], v[124:127], v[84:87]
    s_waitcnt lgkmcnt(5)
    v_mfma_f32_16x16x32_bf16 v[24:27], a[36:39], v[116:119], v[24:27]
    v_mfma_f32_16x16x32_bf16 v[56:59], a[36:39], v[120:123], v[56:59]
    v_mfma_f32_16x16x32_bf16 v[88:91], a[36:39], v[124:127], v[88:91]
    v_mfma_f32_16x16x32_bf16 v[28:31], a[32:35], v[116:119], v[28:31]
    v_mfma_f32_16x16x32_bf16 v[60:63], a[32:35], v[120:123], v[60:63]
    v_mfma_f32_16x16x32_bf16 v[92:95], a[32:35], v[124:127], v[92:95]
    s_waitcnt lgkmcnt(0)
    v_mfma_f32_16x16x32_bf16 v[96:99], a[4:7], a[0:3], v[96:99]
    v_mfma_f32_16x16x32_bf16 v[100:103], a[8:11], a[0:3], v[100:103]
    s_add_u32 s16, s16, 4
    v_mov_b32 v187, 1
    s_mov_b64 exec, 1
    ds_add_rtn_u32 v187, v186, v187
    s_mov_b64 exec, -1
    s_waitcnt lgkmcnt(0)
    v_readfirstlane_b32 s17, v187
    s_nop 0
    s_add_u32 s17, s17, 1
    s_cmp_ge_u32 s17, s16
    s_cbranch_scc1 L_gb44_d
    s_mov_b32 s18, 0
L_gb44_l:
    ds_read_b32 v187, v186
    s_add_u32 s18, s18, 1
    s_cmp_ge_u32 s18, 0x200000
    s_cbranch_scc1 L_gb44_d
    s_waitcnt lgkmcnt(0)
    v_readfirstlane_b32 s17, v187
    s_nop 0
    s_cmp_ge_u32 s17, s16
    s_cbranch_scc0 L_gb44_l
L_gb44_d:
    s_mul_i32 s54, s3, 13312
    s_add_u32 s55, s54, s101
    v_add_u32 v180, s55, v184
    s_sub_u32 s55, 81920, s101
    s_add_u32 s55, s55, s54
    v_add_u32 v181, s55, v184
    s_cmp_eq_u32 s56, 0
    s_cbranch_scc0 L_concat_heads__mha_block_cached__gqa_block_cached__near_ridge_kernel_r1
    ds_write_b128 v180, v[16:19] offset:0
    ds_write_b128 v180, v[20:23] offset:1024
    ds_write_b128 v180, v[24:27] offset:2048
    ds_write_b128 v180, v[28:31] offset:3072
    ds_write_b128 v180, v[48:51] offset:4096
    ds_write_b128 v180, v[52:55] offset:5120
    ds_write_b128 v180, v[56:59] offset:6144
    ds_write_b128 v180, v[60:63] offset:7168
    ds_write_b128 v180, v[80:83] offset:8192
    ds_write_b128 v180, v[84:87] offset:9216
    ds_write_b128 v180, v[88:91] offset:10240
    ds_write_b128 v180, v[92:95] offset:11264
    ds_write_b128 v180, v[100:103] offset:12288
    s_waitcnt lgkmcnt(0)
    s_barrier
    ds_read_b128 v[104:107], v181 offset:0
    ds_read_b128 v[108:111], v181 offset:1024
    ds_read_b128 v[112:115], v181 offset:2048
    ds_read_b128 v[116:119], v181 offset:3072
    ds_read_b128 v[120:123], v181 offset:4096
    ds_read_b128 v[124:127], v181 offset:5120
    ds_read_b128 v[128:131], v181 offset:6144
    ds_read_b128 v[132:135], v181 offset:7168
    ds_read_b128 v[136:139], v181 offset:8192
    ds_read_b128 v[140:143], v181 offset:9216
    ds_read_b128 v[144:147], v181 offset:10240
    ds_read_b128 v[148:151], v181 offset:11264
    ds_read_b128 v[152:155], v181 offset:12288
    s_waitcnt lgkmcnt(12)
    v_add_f32 v104, v104, v0
    v_add_f32 v105, v105, v1
    v_add_f32 v106, v106, v2
    v_add_f32 v107, v107, v3
    s_waitcnt lgkmcnt(11)
    v_add_f32 v108, v108, v4
    v_add_f32 v109, v109, v5
    v_add_f32 v110, v110, v6
    v_add_f32 v111, v111, v7
    s_waitcnt lgkmcnt(10)
    v_add_f32 v112, v112, v8
    v_add_f32 v113, v113, v9
    v_add_f32 v114, v114, v10
    v_add_f32 v115, v115, v11
    s_waitcnt lgkmcnt(9)
    v_add_f32 v116, v116, v12
    v_add_f32 v117, v117, v13
    v_add_f32 v118, v118, v14
    v_add_f32 v119, v119, v15
    s_waitcnt lgkmcnt(8)
    v_add_f32 v120, v120, v32
    v_add_f32 v121, v121, v33
    v_add_f32 v122, v122, v34
    v_add_f32 v123, v123, v35
    s_waitcnt lgkmcnt(7)
    v_add_f32 v124, v124, v36
    v_add_f32 v125, v125, v37
    v_add_f32 v126, v126, v38
    v_add_f32 v127, v127, v39
    s_waitcnt lgkmcnt(6)
    v_add_f32 v128, v128, v40
    v_add_f32 v129, v129, v41
    v_add_f32 v130, v130, v42
    v_add_f32 v131, v131, v43
    s_waitcnt lgkmcnt(5)
    v_add_f32 v132, v132, v44
    v_add_f32 v133, v133, v45
    v_add_f32 v134, v134, v46
    v_add_f32 v135, v135, v47
    s_waitcnt lgkmcnt(4)
    v_add_f32 v136, v136, v64
    v_add_f32 v137, v137, v65
    v_add_f32 v138, v138, v66
    v_add_f32 v139, v139, v67
    s_waitcnt lgkmcnt(3)
    v_add_f32 v140, v140, v68
    v_add_f32 v141, v141, v69
    v_add_f32 v142, v142, v70
    v_add_f32 v143, v143, v71
    s_waitcnt lgkmcnt(2)
    v_add_f32 v144, v144, v72
    v_add_f32 v145, v145, v73
    v_add_f32 v146, v146, v74
    v_add_f32 v147, v147, v75
    s_waitcnt lgkmcnt(1)
    v_add_f32 v148, v148, v76
    v_add_f32 v149, v149, v77
    v_add_f32 v150, v150, v78
    v_add_f32 v151, v151, v79
    s_waitcnt lgkmcnt(0)
    v_add_f32 v152, v152, v96
    v_add_f32 v153, v153, v97
    v_add_f32 v154, v154, v98
    v_add_f32 v155, v155, v99
    s_branch L_concat_heads__mha_block_cached__gqa_block_cached__near_ridge_kernel_r2
L_concat_heads__mha_block_cached__gqa_block_cached__near_ridge_kernel_r1:
    s_nop 7
    ds_write_b128 v180, v[0:3] offset:0
    ds_write_b128 v180, v[4:7] offset:1024
    ds_write_b128 v180, v[8:11] offset:2048
    ds_write_b128 v180, v[12:15] offset:3072
    ds_write_b128 v180, v[32:35] offset:4096
    ds_write_b128 v180, v[36:39] offset:5120
    ds_write_b128 v180, v[40:43] offset:6144
    ds_write_b128 v180, v[44:47] offset:7168
    ds_write_b128 v180, v[64:67] offset:8192
    ds_write_b128 v180, v[68:71] offset:9216
    ds_write_b128 v180, v[72:75] offset:10240
    ds_write_b128 v180, v[76:79] offset:11264
    ds_write_b128 v180, v[96:99] offset:12288
    s_waitcnt lgkmcnt(0)
    s_barrier
    ds_read_b128 v[104:107], v181 offset:0
    ds_read_b128 v[108:111], v181 offset:1024
    ds_read_b128 v[112:115], v181 offset:2048
    ds_read_b128 v[116:119], v181 offset:3072
    ds_read_b128 v[120:123], v181 offset:4096
    ds_read_b128 v[124:127], v181 offset:5120
    ds_read_b128 v[128:131], v181 offset:6144
    ds_read_b128 v[132:135], v181 offset:7168
    ds_read_b128 v[136:139], v181 offset:8192
    ds_read_b128 v[140:143], v181 offset:9216
    ds_read_b128 v[144:147], v181 offset:10240
    ds_read_b128 v[148:151], v181 offset:11264
    ds_read_b128 v[152:155], v181 offset:12288
    s_waitcnt lgkmcnt(12)
    v_add_f32 v104, v104, v16
    v_add_f32 v105, v105, v17
    v_add_f32 v106, v106, v18
    v_add_f32 v107, v107, v19
    s_waitcnt lgkmcnt(11)
    v_add_f32 v108, v108, v20
    v_add_f32 v109, v109, v21
    v_add_f32 v110, v110, v22
    v_add_f32 v111, v111, v23
    s_waitcnt lgkmcnt(10)
    v_add_f32 v112, v112, v24
    v_add_f32 v113, v113, v25
    v_add_f32 v114, v114, v26
    v_add_f32 v115, v115, v27
    s_waitcnt lgkmcnt(9)
    v_add_f32 v116, v116, v28
    v_add_f32 v117, v117, v29
    v_add_f32 v118, v118, v30
    v_add_f32 v119, v119, v31
    s_waitcnt lgkmcnt(8)
    v_add_f32 v120, v120, v48
    v_add_f32 v121, v121, v49
    v_add_f32 v122, v122, v50
    v_add_f32 v123, v123, v51
    s_waitcnt lgkmcnt(7)
    v_add_f32 v124, v124, v52
    v_add_f32 v125, v125, v53
    v_add_f32 v126, v126, v54
    v_add_f32 v127, v127, v55
    s_waitcnt lgkmcnt(6)
    v_add_f32 v128, v128, v56
    v_add_f32 v129, v129, v57
    v_add_f32 v130, v130, v58
    v_add_f32 v131, v131, v59
    s_waitcnt lgkmcnt(5)
    v_add_f32 v132, v132, v60
    v_add_f32 v133, v133, v61
    v_add_f32 v134, v134, v62
    v_add_f32 v135, v135, v63
    s_waitcnt lgkmcnt(4)
    v_add_f32 v136, v136, v80
    v_add_f32 v137, v137, v81
    v_add_f32 v138, v138, v82
    v_add_f32 v139, v139, v83
    s_waitcnt lgkmcnt(3)
    v_add_f32 v140, v140, v84
    v_add_f32 v141, v141, v85
    v_add_f32 v142, v142, v86
    v_add_f32 v143, v143, v87
    s_waitcnt lgkmcnt(2)
    v_add_f32 v144, v144, v88
    v_add_f32 v145, v145, v89
    v_add_f32 v146, v146, v90
    v_add_f32 v147, v147, v91
    s_waitcnt lgkmcnt(1)
    v_add_f32 v148, v148, v92
    v_add_f32 v149, v149, v93
    v_add_f32 v150, v150, v94
    v_add_f32 v151, v151, v95
    s_waitcnt lgkmcnt(0)
    v_add_f32 v152, v152, v100
    v_add_f32 v153, v153, v101
    v_add_f32 v154, v154, v102
    v_add_f32 v155, v155, v103
L_concat_heads__mha_block_cached__gqa_block_cached__near_ridge_kernel_r2:
    s_add_u32 s54, s26, 1
    s_and_b32 s54, s54, 3
    s_lshl_b32 s54, s54, 2
    s_add_u32 s54, s54, s26
    s_lshl_b32 s54, s54, 3
    s_add_u32 s54, s54, s57
    s_lshl_b32 s54, s54, 12
    buffer_store_dwordx4 v[108:111], v184, s[36:39], s54 offen offset:0 sc1
    buffer_store_dwordx4 v[124:127], v184, s[36:39], s54 offen offset:1024 sc1
    buffer_store_dwordx4 v[140:143], v184, s[36:39], s54 offen offset:2048 sc1
    s_add_u32 s54, s26, 2
    s_and_b32 s54, s54, 3
    s_lshl_b32 s54, s54, 2
    s_add_u32 s54, s54, s26
    s_lshl_b32 s54, s54, 3
    s_add_u32 s54, s54, s57
    s_lshl_b32 s54, s54, 12
    buffer_store_dwordx4 v[112:115], v184, s[36:39], s54 offen offset:0 sc1
    buffer_store_dwordx4 v[128:131], v184, s[36:39], s54 offen offset:1024 sc1
    buffer_store_dwordx4 v[144:147], v184, s[36:39], s54 offen offset:2048 sc1
    s_add_u32 s54, s26, 3
    s_and_b32 s54, s54, 3
    s_lshl_b32 s54, s54, 2
    s_add_u32 s54, s54, s26
    s_lshl_b32 s54, s54, 3
    s_add_u32 s54, s54, s57
    s_lshl_b32 s54, s54, 12
    buffer_store_dwordx4 v[116:119], v184, s[36:39], s54 offen offset:0 sc1
    buffer_store_dwordx4 v[132:135], v184, s[36:39], s54 offen offset:1024 sc1
    buffer_store_dwordx4 v[148:151], v184, s[36:39], s54 offen offset:2048 sc1
    s_lshl_b32 s54, s3, 2
    s_add_u32 s54, s54, s26
    s_lshl_b32 s54, s54, 3
    s_add_u32 s54, s54, s57
    s_lshl_b32 s54, s54, 12
    buffer_store_dwordx4 v[152:155], v184, s[36:39], s54 offen offset:3072 sc1
    s_waitcnt vmcnt(0)
    s_andn2_b32 s54, s2, 3
    s_lshl_b32 s54, s54, 8
    s_lshl_b32 s7, s26, 3
    s_add_u32 s7, s7, s57
    s_lshl_b32 s7, s7, 2
    s_add_u32 s54, s54, s7
    v_lshlrev_b32 v181, 4, v184
    v_mov_b32 v173, 1
    s_mov_b64 exec, 0xf
    buffer_store_dword v173, v181, s[84:87], s54 offen offset:128 sc1
    s_mov_b64 exec, -1
    s_lshl_b32 s55, 0x01010101, s57
    s_mov_b32 s50, 0
    s_lshl_b32 s7, s2, 8
    v_lshrrev_b32 v181, 2, v184
    v_and_b32 v181, 0x7c, v181
L_concat_heads__mha_block_cached__gqa_block_cached__near_ridge_kernel_w1_poll:
    buffer_load_dword v173, v181, s[84:87], s7 offen offset:128 sc1
    s_waitcnt vmcnt(0)
    v_cmp_eq_u32 vcc, 1, v173
    s_nop 0
    s_and_b32 s54, vcc_lo, s55
    s_cmp_eq_u32 s54, s55
    s_cbranch_scc1 L_concat_heads__mha_block_cached__gqa_block_cached__near_ridge_kernel_w1_polled
    s_sleep 2
    s_add_u32 s50, s50, 1
    s_cmp_lt_u32 s50, 0x100000
    s_cbranch_scc1 L_concat_heads__mha_block_cached__gqa_block_cached__near_ridge_kernel_w1_poll
L_concat_heads__mha_block_cached__gqa_block_cached__near_ridge_kernel_w1_polled:
    s_add_u32 s54, s26, 1
    s_and_b32 s54, s54, 3
    s_lshl_b32 s55, s26, 2
    s_add_u32 s54, s54, s55
    s_lshl_b32 s54, s54, 3
    s_add_u32 s54, s54, s57
    s_lshl_b32 s54, s54, 12
    buffer_load_dwordx4 v[0:3], v184, s[36:39], s54 offen offset:0 sc1
    buffer_load_dwordx4 v[4:7], v184, s[36:39], s54 offen offset:1024 sc1
    buffer_load_dwordx4 v[8:11], v184, s[36:39], s54 offen offset:2048 sc1
    buffer_load_dwordx4 v[12:15], v184, s[36:39], s54 offen offset:3072 sc1
    s_add_u32 s54, s26, 2
    s_and_b32 s54, s54, 3
    s_lshl_b32 s55, s26, 2
    s_add_u32 s54, s54, s55
    s_lshl_b32 s54, s54, 3
    s_add_u32 s54, s54, s57
    s_lshl_b32 s54, s54, 12
    buffer_load_dwordx4 v[16:19], v184, s[36:39], s54 offen offset:0 sc1
    buffer_load_dwordx4 v[20:23], v184, s[36:39], s54 offen offset:1024 sc1
    buffer_load_dwordx4 v[24:27], v184, s[36:39], s54 offen offset:2048 sc1
    buffer_load_dwordx4 v[28:31], v184, s[36:39], s54 offen offset:3072 sc1
    s_add_u32 s54, s26, 3
    s_and_b32 s54, s54, 3
    s_lshl_b32 s55, s26, 2
    s_add_u32 s54, s54, s55
    s_lshl_b32 s54, s54, 3
    s_add_u32 s54, s54, s57
    s_lshl_b32 s54, s54, 12
    buffer_load_dwordx4 v[32:35], v184, s[36:39], s54 offen offset:0 sc1
    buffer_load_dwordx4 v[36:39], v184, s[36:39], s54 offen offset:1024 sc1
    buffer_load_dwordx4 v[40:43], v184, s[36:39], s54 offen offset:2048 sc1
    buffer_load_dwordx4 v[44:47], v184, s[36:39], s54 offen offset:3072 sc1
    v_and_b32 v180, 15, v182
    v_lshlrev_b32 v180, 11, v180
    v_lshl_add_u32 v180, v183, 3, v180
    s_lshl_b32 s54, s56, 7
    s_lshl_b32 s55, s26, 5
    s_add_u32 s54, s54, s55
    s_mul_i32 s55, s3, 98304
    s_add_u32 s55, s55, s54
    s_waitcnt vmcnt(7)
    v_add_f32 v0, v0, v16
    s_waitcnt vmcnt(3)
    v_add_f32 v104, v104, v32
    v_add_f32 v1, v1, v17
    v_add_f32 v105, v105, v33
    v_add_f32 v2, v2, v18
    v_add_f32 v106, v106, v34
    v_add_f32 v3, v3, v19
    v_add_f32 v107, v107, v35
    v_add_f32 v104, v104, v0
    v_add_f32 v105, v105, v1
    v_add_f32 v106, v106, v2
    v_add_f32 v107, v107, v3
    v_cvt_pk_bf16_f32 v48, v104, v105
    v_cvt_pk_bf16_f32 v49, v106, v107
    buffer_store_dwordx2 v[48:49], v180, s[44:47], s55 offen
    s_add_u32 s55, s55, 32768
    v_add_f32 v4, v4, v20
    s_waitcnt vmcnt(3)
    v_add_f32 v120, v120, v36
    v_add_f32 v5, v5, v21
    v_add_f32 v121, v121, v37
    v_add_f32 v6, v6, v22
    v_add_f32 v122, v122, v38
    v_add_f32 v7, v7, v23
    v_add_f32 v123, v123, v39
    v_add_f32 v120, v120, v4
    v_add_f32 v121, v121, v5
    v_add_f32 v122, v122, v6
    v_add_f32 v123, v123, v7
    v_cvt_pk_bf16_f32 v50, v120, v121
    v_cvt_pk_bf16_f32 v51, v122, v123
    buffer_store_dwordx2 v[50:51], v180, s[44:47], s55 offen
    s_add_u32 s55, s55, 32768
    v_add_f32 v8, v8, v24
    s_waitcnt vmcnt(3)
    v_add_f32 v136, v136, v40
    v_add_f32 v9, v9, v25
    v_add_f32 v137, v137, v41
    v_add_f32 v10, v10, v26
    v_add_f32 v138, v138, v42
    v_add_f32 v11, v11, v27
    v_add_f32 v139, v139, v43
    v_add_f32 v136, v136, v8
    v_add_f32 v137, v137, v9
    v_add_f32 v138, v138, v10
    v_add_f32 v139, v139, v11
    v_cvt_pk_bf16_f32 v52, v136, v137
    v_cvt_pk_bf16_f32 v53, v138, v139
    buffer_store_dwordx2 v[52:53], v180, s[44:47], s55 offen
    s_add_u32 s55, s55, 32768
    v_add_f32 v12, v12, v28
    s_waitcnt vmcnt(3)
    v_add_f32 v152, v152, v44
    v_add_f32 v13, v13, v29
    v_add_f32 v153, v153, v45
    v_add_f32 v14, v14, v30
    v_add_f32 v154, v154, v46
    v_add_f32 v15, v15, v31
    v_add_f32 v155, v155, v47
    v_add_f32 v152, v152, v12
    v_add_f32 v153, v153, v13
    v_add_f32 v154, v154, v14
    v_add_f32 v155, v155, v15
    v_cvt_pk_bf16_f32 v54, v152, v153
    v_cvt_pk_bf16_f32 v55, v154, v155
    s_cmp_lg_u32 s3, s26
    s_cbranch_scc1 L_concat_heads__mha_block_cached__gqa_block_cached__near_ridge_kernel_fin
    s_add_u32 s54, s54, 393216
    buffer_store_dwordx2 v[54:55], v180, s[44:47], s54 offen
L_concat_heads__mha_block_cached__gqa_block_cached__near_ridge_kernel_fin:
L_concat_heads__mha_block_cached__gqa_block_cached__near_ridge_kernel_end:
    s_endpgm
.section .rodata,"a"
.p2align 6
.amdhsa_kernel concat_heads__mha_block_cached__gqa_block_cached__near_ridge_kernel
  .amdhsa_next_free_vgpr 256
  .amdhsa_next_free_sgpr 102
  .amdhsa_accum_offset 188
  .amdhsa_group_segment_fixed_size 0
  .amdhsa_kernarg_size 104
  .amdhsa_user_sgpr_count 2
  .amdhsa_user_sgpr_kernarg_segment_ptr 1
  .amdhsa_system_sgpr_workgroup_id_x 1
.end_amdhsa_kernel
```
